```python
import torch

def _softmax(x, axis=-1):
    return torch.softmax(x, dim=axis)
def _gelu(x):
    return torch.nn.functional.gelu(x, approximate="tanh")
def _silu(x):
    return torch.nn.functional.silu(x)
def _sigmoid(x):
    return torch.sigmoid(x)
def _layernorm(x, axis=-1, eps=1e-5):
    m = x.mean(dim=axis, keepdim=True)
    v = x.var(dim=axis, keepdim=True, unbiased=False)
    return (x - m) / torch.sqrt(v + eps)
def _scatter_add(tgt, idx, src, axis=0):
    return tgt.clone().index_add_(axis, idx, src)
def _segment_sum(src, seg, n):
    out = torch.zeros((n,) + src.shape[1:], dtype=src.dtype)
    return out.index_add_(0, seg, src)
def _pad(x, pw):
    flat = tuple(v for pair in reversed(pw) for v in pair)
    return torch.nn.functional.pad(x, flat)

kernel_name = 'interleave_layers__linear_attn_block__spectral_fnet__prompt'

def setup_inputs():

    _w = (lambda a: (lambda t: t.to(torch.bfloat16) if t.is_floating_point() else t)(torch.as_tensor(a)))
    def _A_setup():
        B, S, D = 1, 2048, 1024
        return {
            "x": _w((lambda *s: torch.randn(*s, dtype=torch.bfloat16) * 0.4)(B, S, D)),
            "wqkv": _w((lambda *s: torch.randn(*s, dtype=torch.bfloat16) * 1.6)(D, 3 * D)),
            "wo": _w((lambda *s: torch.randn(*s, dtype=torch.bfloat16) * 1.6)(D, D)),
        }
    _A_in = _A_setup()

    def _B_setup():
        B, S, D = 1, 2048, 1024
        ns = torch.arange(S)[:, None] * torch.arange(S)[None, :]
        nd = torch.arange(D)[:, None] * torch.arange(D)[None, :]
        Ws_re = torch.cos(-2.0 * torch.pi * ns / S).to(float)
        Ws_im = torch.sin(-2.0 * torch.pi * ns / S).to(float)
        Wd_re = torch.cos(-2.0 * torch.pi * nd / D).to(float)
        Wd_im = torch.sin(-2.0 * torch.pi * nd / D).to(float)
        return {
            "x": _w((lambda *s: torch.randn(*s, dtype=torch.bfloat16) * 0.4)(B, S, D)),
            "dft_seq_re": _w(Ws_re),
            "dft_seq_im": _w(Ws_im),
            "dft_hid_re": _w(Wd_re),
            "dft_hid_im": _w(Wd_im),
        }
    _B_in = _B_setup()

    return {
        "A_x": _A_in["x"],
        "A_wqkv": _A_in["wqkv"],
        "A_wo": _A_in["wo"],
        "B_x": _B_in["x"],
        "B_dft_seq_re": _B_in["dft_seq_re"],
        "B_dft_seq_im": _B_in["dft_seq_im"],
        "B_dft_hid_re": _B_in["dft_hid_re"],
        "B_dft_hid_im": _B_in["dft_hid_im"],
    }

def reference(A_x, A_wqkv, A_wo, B_x, B_dft_seq_re, B_dft_seq_im, B_dft_hid_re, B_dft_hid_im):
    def _A_ref(x, wqkv, wo):
        B, S, D = x.shape
        H = 32; Dh = D // H
        qkv = (lambda x, *d: x.permute(*d))((x @ wqkv).reshape(B, S, 3, H, Dh), 2, 0, 3, 1, 4)
        q, k, v = qkv[0], qkv[1], qkv[2]
        phi = lambda t: torch.where(t > 0, t + 1, torch.exp(t)) + 1e-6
        pq, pk = phi(q), phi(k)
        kv = torch.einsum("bhsd,bhse->bhde", pk, v)
        z = torch.einsum("bhsd->bhd", pk)
        num = torch.einsum("bhqd,bhde->bhqe", pq, kv)
        den = torch.einsum("bhqd,bhd->bhq", pq, z)[..., None] + 1e-6
        o = num / den
        return (lambda x, *d: x.permute(*d))(o, 0, 2, 1, 3).reshape(B, S, D) @ wo

    def _B_ref(x, dft_seq_re, dft_seq_im, dft_hid_re, dft_hid_im):
        a = torch.einsum("bsd,ed->bse", x, dft_hid_re)
        b = torch.einsum("bsd,ed->bse", x, dft_hid_im)
        y = torch.einsum("ts,bse->bte", dft_seq_re, a) - torch.einsum("ts,bse->bte", dft_seq_im, b)
        return y

    x = A_x
    x = x + _A_ref(_layernorm(x, axis=-1), A_wqkv, A_wo)
    x = x + _B_ref(_layernorm(x, axis=-1), B_dft_seq_re, B_dft_seq_im, B_dft_hid_re, B_dft_hid_im)
    x = x + _A_ref(_layernorm(x, axis=-1), A_wqkv, A_wo)
    x = x + _B_ref(_layernorm(x, axis=-1), B_dft_seq_re, B_dft_seq_im, B_dft_hid_re, B_dft_hid_im)
    return x
```

```asm
; @launch grid=(256,1,1) block=(256,1,1) lds=163840
.amdgcn_target "amdgcn-amd-amdhsa--gfx950"
.text
.globl interleave_layers__linear_attn_block__spectral_fnet__prompt_kernel
.p2align 8
.type interleave_layers__linear_attn_block__spectral_fnet__prompt_kernel,@function
interleave_layers__linear_attn_block__spectral_fnet__prompt_kernel:
  s_cmp_ge_u32 s2, 256
  s_cbranch_scc1 L_END
  s_load_dwordx2 s[66:67], s[0:1], 0
  s_load_dwordx2 s[68:69], s[0:1], 8
  s_load_dwordx2 s[70:71], s[0:1], 16
  s_load_dwordx4 s[72:75], s[0:1], 64
  s_load_dwordx2 s[76:77], s[0:1], 80
  v_lshrrev_b32 v1, 6, v0
  v_and_b32 v0, 63, v0
  v_readfirstlane_b32 s30, v1
  s_and_b32 s78, s2, 7
  s_lshr_b32 s79, s78, 1
  s_lshl_b32 s79, s79, 2
  s_lshr_b32 s80, s2, 6
  s_add_u32 s28, s79, s80
  s_and_b32 s79, s2, 1
  s_lshl_b32 s79, s79, 3
  s_lshr_b32 s80, s2, 3
  s_and_b32 s80, s80, 7
  s_add_u32 s29, s79, s80
  s_mul_i32 s79, s29, 0
  s_mul_i32 s80, s28, 5
  s_add_u32 s79, s79, s80
  s_and_b32 s33, s79, 15
  s_mov_b32 s32, 0
  s_mov_b32 s31, 0
  v_lshlrev_b32 v1, 4, v0
  s_lshr_b32 s82, s29, 1
  s_lshl_b32 s82, s82, 4
  s_add_u32 s82, s82, s28
  s_and_b32 s78, s29, 1
  s_lshl_b32 s78, s78, 10
  s_add_u32 s82, s82, s78
  s_lshl_b32 s82, s82, 11
  s_lshl_b32 s80, s30, 9
  s_add_u32 s82, s82, s80
  v_lshrrev_b32 v10, 3, v0
  v_lshlrev_b32 v10, 18, v10
  v_and_b32 v11, 7, v0
  v_lshl_add_u32 v10, v11, 4, v10
  s_waitcnt lgkmcnt(0)
  s_mov_b32 s12, s66
  s_mov_b32 s13, s67
  s_mov_b32 s14, 4194304
  s_mov_b32 s15, 0x00020000
  buffer_load_dwordx4 v[16:19], v10, s[12:15], s82 offen
  buffer_load_dwordx4 v[20:23], v10, s[12:15], s82 offen offset:128
  buffer_load_dwordx4 v[24:27], v10, s[12:15], s82 offen offset:256
  buffer_load_dwordx4 v[28:31], v10, s[12:15], s82 offen offset:384
  s_mov_b32 s4, s76
  s_mov_b32 s5, s77
  s_mov_b32 s6, 268435456
  s_mov_b32 s7, 0x00020000
  s_lshl_b32 s94, s30, 12
  v_mov_b32 v14, 0
  buffer_load_dword v15, v14, s[4:7], 0 offen sc1
  s_getpc_b64 s[84:85]
L_PC:
  s_sub_u32 s84, s84, L_PC-interleave_layers__linear_attn_block__spectral_fnet__prompt_kernel
  s_subb_u32 s85, s85, 0
  s_mov_b32 s86, L_CODE_END-interleave_layers__linear_attn_block__spectral_fnet__prompt_kernel
  s_mov_b32 s87, 0x00020000
  s_lshr_b32 s79, s2, 3
  s_lshl_b32 s79, s79, 2
  s_add_u32 s79, s79, s30
  s_lshl_b32 s79, s79, 10
  buffer_load_dwordx4 v[240:243], v1, s[84:87], s79 offen
  s_mov_b32 s8, s68
  s_mov_b32 s9, s69
  s_mov_b32 s10, 6291456
  s_mov_b32 s11, 0x00020000
  s_mov_b32 s16, s70
  s_mov_b32 s17, s71
  s_mov_b32 s18, 2097152
  s_mov_b32 s19, 0x00020000
  s_mov_b32 s20, s72
  s_mov_b32 s21, s73
  s_mov_b32 s22, 4194304
  s_mov_b32 s23, 0x00020000
  s_cmp_lg_u32 s2, 0
  s_cbranch_scc1 L_zero_1
  s_cmp_lg_u32 s30, 3
  s_cbranch_scc1 L_zero_1
  s_mov_b64 exec, 0xffffffff
  s_mov_b32 exec_hi, 0
  v_lshlrev_b32 v120, 7, v0
  v_mov_b32 v121, 0
  s_mov_b32 s79, 53248
  buffer_store_dword v121, v120, s[4:7], s79 offen sc1
  s_mov_b64 exec, -1
L_zero_1:
  s_add_u32 s79, s33, 0
  s_and_b32 s79, s79, 15
  s_lshl_b32 s34, s79, 11
  s_mul_i32 s50, s79, 393216
  s_add_u32 s79, s33, 1
  s_and_b32 s79, s79, 15
  s_lshl_b32 s35, s79, 11
  s_mul_i32 s51, s79, 393216
  s_add_u32 s79, s33, 2
  s_and_b32 s79, s79, 15
  s_lshl_b32 s36, s79, 11
  s_mul_i32 s52, s79, 393216
  s_add_u32 s79, s33, 3
  s_and_b32 s79, s79, 15
  s_lshl_b32 s37, s79, 11
  s_mul_i32 s53, s79, 393216
  s_add_u32 s79, s33, 4
  s_and_b32 s79, s79, 15
  s_lshl_b32 s38, s79, 11
  s_mul_i32 s54, s79, 393216
  s_add_u32 s79, s33, 5
  s_and_b32 s79, s79, 15
  s_lshl_b32 s39, s79, 11
  s_mul_i32 s55, s79, 393216
  s_add_u32 s79, s33, 6
  s_and_b32 s79, s79, 15
  s_lshl_b32 s40, s79, 11
  s_mul_i32 s56, s79, 393216
  s_add_u32 s79, s33, 7
  s_and_b32 s79, s79, 15
  s_lshl_b32 s41, s79, 11
  s_mul_i32 s57, s79, 393216
  s_add_u32 s79, s33, 8
  s_and_b32 s79, s79, 15
  s_lshl_b32 s42, s79, 11
  s_mul_i32 s58, s79, 393216
  s_add_u32 s79, s33, 9
  s_and_b32 s79, s79, 15
  s_lshl_b32 s43, s79, 11
  s_mul_i32 s59, s79, 393216
  s_add_u32 s79, s33, 10
  s_and_b32 s79, s79, 15
  s_lshl_b32 s44, s79, 11
  s_mul_i32 s60, s79, 393216
  s_add_u32 s79, s33, 11
  s_and_b32 s79, s79, 15
  s_lshl_b32 s45, s79, 11
  s_mul_i32 s61, s79, 393216
  s_add_u32 s79, s33, 12
  s_and_b32 s79, s79, 15
  s_lshl_b32 s46, s79, 11
  s_mul_i32 s62, s79, 393216
  s_add_u32 s79, s33, 13
  s_and_b32 s79, s79, 15
  s_lshl_b32 s47, s79, 11
  s_mul_i32 s63, s79, 393216
  s_add_u32 s79, s33, 14
  s_and_b32 s79, s79, 15
  s_lshl_b32 s48, s79, 11
  s_mul_i32 s64, s79, 393216
  s_add_u32 s79, s33, 15
  s_and_b32 s79, s79, 15
  s_lshl_b32 s49, s79, 11
  s_mul_i32 s65, s79, 393216
  v_lshrrev_b32 v10, 3, v0
  v_bfe_u32 v11, v0, 4, 1
  v_bfe_u32 v12, v0, 1, 2
  v_xor_b32 v11, v11, v12
  v_and_b32 v12, 1, v0
  v_lshlrev_b32 v12, 4, v12
  s_mov_b32 s79, 6144
  v_mul_lo_u32 v10, s79, v10
  v_add_u32 v10, v10, v12
  s_mul_i32 s79, s30, 98304
  s_lshl_b32 s80, s29, 7
  s_add_u32 s79, s79, s80
  v_add_u32 v10, s79, v10
  v_lshl_add_u32 v4, v11, 5, v10
  v_xor_b32 v11, 2, v11
  v_lshl_add_u32 v5, v11, 5, v10
  v_add_u32 v5, 49152, v5
  v_add_u32 v2, 2048, v4
  v_add_u32 v3, 2048, v5
  v_lshrrev_b32 v10, 5, v0
  v_lshlrev_b32 v10, 12, v10
  v_bfe_u32 v11, v0, 4, 1
  v_lshl_add_u32 v10, v11, 10, v10
  v_bfe_u32 v12, v0, 2, 2
  v_lshl_add_u32 v10, v12, 7, v10
  v_and_b32 v12, 3, v0
  v_lshl_add_u32 v10, v12, 3, v10
  v_lshlrev_b32 v11, 1, v11
  v_bfe_u32 v12, v0, 3, 1
  v_or_b32 v11, v11, v12
  v_lshl_add_u32 v6, v11, 5, v10
  v_xor_b32 v7, 32, v6
  v_xor_b32 v8, 64, v6
  v_xor_b32 v9, 96, v6
  s_lshl_b32 s88, s28, 3
  s_lshr_b32 s80, s29, 1
  s_add_u32 s88, s88, s80
  s_lshl_b32 s88, s88, 15
  s_and_b32 s80, s29, 1
  s_lshl_b32 s80, s80, 7
  s_add_u32 s88, s88, s80
  s_add_u32 s88, s88, 8388608
  v_lshrrev_b32 v10, 3, v0
  v_lshlrev_b32 v137, 5, v10
  v_add_u32 v137, 131584, v137
  v_bfe_u32 v11, v0, 2, 1
  v_lshlrev_b32 v11, 10, v11
  v_and_b32 v12, 3, v0
  v_lshl_add_u32 v11, v12, 8, v11
  v_lshl_add_u32 v138, v10, 4, v11
  s_lshl_b32 s79, s30, 13
  v_add_u32 v138, s79, v138
  v_mul_u32_u24 v139, 2080, v10
  v_and_b32 v11, 7, v0
  v_lshl_add_u32 v139, v11, 4, v139
  s_lshl_b32 s79, s30, 9
  s_add_u32 s79, s79, 98304
  v_add_u32 v139, s79, v139
  s_add_u32 s90, s88, 4096
  s_waitcnt vmcnt(2)
  v_lshlrev_b32 v32, 16, v16
  v_and_b32 v33, 0xffff0000, v16
  v_lshlrev_b32 v34, 16, v17
  v_and_b32 v35, 0xffff0000, v17
  v_lshlrev_b32 v36, 16, v18
  v_and_b32 v37, 0xffff0000, v18
  v_lshlrev_b32 v38, 16, v19
  v_and_b32 v39, 0xffff0000, v19
  v_lshlrev_b32 v40, 16, v20
  v_and_b32 v41, 0xffff0000, v20
  v_lshlrev_b32 v42, 16, v21
  v_and_b32 v43, 0xffff0000, v21
  v_lshlrev_b32 v44, 16, v22
  v_and_b32 v45, 0xffff0000, v22
  v_lshlrev_b32 v46, 16, v23
  v_and_b32 v47, 0xffff0000, v23
  v_lshlrev_b32 v48, 16, v24
  v_and_b32 v49, 0xffff0000, v24
  v_lshlrev_b32 v50, 16, v25
  v_and_b32 v51, 0xffff0000, v25
  v_lshlrev_b32 v52, 16, v26
  v_and_b32 v53, 0xffff0000, v26
  v_lshlrev_b32 v54, 16, v27
  v_and_b32 v55, 0xffff0000, v27
  v_lshlrev_b32 v56, 16, v28
  v_and_b32 v57, 0xffff0000, v28
  v_lshlrev_b32 v58, 16, v29
  v_and_b32 v59, 0xffff0000, v29
  v_lshlrev_b32 v60, 16, v30
  v_and_b32 v61, 0xffff0000, v30
  v_lshlrev_b32 v62, 16, v31
  v_and_b32 v63, 0xffff0000, v31
  s_add_u32 m0, s94, 0
  s_nop 0
  buffer_load_dwordx4 v2, s[8:11], s50 offen lds
  buffer_load_dwordx4 v2, s[8:11], s50 offen offset:2048 lds
  s_add_u32 m0, s94, 1024
  s_nop 0
  buffer_load_dwordx4 v3, s[8:11], s50 offen lds
  buffer_load_dwordx4 v3, s[8:11], s50 offen offset:2048 lds
  v_add_f32 v64, v32, v33
  v_add_f32 v65, v34, v35
  v_add_f32 v66, v36, v37
  v_add_f32 v67, v38, v39
  v_add_f32 v68, v40, v41
  v_add_f32 v69, v42, v43
  v_add_f32 v70, v44, v45
  v_add_f32 v71, v46, v47
  v_add_f32 v72, v48, v49
  v_add_f32 v73, v50, v51
  v_add_f32 v74, v52, v53
  v_add_f32 v75, v54, v55
  v_add_f32 v76, v56, v57
  v_add_f32 v77, v58, v59
  v_add_f32 v78, v60, v61
  v_add_f32 v79, v62, v63
  v_add_f32 v64, v64, v65
  v_add_f32 v65, v66, v67
  v_add_f32 v66, v68, v69
  v_add_f32 v67, v70, v71
  v_add_f32 v68, v72, v73
  v_add_f32 v69, v74, v75
  v_add_f32 v70, v76, v77
  v_add_f32 v71, v78, v79
  v_add_f32 v64, v64, v65
  v_add_f32 v65, v66, v67
  v_add_f32 v66, v68, v69
  v_add_f32 v67, v70, v71
  v_add_f32 v64, v64, v65
  v_add_f32 v65, v66, v67
  v_add_f32 v100, v64, v65
  s_nop 1
  v_add_f32_dpp v101, v100, v100 quad_perm:[1,0,3,2] row_mask:0xf bank_mask:0xf
  s_nop 1
  v_add_f32_dpp v100, v101, v101 quad_perm:[2,3,0,1] row_mask:0xf bank_mask:0xf
  s_nop 1
  v_add_f32_dpp v101, v100, v100 row_half_mirror row_mask:0xf bank_mask:0xf
  v_mul_f32 v102, 0x3b800000, v101
  v_sub_f32 v64, v32, v102
  v_sub_f32 v65, v33, v102
  v_sub_f32 v66, v34, v102
  v_sub_f32 v67, v35, v102
  v_sub_f32 v68, v36, v102
  v_sub_f32 v69, v37, v102
  v_sub_f32 v70, v38, v102
  v_sub_f32 v71, v39, v102
  v_sub_f32 v72, v40, v102
  v_sub_f32 v73, v41, v102
  v_sub_f32 v74, v42, v102
  v_sub_f32 v75, v43, v102
  v_sub_f32 v76, v44, v102
  v_sub_f32 v77, v45, v102
  v_sub_f32 v78, v46, v102
  v_sub_f32 v79, v47, v102
  v_sub_f32 v80, v48, v102
  v_sub_f32 v81, v49, v102
  v_sub_f32 v82, v50, v102
  v_sub_f32 v83, v51, v102
  v_sub_f32 v84, v52, v102
  v_sub_f32 v85, v53, v102
  v_sub_f32 v86, v54, v102
  v_sub_f32 v87, v55, v102
  v_sub_f32 v88, v56, v102
  v_sub_f32 v89, v57, v102
  v_sub_f32 v90, v58, v102
  v_sub_f32 v91, v59, v102
  v_sub_f32 v92, v60, v102
  v_sub_f32 v93, v61, v102
  v_sub_f32 v94, v62, v102
  v_sub_f32 v95, v63, v102
  v_mul_f32 v104, v64, v64
  v_mul_f32 v105, v65, v65
  v_mul_f32 v106, v66, v66
  v_mul_f32 v107, v67, v67
  v_fmac_f32 v104, v68, v68
  v_fmac_f32 v105, v69, v69
  v_fmac_f32 v106, v70, v70
  v_fmac_f32 v107, v71, v71
  v_fmac_f32 v104, v72, v72
  v_fmac_f32 v105, v73, v73
  v_fmac_f32 v106, v74, v74
  v_fmac_f32 v107, v75, v75
  v_fmac_f32 v104, v76, v76
  v_fmac_f32 v105, v77, v77
  v_fmac_f32 v106, v78, v78
  v_fmac_f32 v107, v79, v79
  v_fmac_f32 v104, v80, v80
  v_fmac_f32 v105, v81, v81
  v_fmac_f32 v106, v82, v82
  v_fmac_f32 v107, v83, v83
  v_fmac_f32 v104, v84, v84
  v_fmac_f32 v105, v85, v85
  v_fmac_f32 v106, v86, v86
  v_fmac_f32 v107, v87, v87
  v_fmac_f32 v104, v88, v88
  v_fmac_f32 v105, v89, v89
  v_fmac_f32 v106, v90, v90
  v_fmac_f32 v107, v91, v91
  v_fmac_f32 v104, v92, v92
  v_fmac_f32 v105, v93, v93
  v_fmac_f32 v106, v94, v94
  v_fmac_f32 v107, v95, v95
  v_add_f32 v108, v104, v105
  v_add_f32 v109, v106, v107
  v_add_f32 v100, v108, v109
  s_nop 1
  v_add_f32_dpp v101, v100, v100 quad_perm:[1,0,3,2] row_mask:0xf bank_mask:0xf
  s_nop 1
  v_add_f32_dpp v100, v101, v101 quad_perm:[2,3,0,1] row_mask:0xf bank_mask:0xf
  s_nop 1
  v_add_f32_dpp v101, v100, v100 row_half_mirror row_mask:0xf bank_mask:0xf
  v_mov_b32 v103, v101
  s_lshl_b32 s79, s30, 3
  v_add_u32 v10, s79, v137
  s_mov_b32 exec_lo, 0x01010101
  s_mov_b32 exec_hi, 0x01010101
  ds_write_b64 v10, v[102:103]
  s_mov_b64 exec, -1
  s_waitcnt vmcnt(4)
  v_add_u32 v15, 16, v15
  s_waitcnt lgkmcnt(0)
  s_barrier
  v_readfirstlane_b32 s31, v15
  ds_read_b128 v[104:107], v137
  ds_read_b128 v[108:111], v137 offset:16
  s_waitcnt lgkmcnt(0)
  v_add_f32 v100, v104, v106
  v_add_f32 v101, v108, v110
  v_add_f32 v102, v105, v107
  v_add_f32 v103, v109, v111
  v_add_f32 v100, v100, v101
  v_add_f32 v102, v102, v103
  v_mul_f32 v100, 0.25, v100
  v_sub_f32 v104, v104, v100
  v_sub_f32 v106, v106, v100
  v_sub_f32 v108, v108, v100
  v_sub_f32 v110, v110, v100
  v_mul_f32 v101, v104, v104
  v_mul_f32 v103, v106, v106
  v_fmac_f32 v101, v108, v108
  v_fmac_f32 v103, v110, v110
  v_add_f32 v101, v101, v103
  v_fmac_f32 v102, 0x43800000, v101
  v_mov_b32 v101, 0x3727c5ac
  v_fmac_f32 v101, 0x3a800000, v102
  v_rsq_f32 v101, v101
  s_nop 0
  v_mul_f32 v100, v100, v101
  v_fma_f32 v32, v32, v101, -v100
  v_fma_f32 v33, v33, v101, -v100
  v_fma_f32 v34, v34, v101, -v100
  v_fma_f32 v35, v35, v101, -v100
  v_fma_f32 v36, v36, v101, -v100
  v_fma_f32 v37, v37, v101, -v100
  v_fma_f32 v38, v38, v101, -v100
  v_fma_f32 v39, v39, v101, -v100
  v_fma_f32 v40, v40, v101, -v100
  v_fma_f32 v41, v41, v101, -v100
  v_fma_f32 v42, v42, v101, -v100
  v_fma_f32 v43, v43, v101, -v100
  v_fma_f32 v44, v44, v101, -v100
  v_fma_f32 v45, v45, v101, -v100
  v_fma_f32 v46, v46, v101, -v100
  v_fma_f32 v47, v47, v101, -v100
  v_fma_f32 v48, v48, v101, -v100
  v_fma_f32 v49, v49, v101, -v100
  v_fma_f32 v50, v50, v101, -v100
  v_fma_f32 v51, v51, v101, -v100
  v_fma_f32 v52, v52, v101, -v100
  v_fma_f32 v53, v53, v101, -v100
  v_fma_f32 v54, v54, v101, -v100
  v_fma_f32 v55, v55, v101, -v100
  v_fma_f32 v56, v56, v101, -v100
  v_fma_f32 v57, v57, v101, -v100
  v_fma_f32 v58, v58, v101, -v100
  v_fma_f32 v59, v59, v101, -v100
  v_fma_f32 v60, v60, v101, -v100
  v_fma_f32 v61, v61, v101, -v100
  v_fma_f32 v62, v62, v101, -v100
  v_fma_f32 v63, v63, v101, -v100
  v_cvt_pk_bf16_f32 v64, v32, v33
  v_cvt_pk_bf16_f32 v65, v34, v35
  v_cvt_pk_bf16_f32 v66, v36, v37
  v_cvt_pk_bf16_f32 v67, v38, v39
  v_cvt_pk_bf16_f32 v68, v40, v41
  v_cvt_pk_bf16_f32 v69, v42, v43
  v_cvt_pk_bf16_f32 v70, v44, v45
  v_cvt_pk_bf16_f32 v71, v46, v47
  v_cvt_pk_bf16_f32 v72, v48, v49
  v_cvt_pk_bf16_f32 v73, v50, v51
  v_cvt_pk_bf16_f32 v74, v52, v53
  v_cvt_pk_bf16_f32 v75, v54, v55
  v_cvt_pk_bf16_f32 v76, v56, v57
  v_cvt_pk_bf16_f32 v77, v58, v59
  v_cvt_pk_bf16_f32 v78, v60, v61
  v_cvt_pk_bf16_f32 v79, v62, v63
  buffer_store_dwordx4 v[64:67], v138, s[4:7], s88 offen sc1
  buffer_store_dwordx4 v[68:71], v138, s[4:7], s88 offen offset:2048 sc1
  buffer_store_dwordx4 v[72:75], v138, s[4:7], s90 offen sc1
  buffer_store_dwordx4 v[76:79], v138, s[4:7], s90 offen offset:2048 sc1
  ds_write_b128 v139, v[16:19] offset:0
  ds_write_b128 v139, v[20:23] offset:128
  ds_write_b128 v139, v[24:27] offset:256
  ds_write_b128 v139, v[28:31] offset:384
  s_add_u32 m0, s94, 16384
  s_nop 0
  buffer_load_dwordx4 v2, s[8:11], s51 offen lds
  buffer_load_dwordx4 v2, s[8:11], s51 offen offset:2048 lds
  s_add_u32 m0, s94, 17408
  s_nop 0
  buffer_load_dwordx4 v3, s[8:11], s51 offen lds
  buffer_load_dwordx4 v3, s[8:11], s51 offen offset:2048 lds
  s_add_u32 m0, s94, 32768
  s_nop 0
  buffer_load_dwordx4 v2, s[8:11], s52 offen lds
  buffer_load_dwordx4 v2, s[8:11], s52 offen offset:2048 lds
  s_add_u32 m0, s94, 33792
  s_nop 0
  buffer_load_dwordx4 v3, s[8:11], s52 offen lds
  buffer_load_dwordx4 v3, s[8:11], s52 offen offset:2048 lds
  s_add_u32 m0, s94, 49152
  s_nop 0
  buffer_load_dwordx4 v2, s[8:11], s53 offen lds
  buffer_load_dwordx4 v2, s[8:11], s53 offen offset:2048 lds
  s_add_u32 m0, s94, 50176
  s_nop 0
  buffer_load_dwordx4 v3, s[8:11], s53 offen lds
  buffer_load_dwordx4 v3, s[8:11], s53 offen offset:2048 lds
  s_lshl_b32 s80, s28, 2
  s_lshr_b32 s78, s29, 2
  s_add_u32 s80, s80, s78
  s_lshl_b32 s80, s80, 7
  s_and_b32 s78, s29, 3
  s_lshl_b32 s78, s78, 2
  s_add_u32 s78, s78, s30
  s_lshl_b32 s78, s78, 2
  s_add_u32 s80, s80, s78
  s_add_u32 s80, s80, 4096
  s_waitcnt vmcnt(12)
  v_mov_b32 v10, s31
  v_mov_b32 v11, 0
  s_mov_b64 exec, 1
  buffer_store_dword v10, v11, s[4:7], s80 offen sc1
  s_mov_b64 exec, -1
  s_lshr_b32 s79, s2, 3
  s_lshl_b32 s79, s79, 5
  s_bfe_u32 s80, s2, 0x20001
  s_lshl_b32 s80, s80, 2
  s_add_u32 s79, s79, s80
  s_and_b32 s80, s30, 1
  s_lshl_b32 s80, s80, 1
  s_add_u32 s79, s79, s80
  s_lshr_b32 s80, s30, 1
  s_lshl_b32 s80, s80, 4
  s_add_u32 s79, s79, s80
  s_lshl_b32 s79, s79, 11
  s_add_u32 s80, s79, 2048
  s_lshl_b32 s81, s30, 12
  s_add_u32 m0, s81, 147456
  v_lshrrev_b32 v13, 3, v0
  v_xor_b32 v13, v13, v0
  v_and_b32 v13, 7, v13
  v_and_b32 v12, 56, v0
  v_or_b32 v13, v13, v12
  v_lshlrev_b32 v13, 4, v13
  buffer_load_dwordx4 v13, s[16:19], s79 offen lds
  buffer_load_dwordx4 v13, s[16:19], s79 offen offset:1024 lds
  s_add_u32 m0, s81, 149504
  s_nop 0
  buffer_load_dwordx4 v13, s[16:19], s80 offen lds
  buffer_load_dwordx4 v13, s[16:19], s80 offen offset:1024 lds
  s_and_b32 s79, s2, 7
  s_lshl_b32 s79, s79, 3
  s_lshr_b32 s80, s2, 5
  s_add_u32 s79, s79, s80
  s_bfe_u32 s80, s2, 0x10004
  s_bfe_u32 s81, s2, 0x10003
  s_cmp_eq_u32 s79, 0
  s_cselect_b32 s82, 64, s79
  s_cmp_eq_u32 s80, 0
  s_cselect_b32 s68, s79, s82
  s_cselect_b32 s69, 0, 1
  s_cmp_eq_u32 s79, 0
  s_cselect_b32 s69, 0, s69
  s_sub_u32 s82, 128, s68
  s_cmp_eq_u32 s69, 0
  s_cselect_b32 s82, s68, s82
  s_and_b32 s66, s82, 15
  s_lshr_b32 s82, s82, 4
  s_lshl_b32 s82, s82, 1
  s_add_u32 s67, s82, s81
  s_cmp_ge_u32 s30, 2
  s_cbranch_scc1 L_ftab_2
  s_lshl_b32 s80, s28, 1
  s_add_u32 s80, s80, s30
  s_lshr_b32 s81, s80, 2
  s_and_b32 s82, s80, 3
  s_lshr_b32 s83, s81, 1
  s_and_b32 s83, s83, 1
  s_lshl_b32 s83, s83, 5
  s_and_b32 s84, s81, 1
  s_lshl_b32 s84, s84, 2
  s_add_u32 s83, s83, s84
  s_lshr_b32 s84, s81, 2
  s_lshr_b32 s85, s82, 1
  s_sub_u32 s86, s84, s85
  s_lshl_b32 s86, s86, 8
  s_and_b32 s86, s86, 1023
  s_and_b32 s87, s82, 1
  s_lshl_b32 s87, s87, 5
  s_add_u32 s87, s87, s29
  v_bfe_u32 v103, v0, 2, 2
  v_lshlrev_b32 v103, 3, v103
  v_and_b32 v104, 3, v0
  v_add_u32 v103, v103, v104
  v_add_u32 v101, s83, v103
  v_lshrrev_b32 v103, 4, v0
  v_lshlrev_b32 v103, 8, v103
  v_add_u32 v100, s87, v103
  v_mov_b32 v102, s86
  s_mov_b32 s79, 0x3a800000
  v_add_u32 v108, 0, v100
  v_mad_u32_u24 v108, v108, v101, v102
  v_and_b32 v108, 1023, v108
  v_cvt_f32_u32 v108, v108
  v_mul_f32 v108, s79, v108
  v_add_u32 v109, 64, v100
  v_mad_u32_u24 v109, v109, v101, v102
  v_and_b32 v109, 1023, v109
  v_cvt_f32_u32 v109, v109
  v_mul_f32 v109, s79, v109
  v_add_u32 v110, 128, v100
  v_mad_u32_u24 v110, v110, v101, v102
  v_and_b32 v110, 1023, v110
  v_cvt_f32_u32 v110, v110
  v_mul_f32 v110, s79, v110
  v_add_u32 v111, 192, v100
  v_mad_u32_u24 v111, v111, v101, v102
  v_and_b32 v111, 1023, v111
  v_cvt_f32_u32 v111, v111
  v_mul_f32 v111, s79, v111
  v_add_u32 v112, 16, v100
  v_mad_u32_u24 v112, v112, v101, v102
  v_and_b32 v112, 1023, v112
  v_cvt_f32_u32 v112, v112
  v_mul_f32 v112, s79, v112
  v_add_u32 v113, 80, v100
  v_mad_u32_u24 v113, v113, v101, v102
  v_and_b32 v113, 1023, v113
  v_cvt_f32_u32 v113, v113
  v_mul_f32 v113, s79, v113
  v_add_u32 v114, 144, v100
  v_mad_u32_u24 v114, v114, v101, v102
  v_and_b32 v114, 1023, v114
  v_cvt_f32_u32 v114, v114
  v_mul_f32 v114, s79, v114
  v_add_u32 v115, 208, v100
  v_mad_u32_u24 v115, v115, v101, v102
  v_and_b32 v115, 1023, v115
  v_cvt_f32_u32 v115, v115
  v_mul_f32 v115, s79, v115
  v_cos_f32 v108, v108
  v_cos_f32 v109, v109
  v_cos_f32 v110, v110
  v_cos_f32 v111, v111
  v_cos_f32 v112, v112
  v_cos_f32 v113, v113
  v_cos_f32 v114, v114
  v_cos_f32 v115, v115
  v_cvt_pk_bf16_f32 v104, v108, v109
  v_cvt_pk_bf16_f32 v105, v110, v111
  v_cvt_pk_bf16_f32 v106, v112, v113
  v_cvt_pk_bf16_f32 v107, v114, v115
  s_lshl_b32 s81, s29, 15
  s_lshl_b32 s80, s80, 10
  s_add_u32 s80, s80, s81
  s_add_u32 s80, s80, 524288
  buffer_store_dwordx4 v[104:107], v1, s[4:7], s80 offen sc1
  s_branch L_tabdone_4
L_ftab_2:
  s_cmp_eq_u32 s30, 3
  s_cbranch_scc1 L_ctab_3
  s_cmp_ge_u32 s2, 32
  s_cbranch_scc1 L_tabdone_4
  s_lshr_b32 s80, s2, 3
  s_lshl_b32 s80, s80, 4
  s_bfe_u32 s81, s2, 0x10002
  s_and_b32 s82, s2, 3
  s_lshl_b32 s82, s82, 1
  v_and_b32 v103, 15, v0
  v_add_u32 v103, s80, v103
  s_lshl_b32 s83, s81, 6
  s_lshl_b32 s84, s81, 5
  v_cmp_eq_u32 vcc, 0, v103
  v_mov_b32 v104, s83
  s_nop 0
  v_cndmask_b32 v101, v103, v104, vcc
  v_mov_b32 v104, s84
  v_cndmask_b32 v102, v104, 0, vcc
  v_lshrrev_b32 v103, 5, v0
  v_bfe_u32 v104, v0, 4, 1
  v_lshlrev_b32 v104, 6, v104
  v_add_u32 v103, v103, v104
  v_add_u32 v100, s82, v103
  s_mov_b32 s79, 0x3c000000
  v_add_u32 v108, 0, v100
  v_mad_u32_u24 v108, v108, v101, v102
  v_and_b32 v108, 127, v108
  v_cvt_f32_u32 v108, v108
  v_mul_f32 v108, s79, v108
  v_add_u32 v109, 8, v100
  v_mad_u32_u24 v109, v109, v101, v102
  v_and_b32 v109, 127, v109
  v_cvt_f32_u32 v109, v109
  v_mul_f32 v109, s79, v109
  v_add_u32 v110, 16, v100
  v_mad_u32_u24 v110, v110, v101, v102
  v_and_b32 v110, 127, v110
  v_cvt_f32_u32 v110, v110
  v_mul_f32 v110, s79, v110
  v_add_u32 v111, 24, v100
  v_mad_u32_u24 v111, v111, v101, v102
  v_and_b32 v111, 127, v111
  v_cvt_f32_u32 v111, v111
  v_mul_f32 v111, s79, v111
  v_add_u32 v112, 32, v100
  v_mad_u32_u24 v112, v112, v101, v102
  v_and_b32 v112, 127, v112
  v_cvt_f32_u32 v112, v112
  v_mul_f32 v112, s79, v112
  v_add_u32 v113, 40, v100
  v_mad_u32_u24 v113, v113, v101, v102
  v_and_b32 v113, 127, v113
  v_cvt_f32_u32 v113, v113
  v_mul_f32 v113, s79, v113
  v_add_u32 v114, 48, v100
  v_mad_u32_u24 v114, v114, v101, v102
  v_and_b32 v114, 127, v114
  v_cvt_f32_u32 v114, v114
  v_mul_f32 v114, s79, v114
  v_add_u32 v115, 56, v100
  v_mad_u32_u24 v115, v115, v101, v102
  v_and_b32 v115, 127, v115
  v_cvt_f32_u32 v115, v115
  v_mul_f32 v115, s79, v115
  v_cos_f32 v108, v108
  v_cos_f32 v109, v109
  v_cos_f32 v110, v110
  v_cos_f32 v111, v111
  v_cos_f32 v112, v112
  v_cos_f32 v113, v113
  v_cos_f32 v114, v114
  v_cos_f32 v115, v115
  v_cvt_pk_bf16_f32 v104, v108, v109
  v_cvt_pk_bf16_f32 v105, v110, v111
  v_cvt_pk_bf16_f32 v106, v112, v113
  v_cvt_pk_bf16_f32 v107, v114, v115
  s_lshl_b32 s80, s2, 10
  s_add_u32 s80, s80, 131072
  buffer_store_dwordx4 v[104:107], v1, s[4:7], s80 offen sc1
  s_branch L_tabdone_4
L_ctab_3:
  s_cmp_ge_u32 s2, 32
  s_cbranch_scc1 L_tabdone_4
  s_bfe_u32 s80, s2, 0x20002
  s_lshl_b32 s80, s80, 2
  s_and_b32 s81, s2, 3
  s_lshl_b32 s81, s81, 2
  v_and_b32 v103, 3, v0
  v_add_u32 v101, s80, v103
  v_sub_u32 v104, 15, v101
  s_cmp_ge_u32 s2, 16
  s_cselect_b64 vcc, -1, 0
  v_cndmask_b32 v101, v101, v104, vcc
  v_mov_b32 v100, s81
  v_mov_b32 v102, 0
  v_lshrrev_b32 v103, 4, v0
  v_bfe_u32 v104, v0, 2, 2
  v_cmp_eq_u32 s[82:83], v103, v104
  s_mov_b32 s79, 0x3d800000
  v_add_u32 v108, 0, v100
  v_mad_u32_u24 v108, v108, v101, v102
  v_and_b32 v108, 15, v108
  v_cvt_f32_u32 v108, v108
  v_mul_f32 v108, s79, v108
  v_add_u32 v109, 0, v100
  v_mad_u32_u24 v109, v109, v101, v102
  v_add_u32 v109, 12, v109
  v_and_b32 v109, 15, v109
  v_cvt_f32_u32 v109, v109
  v_mul_f32 v109, s79, v109
  v_add_u32 v110, 1, v100
  v_mad_u32_u24 v110, v110, v101, v102
  v_and_b32 v110, 15, v110
  v_cvt_f32_u32 v110, v110
  v_mul_f32 v110, s79, v110
  v_add_u32 v111, 1, v100
  v_mad_u32_u24 v111, v111, v101, v102
  v_add_u32 v111, 12, v111
  v_and_b32 v111, 15, v111
  v_cvt_f32_u32 v111, v111
  v_mul_f32 v111, s79, v111
  v_add_u32 v112, 2, v100
  v_mad_u32_u24 v112, v112, v101, v102
  v_and_b32 v112, 15, v112
  v_cvt_f32_u32 v112, v112
  v_mul_f32 v112, s79, v112
  v_add_u32 v113, 2, v100
  v_mad_u32_u24 v113, v113, v101, v102
  v_add_u32 v113, 12, v113
  v_and_b32 v113, 15, v113
  v_cvt_f32_u32 v113, v113
  v_mul_f32 v113, s79, v113
  v_add_u32 v114, 3, v100
  v_mad_u32_u24 v114, v114, v101, v102
  v_and_b32 v114, 15, v114
  v_cvt_f32_u32 v114, v114
  v_mul_f32 v114, s79, v114
  v_add_u32 v115, 3, v100
  v_mad_u32_u24 v115, v115, v101, v102
  v_add_u32 v115, 12, v115
  v_and_b32 v115, 15, v115
  v_cvt_f32_u32 v115, v115
  v_mul_f32 v115, s79, v115
  v_cos_f32 v108, v108
  v_cos_f32 v109, v109
  v_cos_f32 v110, v110
  v_cos_f32 v111, v111
  v_cos_f32 v112, v112
  v_cos_f32 v113, v113
  v_cos_f32 v114, v114
  v_cos_f32 v115, v115
  v_cndmask_b32 v108, 0, v108, s[82:83]
  v_cndmask_b32 v109, 0, v109, s[82:83]
  v_cndmask_b32 v110, 0, v110, s[82:83]
  v_cndmask_b32 v111, 0, v111, s[82:83]
  v_cndmask_b32 v112, 0, v112, s[82:83]
  v_cndmask_b32 v113, 0, v113, s[82:83]
  v_cndmask_b32 v114, 0, v114, s[82:83]
  v_cndmask_b32 v115, 0, v115, s[82:83]
  v_cvt_pk_bf16_f32 v104, v108, v109
  v_cvt_pk_bf16_f32 v105, v110, v111
  v_cvt_pk_bf16_f32 v106, v112, v113
  v_cvt_pk_bf16_f32 v107, v114, v115
  s_lshl_b32 s80, s2, 10
  s_add_u32 s80, s80, 163840
  buffer_store_dwordx4 v[104:107], v1, s[4:7], s80 offen sc1
L_tabdone_4:
  v_and_b32 v135, 15, v0
  s_lshl_b32 s79, s30, 4
  v_add_u32 v135, s79, v135
  v_and_b32 v10, 15, v135
  v_lshrrev_b32 v11, 4, v135
  v_lshlrev_b32 v133, 1, v11
  v_and_b32 v132, 7, v10
  v_xor_b32 v132, v133, v132
  v_lshl_add_u32 v132, v10, 3, v132
  v_lshlrev_b32 v132, 4, v132
  v_lshrrev_b32 v131, 4, v0
  v_lshl_add_u32 v128, v131, 11, v132
  v_mov_b32 v136, v128
  v_add_u32 v128, 115200, v128
  v_xor_b32 v129, 16, v128
  v_lshlrev_b32 v10, 11, v10
  v_lshl_add_u32 v10, v131, 4, v10
  v_lshrrev_b32 v133, 1, v11
  v_lshl_add_u32 v10, v133, 10, v10
  v_and_b32 v11, 1, v11
  v_lshl_add_u32 v133, v11, 9, v10
  v_lshlrev_b32 v131, 5, v131
  v_add_u32 v131, 131584, v131
  s_lshl_b32 s79, s30, 3
  v_add_u32 v130, s79, v131
  s_add_u32 s79, s94, 115200
  v_add_u32 v132, s79, v1
  v_lshrrev_b32 v11, 3, v0
  v_xor_b32 v11, v11, v0
  v_and_b32 v11, 7, v11
  v_and_b32 v10, 56, v0
  v_or_b32 v11, v11, v10
  v_lshlrev_b32 v134, 4, v11
  s_lshl_b32 s88, s28, 3
  s_lshr_b32 s80, s29, 1
  s_add_u32 s88, s88, s80
  s_lshl_b32 s88, s88, 15
  s_and_b32 s80, s29, 1
  s_lshl_b32 s80, s80, 7
  s_add_u32 s88, s88, s80
  s_add_u32 s88, s88, 8388608
  s_lshl_b32 s89, s28, 7
  s_lshl_b32 s80, s29, 3
  s_add_u32 s89, s89, s80
  s_lshl_b32 s80, s30, 1
  s_add_u32 s89, s89, s80
  s_lshl_b32 s89, s89, 11
  s_add_u32 s89, s89, 16777216
  v_lshrrev_b32 v140, 4, v0
  v_mul_u32_u24 v140, 2080, v140
  v_lshl_add_u32 v140, v135, 1, v140
  v_add_u32 v140, 98304, v140
  s_waitcnt lgkmcnt(0)
  s_barrier
  ds_read_u16 v16, v140 offset:0
  ds_read_u16_d16_hi v32, v140 offset:128
  ds_read_u16 v17, v140 offset:256
  ds_read_u16_d16_hi v33, v140 offset:384
  ds_read_u16 v18, v140 offset:512
  ds_read_u16_d16_hi v34, v140 offset:640
  ds_read_u16 v19, v140 offset:768
  ds_read_u16_d16_hi v35, v140 offset:896
  ds_read_u16 v20, v140 offset:1024
  ds_read_u16_d16_hi v36, v140 offset:1152
  ds_read_u16 v21, v140 offset:1280
  ds_read_u16_d16_hi v37, v140 offset:1408
  ds_read_u16 v22, v140 offset:1536
  ds_read_u16_d16_hi v38, v140 offset:1664
  ds_read_u16 v23, v140 offset:1792
  s_waitcnt lgkmcnt(12)
  ds_read_u16_d16_hi v39, v140 offset:1920
  ds_read_u16 v24, v140 offset:8320
  ds_read_u16_d16_hi v40, v140 offset:8448
  s_waitcnt lgkmcnt(12)
  ds_read_u16 v25, v140 offset:8576
  ds_read_u16_d16_hi v41, v140 offset:8704
  ds_read_u16 v26, v140 offset:8832
  s_waitcnt lgkmcnt(12)
  ds_read_u16_d16_hi v42, v140 offset:8960
  ds_read_u16 v27, v140 offset:9088
  ds_read_u16_d16_hi v43, v140 offset:9216
  s_waitcnt lgkmcnt(12)
  ds_read_u16 v28, v140 offset:9344
  ds_read_u16_d16_hi v44, v140 offset:9472
  ds_read_u16 v29, v140 offset:9600
  s_waitcnt lgkmcnt(12)
  ds_read_u16_d16_hi v45, v140 offset:9728
  ds_read_u16 v30, v140 offset:9856
  ds_read_u16_d16_hi v46, v140 offset:9984
  s_waitcnt lgkmcnt(12)
  ds_read_u16 v31, v140 offset:10112
  ds_read_u16_d16_hi v47, v140 offset:10240
  s_waitcnt lgkmcnt(0)
  v_or_b32 v96, v16, v32
  v_or_b32 v97, v17, v33
  v_or_b32 v98, v18, v34
  v_or_b32 v99, v19, v35
  v_or_b32 v100, v20, v36
  v_or_b32 v101, v21, v37
  v_or_b32 v102, v22, v38
  v_or_b32 v103, v23, v39
  v_or_b32 v104, v24, v40
  v_or_b32 v105, v25, v41
  v_or_b32 v106, v26, v42
  v_or_b32 v107, v27, v43
  v_or_b32 v108, v28, v44
  v_or_b32 v109, v29, v45
  v_or_b32 v110, v30, v46
  v_or_b32 v111, v31, v47
  ds_write_b128 v128, v[96:99] offset:0
  ds_write_b128 v129, v[100:103] offset:0
  ds_write_b128 v128, v[104:107] offset:8192
  ds_write_b128 v129, v[108:111] offset:8192
  s_waitcnt lgkmcnt(0)
  s_barrier
  ds_read_b128 v[96:99], v132 offset:0
  ds_read_b128 v[100:103], v132 offset:1024
  ds_read_b128 v[104:107], v132 offset:2048
  ds_read_b128 v[108:111], v132 offset:3072
  s_waitcnt lgkmcnt(0)
  s_barrier
L_LAYER:
  s_add_u32 m0, s94, 65536
  s_nop 0
  buffer_load_dwordx4 v2, s[8:11], s54 offen lds
  buffer_load_dwordx4 v2, s[8:11], s54 offen offset:2048 lds
  s_add_u32 m0, s94, 66560
  s_nop 0
  buffer_load_dwordx4 v3, s[8:11], s54 offen lds
  buffer_load_dwordx4 v3, s[8:11], s54 offen offset:2048 lds
  s_add_u32 m0, s94, 81920
  s_nop 0
  buffer_load_dwordx4 v2, s[8:11], s55 offen lds
  buffer_load_dwordx4 v2, s[8:11], s55 offen offset:2048 lds
  s_add_u32 m0, s94, 82944
  s_nop 0
  buffer_load_dwordx4 v3, s[8:11], s55 offen lds
  buffer_load_dwordx4 v3, s[8:11], s55 offen offset:2048 lds
  s_add_u32 m0, s94, 98304
  s_nop 0
  buffer_load_dwordx4 v2, s[8:11], s56 offen lds
  buffer_load_dwordx4 v2, s[8:11], s56 offen offset:2048 lds
  s_add_u32 m0, s94, 99328
  s_nop 0
  buffer_load_dwordx4 v3, s[8:11], s56 offen lds
  buffer_load_dwordx4 v3, s[8:11], s56 offen offset:2048 lds
  s_add_u32 m0, s94, 114688
  s_nop 0
  buffer_load_dwordx4 v2, s[8:11], s57 offen lds
  buffer_load_dwordx4 v2, s[8:11], s57 offen offset:2048 lds
  s_add_u32 m0, s94, 115712
  s_nop 0
  buffer_load_dwordx4 v3, s[8:11], s57 offen lds
  buffer_load_dwordx4 v3, s[8:11], s57 offen offset:2048 lds
  s_mul_i32 s80, s32, 8192
  s_lshl_b32 s79, s28, 2
  s_add_u32 s79, s79, s30
  s_lshl_b32 s81, s79, 7
  s_add_u32 s80, s80, s81
  s_add_u32 s80, s80, 4096
  s_lshl_b32 s79, s79, 16
  s_lshl_b32 s81, s32, 22
  s_add_u32 s79, s79, s81
  s_add_u32 s79, s79, 8388608
  v_add_u32 v252, s79, v1
  v_add_u32 v253, 0x8000, v252
  v_mov_b32 v144, v6
  v_mov_b32 v145, v7
  v_mov_b32 v146, v8
  v_mov_b32 v147, v9
  v_and_b32 v10, 15, v0
  v_lshlrev_b32 v10, 2, v10
  s_mov_b32 s95, 131072
  buffer_load_dword v44, v10, s[4:7], s80 offen sc1
L_poll_5:
  s_waitcnt vmcnt(0)
  v_cmp_ne_u32 vcc, s31, v44
  s_cbranch_vccz L_poll_5_done
  buffer_load_dword v44, v10, s[4:7], s80 offen sc1
  s_sub_u32 s95, s95, 1
  s_cmp_lg_u32 s95, 0
  s_cbranch_scc1 L_poll_5
L_poll_5_done:
  buffer_load_dwordx4 a[0:3], v252, s[4:7], s34 offen sc1
  buffer_load_dwordx4 a[4:7], v252, s[4:7], s34 offen offset:1024 sc1
  buffer_load_dwordx4 a[8:11], v253, s[4:7], s34 offen sc1
  buffer_load_dwordx4 a[12:15], v253, s[4:7], s34 offen offset:1024 sc1
  buffer_load_dwordx4 a[16:19], v252, s[4:7], s35 offen sc1
  buffer_load_dwordx4 a[20:23], v252, s[4:7], s35 offen offset:1024 sc1
  buffer_load_dwordx4 a[24:27], v253, s[4:7], s35 offen sc1
  buffer_load_dwordx4 a[28:31], v253, s[4:7], s35 offen offset:1024 sc1
  buffer_store_dwordx4 v[96:99], v134, s[4:7], s89 offen offset:0 sc1
  buffer_store_dwordx4 v[100:103], v134, s[4:7], s89 offen offset:1024 sc1
  buffer_store_dwordx4 v[104:107], v134, s[4:7], s89 offen offset:2048 sc1
  buffer_store_dwordx4 v[108:111], v134, s[4:7], s89 offen offset:3072 sc1
  s_add_u32 m0, s94, 131072
  s_nop 0
  buffer_load_dwordx4 v2, s[8:11], s58 offen lds
  buffer_load_dwordx4 v2, s[8:11], s58 offen offset:2048 lds
  s_add_u32 m0, s94, 132096
  s_nop 0
  buffer_load_dwordx4 v3, s[8:11], s58 offen lds
  buffer_load_dwordx4 v3, s[8:11], s58 offen offset:2048 lds
  s_lshl_b32 s76, s29, 17
  s_lshl_b32 s75, s30, 15
  s_add_u32 s76, s76, s75
  s_add_u32 s76, s76, 6291456
  s_barrier
  s_cmp_lg_u32 s32, 0
  s_cbranch_scc1 L_wog_6
  v_bfe_u32 v10, v0, 2, 2
  v_lshlrev_b32 v10, 1, v10
  s_and_b32 s79, s2, 1
  v_add_u32 v10, s79, v10
  v_lshrrev_b32 v12, 4, v0
  v_lshlrev_b32 v12, 2, v12
  v_and_b32 v13, 3, v0
  v_add_u32 v12, v12, v13
  v_and_b32 v13, 7, v12
  v_xor_b32 v10, v10, v13
  v_lshlrev_b32 v10, 4, v10
  v_lshl_add_u32 v11, v12, 7, v10
  s_lshl_b32 s80, s30, 1
  s_add_u32 s80, s80, 147456
  v_add_u32 v11, s80, v11
  s_lshl_b32 s79, s79, 3
  s_add_u32 s79, s79, s30
  v_lshrrev_b32 v12, 4, v0
  v_lshlrev_b32 v12, 15, v12
  v_and_b32 v13, 15, v0
  v_lshl_add_u32 v12, v13, 4, v12
  s_lshl_b32 s79, s79, 17
  s_lshr_b32 s80, s2, 3
  s_lshl_b32 s80, s80, 10
  s_add_u32 s79, s79, s80
  s_bfe_u32 s80, s2, 0x20001
  s_lshl_b32 s80, s80, 8
  s_add_u32 s79, s79, s80
  s_add_u32 s79, s79, 6291456
  s_add_u32 s80, s79, 524288
  ds_read_u16 v16, v11 offset:0
  ds_read_u16_d16_hi v24, v11 offset:2048
  ds_read_u16 v17, v11 offset:4096
  ds_read_u16_d16_hi v25, v11 offset:6144
  ds_read_u16 v18, v11 offset:8192
  ds_read_u16_d16_hi v26, v11 offset:10240
  ds_read_u16 v19, v11 offset:12288
  ds_read_u16_d16_hi v27, v11 offset:14336
  s_waitcnt lgkmcnt(0)
  ds_read_u16 v20, v11 offset:8
  ds_read_u16_d16_hi v28, v11 offset:2056
  ds_read_u16 v21, v11 offset:4104
  ds_read_u16_d16_hi v29, v11 offset:6152
  ds_read_u16 v22, v11 offset:8200
  ds_read_u16_d16_hi v30, v11 offset:10248
  ds_read_u16 v23, v11 offset:12296
  ds_read_u16_d16_hi v31, v11 offset:14344
  s_waitcnt lgkmcnt(0)
  v_or_b32 v16, v16, v24
  v_or_b32 v17, v17, v25
  v_or_b32 v18, v18, v26
  v_or_b32 v19, v19, v27
  v_or_b32 v20, v20, v28
  v_or_b32 v21, v21, v29
  v_or_b32 v22, v22, v30
  v_or_b32 v23, v23, v31
  buffer_store_dwordx4 v[16:19], v12, s[4:7], s79 offen sc1
  buffer_store_dwordx4 v[20:23], v12, s[4:7], s80 offen sc1
L_wog_6:
  ds_read_b64_tr_b16 v[112:113], v144 offset:0
  ds_read_b64_tr_b16 v[114:115], v144 offset:512
  ds_read_b64_tr_b16 v[116:117], v144 offset:8192
  ds_read_b64_tr_b16 v[118:119], v144 offset:8704
  ds_read_b64_tr_b16 v[120:121], v145 offset:0
  ds_read_b64_tr_b16 v[122:123], v145 offset:512
  ds_read_b64_tr_b16 v[124:125], v145 offset:8192
  ds_read_b64_tr_b16 v[126:127], v145 offset:8704
  ds_read_b64_tr_b16 v[128:129], v146 offset:0
  ds_read_b64_tr_b16 v[130:131], v146 offset:512
  ds_read_b64_tr_b16 v[132:133], v146 offset:8192
  ds_read_b64_tr_b16 v[134:135], v146 offset:8704
  s_waitcnt vmcnt(12)
  s_waitcnt lgkmcnt(8)
  v_mfma_f32_16x16x32_bf16 v[16:19], a[0:3], v[112:115], 0
  ds_read_b64_tr_b16 v[136:137], v147 offset:0
  v_mfma_f32_16x16x32_bf16 v[16:19], a[4:7], v[116:119], v[16:19]
  ds_read_b64_tr_b16 v[138:139], v147 offset:512
  buffer_load_dwordx4 a[32:35], v252, s[4:7], s36 offen sc1
  v_mfma_f32_16x16x32_bf16 v[20:23], a[8:11], v[112:115], 0
  ds_read_b64_tr_b16 v[140:141], v147 offset:8192
  v_add_u32 v148, 16384, v6
  v_mfma_f32_16x16x32_bf16 v[20:23], a[12:15], v[116:119], v[20:23]
  ds_read_b64_tr_b16 v[142:143], v147 offset:8704
  s_waitcnt lgkmcnt(8)
  v_mfma_f32_16x16x32_bf16 v[24:27], a[0:3], v[120:123], 0
  ds_read_b64_tr_b16 v[112:113], v144 offset:2048
  v_mfma_f32_16x16x32_bf16 v[24:27], a[4:7], v[124:127], v[24:27]
  ds_read_b64_tr_b16 v[114:115], v144 offset:2560
  buffer_load_dwordx4 a[36:39], v252, s[4:7], s36 offen offset:1024 sc1
  v_mfma_f32_16x16x32_bf16 v[28:31], a[8:11], v[120:123], 0
  ds_read_b64_tr_b16 v[116:117], v144 offset:10240
  v_add_u32 v149, 16384, v7
  v_mfma_f32_16x16x32_bf16 v[28:31], a[12:15], v[124:127], v[28:31]
  ds_read_b64_tr_b16 v[118:119], v144 offset:10752
  s_waitcnt lgkmcnt(8)
  v_mfma_f32_16x16x32_bf16 v[32:35], a[0:3], v[128:131], 0
  ds_read_b64_tr_b16 v[120:121], v145 offset:2048
  v_mfma_f32_16x16x32_bf16 v[32:35], a[4:7], v[132:135], v[32:35]
  ds_read_b64_tr_b16 v[122:123], v145 offset:2560
  buffer_load_dwordx4 a[40:43], v253, s[4:7], s36 offen sc1
  v_mfma_f32_16x16x32_bf16 v[36:39], a[8:11], v[128:131], 0
  ds_read_b64_tr_b16 v[124:125], v145 offset:10240
  v_add_u32 v150, 16384, v8
  v_mfma_f32_16x16x32_bf16 v[36:39], a[12:15], v[132:135], v[36:39]
  ds_read_b64_tr_b16 v[126:127], v145 offset:10752
  s_waitcnt lgkmcnt(8)
  v_mfma_f32_16x16x32_bf16 v[40:43], a[0:3], v[136:139], 0
  ds_read_b64_tr_b16 v[128:129], v146 offset:2048
  v_mfma_f32_16x16x32_bf16 v[40:43], a[4:7], v[140:143], v[40:43]
  ds_read_b64_tr_b16 v[130:131], v146 offset:2560
  v_mfma_f32_16x16x32_bf16 v[44:47], a[8:11], v[136:139], 0
  ds_read_b64_tr_b16 v[132:133], v146 offset:10240
  v_add_u32 v151, 16384, v9
  v_mfma_f32_16x16x32_bf16 v[44:47], a[12:15], v[140:143], v[44:47]
  ds_read_b64_tr_b16 v[134:135], v146 offset:10752
  s_waitcnt lgkmcnt(8)
  v_mfma_f32_16x16x32_bf16 v[48:51], a[0:3], v[112:115], 0
  ds_read_b64_tr_b16 v[136:137], v147 offset:2048
  v_mfma_f32_16x16x32_bf16 v[48:51], a[4:7], v[116:119], v[48:51]
  ds_read_b64_tr_b16 v[138:139], v147 offset:2560
  buffer_load_dwordx4 a[44:47], v253, s[4:7], s36 offen offset:1024 sc1
  v_mfma_f32_16x16x32_bf16 v[52:55], a[8:11], v[112:115], 0
  ds_read_b64_tr_b16 v[140:141], v147 offset:10240
  v_mfma_f32_16x16x32_bf16 v[52:55], a[12:15], v[116:119], v[52:55]
  ds_read_b64_tr_b16 v[142:143], v147 offset:10752
  s_waitcnt lgkmcnt(8)
  v_mfma_f32_16x16x32_bf16 v[56:59], a[0:3], v[120:123], 0
  s_barrier
  ds_read_b64_tr_b16 v[112:113], v148 offset:0
  v_mfma_f32_16x16x32_bf16 v[56:59], a[4:7], v[124:127], v[56:59]
  ds_read_b64_tr_b16 v[114:115], v148 offset:512
  buffer_load_dwordx4 a[48:51], v252, s[4:7], s37 offen sc1
  v_mfma_f32_16x16x32_bf16 v[60:63], a[8:11], v[120:123], 0
  ds_read_b64_tr_b16 v[116:117], v148 offset:8192
  v_mfma_f32_16x16x32_bf16 v[60:63], a[12:15], v[124:127], v[60:63]
  ds_read_b64_tr_b16 v[118:119], v148 offset:8704
  s_waitcnt lgkmcnt(8)
  v_mfma_f32_16x16x32_bf16 v[64:67], a[0:3], v[128:131], 0
  ds_read_b64_tr_b16 v[120:121], v149 offset:0
  v_mfma_f32_16x16x32_bf16 v[64:67], a[4:7], v[132:135], v[64:67]
  ds_read_b64_tr_b16 v[122:123], v149 offset:512
  buffer_load_dwordx4 a[52:55], v252, s[4:7], s37 offen offset:1024 sc1
  v_mfma_f32_16x16x32_bf16 v[68:71], a[8:11], v[128:131], 0
  ds_read_b64_tr_b16 v[124:125], v149 offset:8192
  v_mfma_f32_16x16x32_bf16 v[68:71], a[12:15], v[132:135], v[68:71]
  ds_read_b64_tr_b16 v[126:127], v149 offset:8704
  s_waitcnt lgkmcnt(8)
  v_mfma_f32_16x16x32_bf16 v[72:75], a[0:3], v[136:139], 0
  ds_read_b64_tr_b16 v[128:129], v150 offset:0
  v_mfma_f32_16x16x32_bf16 v[72:75], a[4:7], v[140:143], v[72:75]
  ds_read_b64_tr_b16 v[130:131], v150 offset:512
  v_mfma_f32_16x16x32_bf16 v[76:79], a[8:11], v[136:139], 0
  ds_read_b64_tr_b16 v[132:133], v150 offset:8192
  v_mfma_f32_16x16x32_bf16 v[76:79], a[12:15], v[140:143], v[76:79]
  ds_read_b64_tr_b16 v[134:135], v150 offset:8704
  s_waitcnt vmcnt(14)
  s_waitcnt lgkmcnt(8)
  v_mfma_f32_16x16x32_bf16 v[16:19], a[16:19], v[112:115], v[16:19]
  ds_read_b64_tr_b16 v[136:137], v151 offset:0
  v_mfma_f32_16x16x32_bf16 v[16:19], a[20:23], v[116:119], v[16:19]
  ds_read_b64_tr_b16 v[138:139], v151 offset:512
  buffer_load_dwordx4 a[56:59], v253, s[4:7], s37 offen sc1
  v_mfma_f32_16x16x32_bf16 v[20:23], a[24:27], v[112:115], v[20:23]
  ds_read_b64_tr_b16 v[140:141], v151 offset:8192
  v_add_u32 v144, 32768, v6
  v_mfma_f32_16x16x32_bf16 v[20:23], a[28:31], v[116:119], v[20:23]
  ds_read_b64_tr_b16 v[142:143], v151 offset:8704
  s_waitcnt lgkmcnt(8)
  v_mfma_f32_16x16x32_bf16 v[24:27], a[16:19], v[120:123], v[24:27]
  ds_read_b64_tr_b16 v[112:113], v148 offset:2048
  v_mfma_f32_16x16x32_bf16 v[24:27], a[20:23], v[124:127], v[24:27]
  ds_read_b64_tr_b16 v[114:115], v148 offset:2560
  buffer_load_dwordx4 a[60:63], v253, s[4:7], s37 offen offset:1024 sc1
  v_mfma_f32_16x16x32_bf16 v[28:31], a[24:27], v[120:123], v[28:31]
  ds_read_b64_tr_b16 v[116:117], v148 offset:10240
  v_add_u32 v145, 32768, v7
  v_mfma_f32_16x16x32_bf16 v[28:31], a[28:31], v[124:127], v[28:31]
  ds_read_b64_tr_b16 v[118:119], v148 offset:10752
  s_waitcnt lgkmcnt(8)
  v_mfma_f32_16x16x32_bf16 v[32:35], a[16:19], v[128:131], v[32:35]
  ds_read_b64_tr_b16 v[120:121], v149 offset:2048
  v_mfma_f32_16x16x32_bf16 v[32:35], a[20:23], v[132:135], v[32:35]
  ds_read_b64_tr_b16 v[122:123], v149 offset:2560
  buffer_load_dwordx4 a[64:67], v252, s[4:7], s38 offen sc1
  v_mfma_f32_16x16x32_bf16 v[36:39], a[24:27], v[128:131], v[36:39]
  ds_read_b64_tr_b16 v[124:125], v149 offset:10240
  v_add_u32 v146, 32768, v8
  v_mfma_f32_16x16x32_bf16 v[36:39], a[28:31], v[132:135], v[36:39]
  ds_read_b64_tr_b16 v[126:127], v149 offset:10752
  s_waitcnt lgkmcnt(8)
  v_mfma_f32_16x16x32_bf16 v[40:43], a[16:19], v[136:139], v[40:43]
  ds_read_b64_tr_b16 v[128:129], v150 offset:2048
  v_mfma_f32_16x16x32_bf16 v[40:43], a[20:23], v[140:143], v[40:43]
  ds_read_b64_tr_b16 v[130:131], v150 offset:2560
  v_mfma_f32_16x16x32_bf16 v[44:47], a[24:27], v[136:139], v[44:47]
  ds_read_b64_tr_b16 v[132:133], v150 offset:10240
  v_add_u32 v147, 32768, v9
  v_mfma_f32_16x16x32_bf16 v[44:47], a[28:31], v[140:143], v[44:47]
  ds_read_b64_tr_b16 v[134:135], v150 offset:10752
  s_waitcnt lgkmcnt(8)
  v_mfma_f32_16x16x32_bf16 v[48:51], a[16:19], v[112:115], v[48:51]
  ds_read_b64_tr_b16 v[136:137], v151 offset:2048
  v_mfma_f32_16x16x32_bf16 v[48:51], a[20:23], v[116:119], v[48:51]
  ds_read_b64_tr_b16 v[138:139], v151 offset:2560
  buffer_load_dwordx4 a[68:71], v252, s[4:7], s38 offen offset:1024 sc1
  v_mfma_f32_16x16x32_bf16 v[52:55], a[24:27], v[112:115], v[52:55]
  ds_read_b64_tr_b16 v[140:141], v151 offset:10240
  v_mfma_f32_16x16x32_bf16 v[52:55], a[28:31], v[116:119], v[52:55]
  ds_read_b64_tr_b16 v[142:143], v151 offset:10752
  s_waitcnt lgkmcnt(8)
  v_mfma_f32_16x16x32_bf16 v[56:59], a[16:19], v[120:123], v[56:59]
  s_barrier
  ds_read_b64_tr_b16 v[112:113], v144 offset:0
  v_mfma_f32_16x16x32_bf16 v[56:59], a[20:23], v[124:127], v[56:59]
  ds_read_b64_tr_b16 v[114:115], v144 offset:512
  buffer_load_dwordx4 a[72:75], v253, s[4:7], s38 offen sc1
  v_mfma_f32_16x16x32_bf16 v[60:63], a[24:27], v[120:123], v[60:63]
  ds_read_b64_tr_b16 v[116:117], v144 offset:8192
  v_mfma_f32_16x16x32_bf16 v[60:63], a[28:31], v[124:127], v[60:63]
  ds_read_b64_tr_b16 v[118:119], v144 offset:8704
  s_waitcnt lgkmcnt(8)
  v_mfma_f32_16x16x32_bf16 v[64:67], a[16:19], v[128:131], v[64:67]
  ds_read_b64_tr_b16 v[120:121], v145 offset:0
  v_mfma_f32_16x16x32_bf16 v[64:67], a[20:23], v[132:135], v[64:67]
  ds_read_b64_tr_b16 v[122:123], v145 offset:512
  buffer_load_dwordx4 a[76:79], v253, s[4:7], s38 offen offset:1024 sc1
  v_mfma_f32_16x16x32_bf16 v[68:71], a[24:27], v[128:131], v[68:71]
  ds_read_b64_tr_b16 v[124:125], v145 offset:8192
  v_mfma_f32_16x16x32_bf16 v[68:71], a[28:31], v[132:135], v[68:71]
  ds_read_b64_tr_b16 v[126:127], v145 offset:8704
  s_waitcnt lgkmcnt(8)
  v_mfma_f32_16x16x32_bf16 v[72:75], a[16:19], v[136:139], v[72:75]
  ds_read_b64_tr_b16 v[128:129], v146 offset:0
  v_mfma_f32_16x16x32_bf16 v[72:75], a[20:23], v[140:143], v[72:75]
  ds_read_b64_tr_b16 v[130:131], v146 offset:512
  v_mfma_f32_16x16x32_bf16 v[76:79], a[24:27], v[136:139], v[76:79]
  ds_read_b64_tr_b16 v[132:133], v146 offset:8192
  v_mfma_f32_16x16x32_bf16 v[76:79], a[28:31], v[140:143], v[76:79]
  ds_read_b64_tr_b16 v[134:135], v146 offset:8704
  s_waitcnt vmcnt(8)
  s_waitcnt lgkmcnt(8)
  v_mfma_f32_16x16x32_bf16 v[16:19], a[32:35], v[112:115], v[16:19]
  ds_read_b64_tr_b16 v[136:137], v147 offset:0
  v_mfma_f32_16x16x32_bf16 v[16:19], a[36:39], v[116:119], v[16:19]
  ds_read_b64_tr_b16 v[138:139], v147 offset:512
  buffer_load_dwordx4 a[80:83], v252, s[4:7], s39 offen sc1
  v_mfma_f32_16x16x32_bf16 v[20:23], a[40:43], v[112:115], v[20:23]
  ds_read_b64_tr_b16 v[140:141], v147 offset:8192
  v_add_u32 v148, 49152, v6
  v_mfma_f32_16x16x32_bf16 v[20:23], a[44:47], v[116:119], v[20:23]
  ds_read_b64_tr_b16 v[142:143], v147 offset:8704
  s_waitcnt lgkmcnt(8)
  v_mfma_f32_16x16x32_bf16 v[24:27], a[32:35], v[120:123], v[24:27]
  ds_read_b64_tr_b16 v[112:113], v144 offset:2048
  v_mfma_f32_16x16x32_bf16 v[24:27], a[36:39], v[124:127], v[24:27]
  ds_read_b64_tr_b16 v[114:115], v144 offset:2560
  buffer_load_dwordx4 a[84:87], v252, s[4:7], s39 offen offset:1024 sc1
  v_mfma_f32_16x16x32_bf16 v[28:31], a[40:43], v[120:123], v[28:31]
  ds_read_b64_tr_b16 v[116:117], v144 offset:10240
  v_add_u32 v149, 49152, v7
  v_mfma_f32_16x16x32_bf16 v[28:31], a[44:47], v[124:127], v[28:31]
  ds_read_b64_tr_b16 v[118:119], v144 offset:10752
  s_waitcnt lgkmcnt(8)
  v_mfma_f32_16x16x32_bf16 v[32:35], a[32:35], v[128:131], v[32:35]
  ds_read_b64_tr_b16 v[120:121], v145 offset:2048
  v_mfma_f32_16x16x32_bf16 v[32:35], a[36:39], v[132:135], v[32:35]
  ds_read_b64_tr_b16 v[122:123], v145 offset:2560
  buffer_load_dwordx4 a[88:91], v253, s[4:7], s39 offen sc1
  v_mfma_f32_16x16x32_bf16 v[36:39], a[40:43], v[128:131], v[36:39]
  ds_read_b64_tr_b16 v[124:125], v145 offset:10240
  v_add_u32 v150, 49152, v8
  v_mfma_f32_16x16x32_bf16 v[36:39], a[44:47], v[132:135], v[36:39]
  ds_read_b64_tr_b16 v[126:127], v145 offset:10752
  s_waitcnt lgkmcnt(8)
  v_mfma_f32_16x16x32_bf16 v[40:43], a[32:35], v[136:139], v[40:43]
  ds_read_b64_tr_b16 v[128:129], v146 offset:2048
  v_mfma_f32_16x16x32_bf16 v[40:43], a[36:39], v[140:143], v[40:43]
  ds_read_b64_tr_b16 v[130:131], v146 offset:2560
  v_mfma_f32_16x16x32_bf16 v[44:47], a[40:43], v[136:139], v[44:47]
  ds_read_b64_tr_b16 v[132:133], v146 offset:10240
  v_add_u32 v151, 49152, v9
  v_mfma_f32_16x16x32_bf16 v[44:47], a[44:47], v[140:143], v[44:47]
  ds_read_b64_tr_b16 v[134:135], v146 offset:10752
  s_waitcnt lgkmcnt(8)
  v_mfma_f32_16x16x32_bf16 v[48:51], a[32:35], v[112:115], v[48:51]
  ds_read_b64_tr_b16 v[136:137], v147 offset:2048
  v_mfma_f32_16x16x32_bf16 v[48:51], a[36:39], v[116:119], v[48:51]
  ds_read_b64_tr_b16 v[138:139], v147 offset:2560
  buffer_load_dwordx4 a[92:95], v253, s[4:7], s39 offen offset:1024 sc1
  v_mfma_f32_16x16x32_bf16 v[52:55], a[40:43], v[112:115], v[52:55]
  ds_read_b64_tr_b16 v[140:141], v147 offset:10240
  v_mfma_f32_16x16x32_bf16 v[52:55], a[44:47], v[116:119], v[52:55]
  ds_read_b64_tr_b16 v[142:143], v147 offset:10752
  s_waitcnt lgkmcnt(8)
  v_mfma_f32_16x16x32_bf16 v[56:59], a[32:35], v[120:123], v[56:59]
  s_barrier
  ds_read_b64_tr_b16 v[112:113], v148 offset:0
  v_mfma_f32_16x16x32_bf16 v[56:59], a[36:39], v[124:127], v[56:59]
  ds_read_b64_tr_b16 v[114:115], v148 offset:512
  buffer_load_dwordx4 a[96:99], v252, s[4:7], s40 offen sc1
  v_mfma_f32_16x16x32_bf16 v[60:63], a[40:43], v[120:123], v[60:63]
  ds_read_b64_tr_b16 v[116:117], v148 offset:8192
  v_mfma_f32_16x16x32_bf16 v[60:63], a[44:47], v[124:127], v[60:63]
  ds_read_b64_tr_b16 v[118:119], v148 offset:8704
  s_waitcnt lgkmcnt(8)
  v_mfma_f32_16x16x32_bf16 v[64:67], a[32:35], v[128:131], v[64:67]
  ds_read_b64_tr_b16 v[120:121], v149 offset:0
  v_mfma_f32_16x16x32_bf16 v[64:67], a[36:39], v[132:135], v[64:67]
  ds_read_b64_tr_b16 v[122:123], v149 offset:512
  buffer_load_dwordx4 a[100:103], v252, s[4:7], s40 offen offset:1024 sc1
  v_mfma_f32_16x16x32_bf16 v[68:71], a[40:43], v[128:131], v[68:71]
  ds_read_b64_tr_b16 v[124:125], v149 offset:8192
  v_mfma_f32_16x16x32_bf16 v[68:71], a[44:47], v[132:135], v[68:71]
  ds_read_b64_tr_b16 v[126:127], v149 offset:8704
  s_waitcnt lgkmcnt(8)
  v_mfma_f32_16x16x32_bf16 v[72:75], a[32:35], v[136:139], v[72:75]
  ds_read_b64_tr_b16 v[128:129], v150 offset:0
  v_mfma_f32_16x16x32_bf16 v[72:75], a[36:39], v[140:143], v[72:75]
  ds_read_b64_tr_b16 v[130:131], v150 offset:512
  v_mfma_f32_16x16x32_bf16 v[76:79], a[40:43], v[136:139], v[76:79]
  ds_read_b64_tr_b16 v[132:133], v150 offset:8192
  v_mfma_f32_16x16x32_bf16 v[76:79], a[44:47], v[140:143], v[76:79]
  ds_read_b64_tr_b16 v[134:135], v150 offset:8704
  s_cmp_lg_u32 s30, 0
  s_cbranch_scc1 L_p0f_7
  s_lshl_b32 s79, s2, 2
  s_add_u32 s79, s79, 61440
  v_mov_b32 v10, s31
  v_mov_b32 v11, 0
  s_mov_b64 exec, 1
  buffer_store_dword v10, v11, s[4:7], s79 offen sc1
  s_mov_b64 exec, -1
L_p0f_7:
  s_waitcnt vmcnt(10)
  s_waitcnt lgkmcnt(8)
  v_mfma_f32_16x16x32_bf16 v[16:19], a[48:51], v[112:115], v[16:19]
  ds_read_b64_tr_b16 v[136:137], v151 offset:0
  v_mfma_f32_16x16x32_bf16 v[16:19], a[52:55], v[116:119], v[16:19]
  ds_read_b64_tr_b16 v[138:139], v151 offset:512
  buffer_load_dwordx4 a[104:107], v253, s[4:7], s40 offen sc1
  v_mfma_f32_16x16x32_bf16 v[20:23], a[56:59], v[112:115], v[20:23]
  ds_read_b64_tr_b16 v[140:141], v151 offset:8192
  v_add_u32 v144, 65536, v6
  v_mfma_f32_16x16x32_bf16 v[20:23], a[60:63], v[116:119], v[20:23]
  ds_read_b64_tr_b16 v[142:143], v151 offset:8704
  s_waitcnt lgkmcnt(8)
  v_mfma_f32_16x16x32_bf16 v[24:27], a[48:51], v[120:123], v[24:27]
  ds_read_b64_tr_b16 v[112:113], v148 offset:2048
  v_mfma_f32_16x16x32_bf16 v[24:27], a[52:55], v[124:127], v[24:27]
  ds_read_b64_tr_b16 v[114:115], v148 offset:2560
  buffer_load_dwordx4 a[108:111], v253, s[4:7], s40 offen offset:1024 sc1
  v_mfma_f32_16x16x32_bf16 v[28:31], a[56:59], v[120:123], v[28:31]
  ds_read_b64_tr_b16 v[116:117], v148 offset:10240
  v_add_u32 v145, 65536, v7
  v_mfma_f32_16x16x32_bf16 v[28:31], a[60:63], v[124:127], v[28:31]
  ds_read_b64_tr_b16 v[118:119], v148 offset:10752
  s_waitcnt lgkmcnt(8)
  v_mfma_f32_16x16x32_bf16 v[32:35], a[48:51], v[128:131], v[32:35]
  ds_read_b64_tr_b16 v[120:121], v149 offset:2048
  v_mfma_f32_16x16x32_bf16 v[32:35], a[52:55], v[132:135], v[32:35]
  ds_read_b64_tr_b16 v[122:123], v149 offset:2560
  buffer_load_dwordx4 a[112:115], v252, s[4:7], s41 offen sc1
  v_mfma_f32_16x16x32_bf16 v[36:39], a[56:59], v[128:131], v[36:39]
  ds_read_b64_tr_b16 v[124:125], v149 offset:10240
  v_add_u32 v146, 65536, v8
  v_mfma_f32_16x16x32_bf16 v[36:39], a[60:63], v[132:135], v[36:39]
  ds_read_b64_tr_b16 v[126:127], v149 offset:10752
  s_waitcnt lgkmcnt(8)
  v_mfma_f32_16x16x32_bf16 v[40:43], a[48:51], v[136:139], v[40:43]
  ds_read_b64_tr_b16 v[128:129], v150 offset:2048
  v_mfma_f32_16x16x32_bf16 v[40:43], a[52:55], v[140:143], v[40:43]
  ds_read_b64_tr_b16 v[130:131], v150 offset:2560
  v_mfma_f32_16x16x32_bf16 v[44:47], a[56:59], v[136:139], v[44:47]
  ds_read_b64_tr_b16 v[132:133], v150 offset:10240
  v_add_u32 v147, 65536, v9
  v_mfma_f32_16x16x32_bf16 v[44:47], a[60:63], v[140:143], v[44:47]
  ds_read_b64_tr_b16 v[134:135], v150 offset:10752
  s_waitcnt lgkmcnt(8)
  v_mfma_f32_16x16x32_bf16 v[48:51], a[48:51], v[112:115], v[48:51]
  ds_read_b64_tr_b16 v[136:137], v151 offset:2048
  v_mfma_f32_16x16x32_bf16 v[48:51], a[52:55], v[116:119], v[48:51]
  ds_read_b64_tr_b16 v[138:139], v151 offset:2560
  buffer_load_dwordx4 a[116:119], v252, s[4:7], s41 offen offset:1024 sc1
  v_mfma_f32_16x16x32_bf16 v[52:55], a[56:59], v[112:115], v[52:55]
  ds_read_b64_tr_b16 v[140:141], v151 offset:10240
  v_mfma_f32_16x16x32_bf16 v[52:55], a[60:63], v[116:119], v[52:55]
  ds_read_b64_tr_b16 v[142:143], v151 offset:10752
  s_waitcnt lgkmcnt(8)
  v_mfma_f32_16x16x32_bf16 v[56:59], a[48:51], v[120:123], v[56:59]
  s_barrier
  ds_read_b64_tr_b16 v[112:113], v144 offset:0
  v_mfma_f32_16x16x32_bf16 v[56:59], a[52:55], v[124:127], v[56:59]
  ds_read_b64_tr_b16 v[114:115], v144 offset:512
  buffer_load_dwordx4 a[120:123], v253, s[4:7], s41 offen sc1
  v_mfma_f32_16x16x32_bf16 v[60:63], a[56:59], v[120:123], v[60:63]
  ds_read_b64_tr_b16 v[116:117], v144 offset:8192
  v_mfma_f32_16x16x32_bf16 v[60:63], a[60:63], v[124:127], v[60:63]
  ds_read_b64_tr_b16 v[118:119], v144 offset:8704
  s_waitcnt lgkmcnt(8)
  v_mfma_f32_16x16x32_bf16 v[64:67], a[48:51], v[128:131], v[64:67]
  ds_read_b64_tr_b16 v[120:121], v145 offset:0
  v_mfma_f32_16x16x32_bf16 v[64:67], a[52:55], v[132:135], v[64:67]
  ds_read_b64_tr_b16 v[122:123], v145 offset:512
  buffer_load_dwordx4 a[124:127], v253, s[4:7], s41 offen offset:1024 sc1
  v_mfma_f32_16x16x32_bf16 v[68:71], a[56:59], v[128:131], v[68:71]
  ds_read_b64_tr_b16 v[124:125], v145 offset:8192
  v_mfma_f32_16x16x32_bf16 v[68:71], a[60:63], v[132:135], v[68:71]
  ds_read_b64_tr_b16 v[126:127], v145 offset:8704
  s_waitcnt lgkmcnt(8)
  v_mfma_f32_16x16x32_bf16 v[72:75], a[48:51], v[136:139], v[72:75]
  ds_read_b64_tr_b16 v[128:129], v146 offset:0
  v_mfma_f32_16x16x32_bf16 v[72:75], a[52:55], v[140:143], v[72:75]
  ds_read_b64_tr_b16 v[130:131], v146 offset:512
  v_mfma_f32_16x16x32_bf16 v[76:79], a[56:59], v[136:139], v[76:79]
  ds_read_b64_tr_b16 v[132:133], v146 offset:8192
  v_mfma_f32_16x16x32_bf16 v[76:79], a[60:63], v[140:143], v[76:79]
  ds_read_b64_tr_b16 v[134:135], v146 offset:8704
  s_waitcnt vmcnt(12)
  s_waitcnt lgkmcnt(8)
  v_mfma_f32_16x16x32_bf16 v[16:19], a[64:67], v[112:115], v[16:19]
  ds_read_b64_tr_b16 v[136:137], v147 offset:0
  v_mfma_f32_16x16x32_bf16 v[16:19], a[68:71], v[116:119], v[16:19]
  ds_read_b64_tr_b16 v[138:139], v147 offset:512
  buffer_load_dwordx4 a[128:131], v252, s[4:7], s42 offen sc1
  v_mfma_f32_16x16x32_bf16 v[20:23], a[72:75], v[112:115], v[20:23]
  ds_read_b64_tr_b16 v[140:141], v147 offset:8192
  v_add_u32 v148, 81920, v6
  v_mfma_f32_16x16x32_bf16 v[20:23], a[76:79], v[116:119], v[20:23]
  ds_read_b64_tr_b16 v[142:143], v147 offset:8704
  s_waitcnt lgkmcnt(8)
  v_mfma_f32_16x16x32_bf16 v[24:27], a[64:67], v[120:123], v[24:27]
  ds_read_b64_tr_b16 v[112:113], v144 offset:2048
  v_mfma_f32_16x16x32_bf16 v[24:27], a[68:71], v[124:127], v[24:27]
  ds_read_b64_tr_b16 v[114:115], v144 offset:2560
  buffer_load_dwordx4 a[132:135], v252, s[4:7], s42 offen offset:1024 sc1
  v_mfma_f32_16x16x32_bf16 v[28:31], a[72:75], v[120:123], v[28:31]
  ds_read_b64_tr_b16 v[116:117], v144 offset:10240
  v_add_u32 v149, 81920, v7
  v_mfma_f32_16x16x32_bf16 v[28:31], a[76:79], v[124:127], v[28:31]
  ds_read_b64_tr_b16 v[118:119], v144 offset:10752
  s_waitcnt lgkmcnt(8)
  v_mfma_f32_16x16x32_bf16 v[32:35], a[64:67], v[128:131], v[32:35]
  ds_read_b64_tr_b16 v[120:121], v145 offset:2048
  v_mfma_f32_16x16x32_bf16 v[32:35], a[68:71], v[132:135], v[32:35]
  ds_read_b64_tr_b16 v[122:123], v145 offset:2560
  buffer_load_dwordx4 a[136:139], v253, s[4:7], s42 offen sc1
  v_mfma_f32_16x16x32_bf16 v[36:39], a[72:75], v[128:131], v[36:39]
  ds_read_b64_tr_b16 v[124:125], v145 offset:10240
  v_add_u32 v150, 81920, v8
  v_mfma_f32_16x16x32_bf16 v[36:39], a[76:79], v[132:135], v[36:39]
  ds_read_b64_tr_b16 v[126:127], v145 offset:10752
  s_waitcnt lgkmcnt(8)
  v_mfma_f32_16x16x32_bf16 v[40:43], a[64:67], v[136:139], v[40:43]
  ds_read_b64_tr_b16 v[128:129], v146 offset:2048
  v_mfma_f32_16x16x32_bf16 v[40:43], a[68:71], v[140:143], v[40:43]
  ds_read_b64_tr_b16 v[130:131], v146 offset:2560
  v_mfma_f32_16x16x32_bf16 v[44:47], a[72:75], v[136:139], v[44:47]
  ds_read_b64_tr_b16 v[132:133], v146 offset:10240
  v_add_u32 v151, 81920, v9
  v_mfma_f32_16x16x32_bf16 v[44:47], a[76:79], v[140:143], v[44:47]
  ds_read_b64_tr_b16 v[134:135], v146 offset:10752
  s_waitcnt lgkmcnt(8)
  v_mfma_f32_16x16x32_bf16 v[48:51], a[64:67], v[112:115], v[48:51]
  ds_read_b64_tr_b16 v[136:137], v147 offset:2048
  v_mfma_f32_16x16x32_bf16 v[48:51], a[68:71], v[116:119], v[48:51]
  ds_read_b64_tr_b16 v[138:139], v147 offset:2560
  buffer_load_dwordx4 a[140:143], v253, s[4:7], s42 offen offset:1024 sc1
  v_mfma_f32_16x16x32_bf16 v[52:55], a[72:75], v[112:115], v[52:55]
  ds_read_b64_tr_b16 v[140:141], v147 offset:10240
  v_mfma_f32_16x16x32_bf16 v[52:55], a[76:79], v[116:119], v[52:55]
  ds_read_b64_tr_b16 v[142:143], v147 offset:10752
  s_waitcnt lgkmcnt(8)
  v_mfma_f32_16x16x32_bf16 v[56:59], a[64:67], v[120:123], v[56:59]
  s_barrier
  ds_read_b64_tr_b16 v[112:113], v148 offset:0
  v_mfma_f32_16x16x32_bf16 v[56:59], a[68:71], v[124:127], v[56:59]
  ds_read_b64_tr_b16 v[114:115], v148 offset:512
  buffer_load_dwordx4 a[144:147], v252, s[4:7], s43 offen sc1
  v_mfma_f32_16x16x32_bf16 v[60:63], a[72:75], v[120:123], v[60:63]
  ds_read_b64_tr_b16 v[116:117], v148 offset:8192
  v_mfma_f32_16x16x32_bf16 v[60:63], a[76:79], v[124:127], v[60:63]
  ds_read_b64_tr_b16 v[118:119], v148 offset:8704
  s_waitcnt lgkmcnt(8)
  v_mfma_f32_16x16x32_bf16 v[64:67], a[64:67], v[128:131], v[64:67]
  ds_read_b64_tr_b16 v[120:121], v149 offset:0
  v_mfma_f32_16x16x32_bf16 v[64:67], a[68:71], v[132:135], v[64:67]
  ds_read_b64_tr_b16 v[122:123], v149 offset:512
  buffer_load_dwordx4 a[148:151], v252, s[4:7], s43 offen offset:1024 sc1
  v_mfma_f32_16x16x32_bf16 v[68:71], a[72:75], v[128:131], v[68:71]
  ds_read_b64_tr_b16 v[124:125], v149 offset:8192
  v_mfma_f32_16x16x32_bf16 v[68:71], a[76:79], v[132:135], v[68:71]
  ds_read_b64_tr_b16 v[126:127], v149 offset:8704
  s_waitcnt lgkmcnt(8)
  v_mfma_f32_16x16x32_bf16 v[72:75], a[64:67], v[136:139], v[72:75]
  ds_read_b64_tr_b16 v[128:129], v150 offset:0
  v_mfma_f32_16x16x32_bf16 v[72:75], a[68:71], v[140:143], v[72:75]
  ds_read_b64_tr_b16 v[130:131], v150 offset:512
  v_mfma_f32_16x16x32_bf16 v[76:79], a[72:75], v[136:139], v[76:79]
  ds_read_b64_tr_b16 v[132:133], v150 offset:8192
  v_mfma_f32_16x16x32_bf16 v[76:79], a[76:79], v[140:143], v[76:79]
  ds_read_b64_tr_b16 v[134:135], v150 offset:8704
  s_waitcnt vmcnt(14)
  s_waitcnt lgkmcnt(8)
  v_mfma_f32_16x16x32_bf16 v[16:19], a[80:83], v[112:115], v[16:19]
  ds_read_b64_tr_b16 v[136:137], v151 offset:0
  v_mfma_f32_16x16x32_bf16 v[16:19], a[84:87], v[116:119], v[16:19]
  ds_read_b64_tr_b16 v[138:139], v151 offset:512
  buffer_load_dwordx4 a[152:155], v253, s[4:7], s43 offen sc1
  v_mfma_f32_16x16x32_bf16 v[20:23], a[88:91], v[112:115], v[20:23]
  ds_read_b64_tr_b16 v[140:141], v151 offset:8192
  v_add_u32 v144, 98304, v6
  v_mfma_f32_16x16x32_bf16 v[20:23], a[92:95], v[116:119], v[20:23]
  ds_read_b64_tr_b16 v[142:143], v151 offset:8704
  s_waitcnt lgkmcnt(8)
  v_mfma_f32_16x16x32_bf16 v[24:27], a[80:83], v[120:123], v[24:27]
  ds_read_b64_tr_b16 v[112:113], v148 offset:2048
  v_mfma_f32_16x16x32_bf16 v[24:27], a[84:87], v[124:127], v[24:27]
  ds_read_b64_tr_b16 v[114:115], v148 offset:2560
  buffer_load_dwordx4 a[156:159], v253, s[4:7], s43 offen offset:1024 sc1
  v_mfma_f32_16x16x32_bf16 v[28:31], a[88:91], v[120:123], v[28:31]
  ds_read_b64_tr_b16 v[116:117], v148 offset:10240
  v_add_u32 v145, 98304, v7
  v_mfma_f32_16x16x32_bf16 v[28:31], a[92:95], v[124:127], v[28:31]
  ds_read_b64_tr_b16 v[118:119], v148 offset:10752
  s_waitcnt lgkmcnt(8)
  v_mfma_f32_16x16x32_bf16 v[32:35], a[80:83], v[128:131], v[32:35]
  ds_read_b64_tr_b16 v[120:121], v149 offset:2048
  s_add_u32 m0, s94, 0
  v_mfma_f32_16x16x32_bf16 v[32:35], a[84:87], v[132:135], v[32:35]
  ds_read_b64_tr_b16 v[122:123], v149 offset:2560
  buffer_load_dwordx4 v2, s[8:11], s59 offen lds
  v_mfma_f32_16x16x32_bf16 v[36:39], a[88:91], v[128:131], v[36:39]
  ds_read_b64_tr_b16 v[124:125], v149 offset:10240
  v_add_u32 v146, 98304, v8
  v_mfma_f32_16x16x32_bf16 v[36:39], a[92:95], v[132:135], v[36:39]
  ds_read_b64_tr_b16 v[126:127], v149 offset:10752
  s_waitcnt lgkmcnt(8)
  v_mfma_f32_16x16x32_bf16 v[40:43], a[80:83], v[136:139], v[40:43]
  ds_read_b64_tr_b16 v[128:129], v150 offset:2048
  v_mfma_f32_16x16x32_bf16 v[40:43], a[84:87], v[140:143], v[40:43]
  ds_read_b64_tr_b16 v[130:131], v150 offset:2560
  v_mfma_f32_16x16x32_bf16 v[44:47], a[88:91], v[136:139], v[44:47]
  ds_read_b64_tr_b16 v[132:133], v150 offset:10240
  v_add_u32 v147, 98304, v9
  v_mfma_f32_16x16x32_bf16 v[44:47], a[92:95], v[140:143], v[44:47]
  ds_read_b64_tr_b16 v[134:135], v150 offset:10752
  s_waitcnt lgkmcnt(8)
  v_mfma_f32_16x16x32_bf16 v[48:51], a[80:83], v[112:115], v[48:51]
  ds_read_b64_tr_b16 v[136:137], v151 offset:2048
  v_mfma_f32_16x16x32_bf16 v[48:51], a[84:87], v[116:119], v[48:51]
  ds_read_b64_tr_b16 v[138:139], v151 offset:2560
  buffer_load_dwordx4 v2, s[8:11], s59 offen offset:2048 lds
  v_mfma_f32_16x16x32_bf16 v[52:55], a[88:91], v[112:115], v[52:55]
  ds_read_b64_tr_b16 v[140:141], v151 offset:10240
  v_mfma_f32_16x16x32_bf16 v[52:55], a[92:95], v[116:119], v[52:55]
  ds_read_b64_tr_b16 v[142:143], v151 offset:10752
  s_waitcnt lgkmcnt(8)
  v_mfma_f32_16x16x32_bf16 v[56:59], a[80:83], v[120:123], v[56:59]
  s_barrier
  ds_read_b64_tr_b16 v[112:113], v144 offset:0
  s_add_u32 m0, s94, 1024
  v_mfma_f32_16x16x32_bf16 v[56:59], a[84:87], v[124:127], v[56:59]
  ds_read_b64_tr_b16 v[114:115], v144 offset:512
  buffer_load_dwordx4 v3, s[8:11], s59 offen lds
  v_mfma_f32_16x16x32_bf16 v[60:63], a[88:91], v[120:123], v[60:63]
  ds_read_b64_tr_b16 v[116:117], v144 offset:8192
  v_mfma_f32_16x16x32_bf16 v[60:63], a[92:95], v[124:127], v[60:63]
  ds_read_b64_tr_b16 v[118:119], v144 offset:8704
  s_waitcnt lgkmcnt(8)
  v_mfma_f32_16x16x32_bf16 v[64:67], a[80:83], v[128:131], v[64:67]
  ds_read_b64_tr_b16 v[120:121], v145 offset:0
  v_mfma_f32_16x16x32_bf16 v[64:67], a[84:87], v[132:135], v[64:67]
  ds_read_b64_tr_b16 v[122:123], v145 offset:512
  buffer_load_dwordx4 v3, s[8:11], s59 offen offset:2048 lds
  v_mfma_f32_16x16x32_bf16 v[68:71], a[88:91], v[128:131], v[68:71]
  ds_read_b64_tr_b16 v[124:125], v145 offset:8192
  v_mfma_f32_16x16x32_bf16 v[68:71], a[92:95], v[132:135], v[68:71]
  ds_read_b64_tr_b16 v[126:127], v145 offset:8704
  s_waitcnt lgkmcnt(8)
  v_mfma_f32_16x16x32_bf16 v[72:75], a[80:83], v[136:139], v[72:75]
  ds_read_b64_tr_b16 v[128:129], v146 offset:0
  v_mfma_f32_16x16x32_bf16 v[72:75], a[84:87], v[140:143], v[72:75]
  ds_read_b64_tr_b16 v[130:131], v146 offset:512
  v_mfma_f32_16x16x32_bf16 v[76:79], a[88:91], v[136:139], v[76:79]
  ds_read_b64_tr_b16 v[132:133], v146 offset:8192
  v_mfma_f32_16x16x32_bf16 v[76:79], a[92:95], v[140:143], v[76:79]
  ds_read_b64_tr_b16 v[134:135], v146 offset:8704
  s_waitcnt vmcnt(16)
  s_waitcnt lgkmcnt(8)
  v_mfma_f32_16x16x32_bf16 v[16:19], a[96:99], v[112:115], v[16:19]
  ds_read_b64_tr_b16 v[136:137], v147 offset:0
  v_mfma_f32_16x16x32_bf16 v[16:19], a[100:103], v[116:119], v[16:19]
  ds_read_b64_tr_b16 v[138:139], v147 offset:512
  buffer_load_dwordx4 a[160:163], v252, s[4:7], s44 offen sc1
  v_mfma_f32_16x16x32_bf16 v[20:23], a[104:107], v[112:115], v[20:23]
  ds_read_b64_tr_b16 v[140:141], v147 offset:8192
  v_add_u32 v148, 114688, v6
  v_mfma_f32_16x16x32_bf16 v[20:23], a[108:111], v[116:119], v[20:23]
  ds_read_b64_tr_b16 v[142:143], v147 offset:8704
  s_waitcnt lgkmcnt(8)
  v_mfma_f32_16x16x32_bf16 v[24:27], a[96:99], v[120:123], v[24:27]
  ds_read_b64_tr_b16 v[112:113], v144 offset:2048
  v_mfma_f32_16x16x32_bf16 v[24:27], a[100:103], v[124:127], v[24:27]
  ds_read_b64_tr_b16 v[114:115], v144 offset:2560
  buffer_load_dwordx4 a[164:167], v252, s[4:7], s44 offen offset:1024 sc1
  v_mfma_f32_16x16x32_bf16 v[28:31], a[104:107], v[120:123], v[28:31]
  ds_read_b64_tr_b16 v[116:117], v144 offset:10240
  v_add_u32 v149, 114688, v7
  v_mfma_f32_16x16x32_bf16 v[28:31], a[108:111], v[124:127], v[28:31]
  ds_read_b64_tr_b16 v[118:119], v144 offset:10752
  s_waitcnt lgkmcnt(8)
  v_mfma_f32_16x16x32_bf16 v[32:35], a[96:99], v[128:131], v[32:35]
  ds_read_b64_tr_b16 v[120:121], v145 offset:2048
  v_mfma_f32_16x16x32_bf16 v[32:35], a[100:103], v[132:135], v[32:35]
  ds_read_b64_tr_b16 v[122:123], v145 offset:2560
  buffer_load_dwordx4 a[168:171], v253, s[4:7], s44 offen sc1
  v_mfma_f32_16x16x32_bf16 v[36:39], a[104:107], v[128:131], v[36:39]
  ds_read_b64_tr_b16 v[124:125], v145 offset:10240
  v_add_u32 v150, 114688, v8
  v_mfma_f32_16x16x32_bf16 v[36:39], a[108:111], v[132:135], v[36:39]
  ds_read_b64_tr_b16 v[126:127], v145 offset:10752
  s_waitcnt lgkmcnt(8)
  v_mfma_f32_16x16x32_bf16 v[40:43], a[96:99], v[136:139], v[40:43]
  ds_read_b64_tr_b16 v[128:129], v146 offset:2048
  v_mfma_f32_16x16x32_bf16 v[40:43], a[100:103], v[140:143], v[40:43]
  ds_read_b64_tr_b16 v[130:131], v146 offset:2560
  v_mfma_f32_16x16x32_bf16 v[44:47], a[104:107], v[136:139], v[44:47]
  ds_read_b64_tr_b16 v[132:133], v146 offset:10240
  v_add_u32 v151, 114688, v9
  v_mfma_f32_16x16x32_bf16 v[44:47], a[108:111], v[140:143], v[44:47]
  ds_read_b64_tr_b16 v[134:135], v146 offset:10752
  s_waitcnt lgkmcnt(8)
  v_mfma_f32_16x16x32_bf16 v[48:51], a[96:99], v[112:115], v[48:51]
  ds_read_b64_tr_b16 v[136:137], v147 offset:2048
  v_mfma_f32_16x16x32_bf16 v[48:51], a[100:103], v[116:119], v[48:51]
  ds_read_b64_tr_b16 v[138:139], v147 offset:2560
  buffer_load_dwordx4 a[172:175], v253, s[4:7], s44 offen offset:1024 sc1
  v_mfma_f32_16x16x32_bf16 v[52:55], a[104:107], v[112:115], v[52:55]
  ds_read_b64_tr_b16 v[140:141], v147 offset:10240
  v_mfma_f32_16x16x32_bf16 v[52:55], a[108:111], v[116:119], v[52:55]
  ds_read_b64_tr_b16 v[142:143], v147 offset:10752
  s_waitcnt lgkmcnt(8)
  v_mfma_f32_16x16x32_bf16 v[56:59], a[96:99], v[120:123], v[56:59]
  s_barrier
  ds_read_b64_tr_b16 v[112:113], v148 offset:0
  s_add_u32 m0, s94, 16384
  v_mfma_f32_16x16x32_bf16 v[56:59], a[100:103], v[124:127], v[56:59]
  ds_read_b64_tr_b16 v[114:115], v148 offset:512
  buffer_load_dwordx4 v2, s[8:11], s60 offen lds
  v_mfma_f32_16x16x32_bf16 v[60:63], a[104:107], v[120:123], v[60:63]
  ds_read_b64_tr_b16 v[116:117], v148 offset:8192
  v_mfma_f32_16x16x32_bf16 v[60:63], a[108:111], v[124:127], v[60:63]
  ds_read_b64_tr_b16 v[118:119], v148 offset:8704
  s_waitcnt lgkmcnt(8)
  v_mfma_f32_16x16x32_bf16 v[64:67], a[96:99], v[128:131], v[64:67]
  ds_read_b64_tr_b16 v[120:121], v149 offset:0
  v_mfma_f32_16x16x32_bf16 v[64:67], a[100:103], v[132:135], v[64:67]
  ds_read_b64_tr_b16 v[122:123], v149 offset:512
  buffer_load_dwordx4 v2, s[8:11], s60 offen offset:2048 lds
  v_mfma_f32_16x16x32_bf16 v[68:71], a[104:107], v[128:131], v[68:71]
  ds_read_b64_tr_b16 v[124:125], v149 offset:8192
  v_mfma_f32_16x16x32_bf16 v[68:71], a[108:111], v[132:135], v[68:71]
  ds_read_b64_tr_b16 v[126:127], v149 offset:8704
  s_waitcnt lgkmcnt(8)
  v_mfma_f32_16x16x32_bf16 v[72:75], a[96:99], v[136:139], v[72:75]
  ds_read_b64_tr_b16 v[128:129], v150 offset:0
  v_mfma_f32_16x16x32_bf16 v[72:75], a[100:103], v[140:143], v[72:75]
  ds_read_b64_tr_b16 v[130:131], v150 offset:512
  v_mfma_f32_16x16x32_bf16 v[76:79], a[104:107], v[136:139], v[76:79]
  ds_read_b64_tr_b16 v[132:133], v150 offset:8192
  v_mfma_f32_16x16x32_bf16 v[76:79], a[108:111], v[140:143], v[76:79]
  ds_read_b64_tr_b16 v[134:135], v150 offset:8704
  s_waitcnt vmcnt(18)
  s_waitcnt lgkmcnt(8)
  v_mfma_f32_16x16x32_bf16 v[16:19], a[112:115], v[112:115], v[16:19]
  ds_read_b64_tr_b16 v[136:137], v151 offset:0
  s_add_u32 m0, s94, 17408
  v_mfma_f32_16x16x32_bf16 v[16:19], a[116:119], v[116:119], v[16:19]
  ds_read_b64_tr_b16 v[138:139], v151 offset:512
  buffer_load_dwordx4 v3, s[8:11], s60 offen lds
  v_mfma_f32_16x16x32_bf16 v[20:23], a[120:123], v[112:115], v[20:23]
  ds_read_b64_tr_b16 v[140:141], v151 offset:8192
  v_add_u32 v144, 131072, v6
  v_mfma_f32_16x16x32_bf16 v[20:23], a[124:127], v[116:119], v[20:23]
  ds_read_b64_tr_b16 v[142:143], v151 offset:8704
  s_waitcnt lgkmcnt(8)
  v_mfma_f32_16x16x32_bf16 v[24:27], a[112:115], v[120:123], v[24:27]
  ds_read_b64_tr_b16 v[112:113], v148 offset:2048
  v_mfma_f32_16x16x32_bf16 v[24:27], a[116:119], v[124:127], v[24:27]
  ds_read_b64_tr_b16 v[114:115], v148 offset:2560
  buffer_load_dwordx4 v3, s[8:11], s60 offen offset:2048 lds
  v_mfma_f32_16x16x32_bf16 v[28:31], a[120:123], v[120:123], v[28:31]
  ds_read_b64_tr_b16 v[116:117], v148 offset:10240
  v_add_u32 v145, 131072, v7
  v_mfma_f32_16x16x32_bf16 v[28:31], a[124:127], v[124:127], v[28:31]
  ds_read_b64_tr_b16 v[118:119], v148 offset:10752
  s_waitcnt lgkmcnt(8)
  v_mfma_f32_16x16x32_bf16 v[32:35], a[112:115], v[128:131], v[32:35]
  ds_read_b64_tr_b16 v[120:121], v149 offset:2048
  v_mfma_f32_16x16x32_bf16 v[32:35], a[116:119], v[132:135], v[32:35]
  ds_read_b64_tr_b16 v[122:123], v149 offset:2560
  buffer_load_dwordx4 a[176:179], v252, s[4:7], s45 offen sc1
  v_mfma_f32_16x16x32_bf16 v[36:39], a[120:123], v[128:131], v[36:39]
  ds_read_b64_tr_b16 v[124:125], v149 offset:10240
  v_add_u32 v146, 131072, v8
  v_mfma_f32_16x16x32_bf16 v[36:39], a[124:127], v[132:135], v[36:39]
  ds_read_b64_tr_b16 v[126:127], v149 offset:10752
  s_waitcnt lgkmcnt(8)
  v_mfma_f32_16x16x32_bf16 v[40:43], a[112:115], v[136:139], v[40:43]
  ds_read_b64_tr_b16 v[128:129], v150 offset:2048
  v_mfma_f32_16x16x32_bf16 v[40:43], a[116:119], v[140:143], v[40:43]
  ds_read_b64_tr_b16 v[130:131], v150 offset:2560
  v_mfma_f32_16x16x32_bf16 v[44:47], a[120:123], v[136:139], v[44:47]
  ds_read_b64_tr_b16 v[132:133], v150 offset:10240
  v_add_u32 v147, 131072, v9
  v_mfma_f32_16x16x32_bf16 v[44:47], a[124:127], v[140:143], v[44:47]
  ds_read_b64_tr_b16 v[134:135], v150 offset:10752
  s_waitcnt lgkmcnt(8)
  v_mfma_f32_16x16x32_bf16 v[48:51], a[112:115], v[112:115], v[48:51]
  ds_read_b64_tr_b16 v[136:137], v151 offset:2048
  v_mfma_f32_16x16x32_bf16 v[48:51], a[116:119], v[116:119], v[48:51]
  ds_read_b64_tr_b16 v[138:139], v151 offset:2560
  buffer_load_dwordx4 a[180:183], v252, s[4:7], s45 offen offset:1024 sc1
  v_mfma_f32_16x16x32_bf16 v[52:55], a[120:123], v[112:115], v[52:55]
  ds_read_b64_tr_b16 v[140:141], v151 offset:10240
  v_mfma_f32_16x16x32_bf16 v[52:55], a[124:127], v[116:119], v[52:55]
  ds_read_b64_tr_b16 v[142:143], v151 offset:10752
  s_waitcnt lgkmcnt(8)
  v_mfma_f32_16x16x32_bf16 v[56:59], a[112:115], v[120:123], v[56:59]
  s_barrier
  ds_read_b64_tr_b16 v[112:113], v144 offset:0
  v_mfma_f32_16x16x32_bf16 v[56:59], a[116:119], v[124:127], v[56:59]
  ds_read_b64_tr_b16 v[114:115], v144 offset:512
  buffer_load_dwordx4 a[184:187], v253, s[4:7], s45 offen sc1
  v_mfma_f32_16x16x32_bf16 v[60:63], a[120:123], v[120:123], v[60:63]
  ds_read_b64_tr_b16 v[116:117], v144 offset:8192
  v_mfma_f32_16x16x32_bf16 v[60:63], a[124:127], v[124:127], v[60:63]
  ds_read_b64_tr_b16 v[118:119], v144 offset:8704
  s_waitcnt lgkmcnt(8)
  v_mfma_f32_16x16x32_bf16 v[64:67], a[112:115], v[128:131], v[64:67]
  ds_read_b64_tr_b16 v[120:121], v145 offset:0
  v_mfma_f32_16x16x32_bf16 v[64:67], a[116:119], v[132:135], v[64:67]
  ds_read_b64_tr_b16 v[122:123], v145 offset:512
  buffer_load_dwordx4 a[188:191], v253, s[4:7], s45 offen offset:1024 sc1
  v_mfma_f32_16x16x32_bf16 v[68:71], a[120:123], v[128:131], v[68:71]
  ds_read_b64_tr_b16 v[124:125], v145 offset:8192
  v_mfma_f32_16x16x32_bf16 v[68:71], a[124:127], v[132:135], v[68:71]
  ds_read_b64_tr_b16 v[126:127], v145 offset:8704
  s_waitcnt lgkmcnt(8)
  v_mfma_f32_16x16x32_bf16 v[72:75], a[112:115], v[136:139], v[72:75]
  ds_read_b64_tr_b16 v[128:129], v146 offset:0
  v_mfma_f32_16x16x32_bf16 v[72:75], a[116:119], v[140:143], v[72:75]
  ds_read_b64_tr_b16 v[130:131], v146 offset:512
  v_mfma_f32_16x16x32_bf16 v[76:79], a[120:123], v[136:139], v[76:79]
  ds_read_b64_tr_b16 v[132:133], v146 offset:8192
  v_mfma_f32_16x16x32_bf16 v[76:79], a[124:127], v[140:143], v[76:79]
  ds_read_b64_tr_b16 v[134:135], v146 offset:8704
  s_waitcnt vmcnt(20)
  s_waitcnt lgkmcnt(8)
  v_mfma_f32_16x16x32_bf16 v[16:19], a[128:131], v[112:115], v[16:19]
  ds_read_b64_tr_b16 v[136:137], v147 offset:0
  s_add_u32 m0, s94, 32768
  v_mfma_f32_16x16x32_bf16 v[16:19], a[132:135], v[116:119], v[16:19]
  ds_read_b64_tr_b16 v[138:139], v147 offset:512
  buffer_load_dwordx4 v2, s[8:11], s61 offen lds
  v_mfma_f32_16x16x32_bf16 v[20:23], a[136:139], v[112:115], v[20:23]
  ds_read_b64_tr_b16 v[140:141], v147 offset:8192
  v_add_u32 v148, 0, v6
  v_mfma_f32_16x16x32_bf16 v[20:23], a[140:143], v[116:119], v[20:23]
  ds_read_b64_tr_b16 v[142:143], v147 offset:8704
  s_waitcnt lgkmcnt(8)
  v_mfma_f32_16x16x32_bf16 v[24:27], a[128:131], v[120:123], v[24:27]
  ds_read_b64_tr_b16 v[112:113], v144 offset:2048
  v_mfma_f32_16x16x32_bf16 v[24:27], a[132:135], v[124:127], v[24:27]
  ds_read_b64_tr_b16 v[114:115], v144 offset:2560
  buffer_load_dwordx4 v2, s[8:11], s61 offen offset:2048 lds
  v_mfma_f32_16x16x32_bf16 v[28:31], a[136:139], v[120:123], v[28:31]
  ds_read_b64_tr_b16 v[116:117], v144 offset:10240
  v_add_u32 v149, 0, v7
  v_mfma_f32_16x16x32_bf16 v[28:31], a[140:143], v[124:127], v[28:31]
  ds_read_b64_tr_b16 v[118:119], v144 offset:10752
  s_waitcnt lgkmcnt(8)
  v_mfma_f32_16x16x32_bf16 v[32:35], a[128:131], v[128:131], v[32:35]
  ds_read_b64_tr_b16 v[120:121], v145 offset:2048
  s_add_u32 m0, s94, 33792
  v_mfma_f32_16x16x32_bf16 v[32:35], a[132:135], v[132:135], v[32:35]
  ds_read_b64_tr_b16 v[122:123], v145 offset:2560
  buffer_load_dwordx4 v3, s[8:11], s61 offen lds
  v_mfma_f32_16x16x32_bf16 v[36:39], a[136:139], v[128:131], v[36:39]
  ds_read_b64_tr_b16 v[124:125], v145 offset:10240
  v_add_u32 v150, 0, v8
  v_mfma_f32_16x16x32_bf16 v[36:39], a[140:143], v[132:135], v[36:39]
  ds_read_b64_tr_b16 v[126:127], v145 offset:10752
  s_waitcnt lgkmcnt(8)
  v_mfma_f32_16x16x32_bf16 v[40:43], a[128:131], v[136:139], v[40:43]
  ds_read_b64_tr_b16 v[128:129], v146 offset:2048
  v_mfma_f32_16x16x32_bf16 v[40:43], a[132:135], v[140:143], v[40:43]
  ds_read_b64_tr_b16 v[130:131], v146 offset:2560
  v_mfma_f32_16x16x32_bf16 v[44:47], a[136:139], v[136:139], v[44:47]
  ds_read_b64_tr_b16 v[132:133], v146 offset:10240
  v_add_u32 v151, 0, v9
  v_mfma_f32_16x16x32_bf16 v[44:47], a[140:143], v[140:143], v[44:47]
  ds_read_b64_tr_b16 v[134:135], v146 offset:10752
  s_waitcnt lgkmcnt(8)
  v_mfma_f32_16x16x32_bf16 v[48:51], a[128:131], v[112:115], v[48:51]
  ds_read_b64_tr_b16 v[136:137], v147 offset:2048
  v_mfma_f32_16x16x32_bf16 v[48:51], a[132:135], v[116:119], v[48:51]
  ds_read_b64_tr_b16 v[138:139], v147 offset:2560
  buffer_load_dwordx4 v3, s[8:11], s61 offen offset:2048 lds
  v_mfma_f32_16x16x32_bf16 v[52:55], a[136:139], v[112:115], v[52:55]
  ds_read_b64_tr_b16 v[140:141], v147 offset:10240
  v_mfma_f32_16x16x32_bf16 v[52:55], a[140:143], v[116:119], v[52:55]
  ds_read_b64_tr_b16 v[142:143], v147 offset:10752
  s_waitcnt lgkmcnt(8)
  v_mfma_f32_16x16x32_bf16 v[56:59], a[128:131], v[120:123], v[56:59]
  s_waitcnt vmcnt(16)
  s_barrier
  ds_read_b64_tr_b16 v[112:113], v148 offset:0
  v_mfma_f32_16x16x32_bf16 v[56:59], a[132:135], v[124:127], v[56:59]
  ds_read_b64_tr_b16 v[114:115], v148 offset:512
  buffer_load_dwordx4 a[192:195], v252, s[4:7], s46 offen sc1
  v_mfma_f32_16x16x32_bf16 v[60:63], a[136:139], v[120:123], v[60:63]
  ds_read_b64_tr_b16 v[116:117], v148 offset:8192
  v_mfma_f32_16x16x32_bf16 v[60:63], a[140:143], v[124:127], v[60:63]
  ds_read_b64_tr_b16 v[118:119], v148 offset:8704
  s_waitcnt lgkmcnt(8)
  v_mfma_f32_16x16x32_bf16 v[64:67], a[128:131], v[128:131], v[64:67]
  ds_read_b64_tr_b16 v[120:121], v149 offset:0
  v_mfma_f32_16x16x32_bf16 v[64:67], a[132:135], v[132:135], v[64:67]
  ds_read_b64_tr_b16 v[122:123], v149 offset:512
  buffer_load_dwordx4 a[196:199], v252, s[4:7], s46 offen offset:1024 sc1
  v_mfma_f32_16x16x32_bf16 v[68:71], a[136:139], v[128:131], v[68:71]
  ds_read_b64_tr_b16 v[124:125], v149 offset:8192
  v_mfma_f32_16x16x32_bf16 v[68:71], a[140:143], v[132:135], v[68:71]
  ds_read_b64_tr_b16 v[126:127], v149 offset:8704
  s_waitcnt lgkmcnt(8)
  v_mfma_f32_16x16x32_bf16 v[72:75], a[128:131], v[136:139], v[72:75]
  ds_read_b64_tr_b16 v[128:129], v150 offset:0
  v_mfma_f32_16x16x32_bf16 v[72:75], a[132:135], v[140:143], v[72:75]
  ds_read_b64_tr_b16 v[130:131], v150 offset:512
  v_mfma_f32_16x16x32_bf16 v[76:79], a[136:139], v[136:139], v[76:79]
  ds_read_b64_tr_b16 v[132:133], v150 offset:8192
  v_mfma_f32_16x16x32_bf16 v[76:79], a[140:143], v[140:143], v[76:79]
  ds_read_b64_tr_b16 v[134:135], v150 offset:8704
  s_waitcnt lgkmcnt(8)
  v_mfma_f32_16x16x32_bf16 v[16:19], a[144:147], v[112:115], v[16:19]
  ds_read_b64_tr_b16 v[136:137], v151 offset:0
  v_mfma_f32_16x16x32_bf16 v[16:19], a[148:151], v[116:119], v[16:19]
  ds_read_b64_tr_b16 v[138:139], v151 offset:512
  buffer_load_dwordx4 a[200:203], v253, s[4:7], s46 offen sc1
  v_mfma_f32_16x16x32_bf16 v[20:23], a[152:155], v[112:115], v[20:23]
  ds_read_b64_tr_b16 v[140:141], v151 offset:8192
  v_add_u32 v144, 16384, v6
  v_mfma_f32_16x16x32_bf16 v[20:23], a[156:159], v[116:119], v[20:23]
  ds_read_b64_tr_b16 v[142:143], v151 offset:8704
  s_waitcnt lgkmcnt(8)
  v_mfma_f32_16x16x32_bf16 v[24:27], a[144:147], v[120:123], v[24:27]
  ds_read_b64_tr_b16 v[112:113], v148 offset:2048
  v_mfma_f32_16x16x32_bf16 v[24:27], a[148:151], v[124:127], v[24:27]
  ds_read_b64_tr_b16 v[114:115], v148 offset:2560
  buffer_load_dwordx4 a[204:207], v253, s[4:7], s46 offen offset:1024 sc1
  v_mfma_f32_16x16x32_bf16 v[28:31], a[152:155], v[120:123], v[28:31]
  ds_read_b64_tr_b16 v[116:117], v148 offset:10240
  v_add_u32 v145, 16384, v7
  v_mfma_f32_16x16x32_bf16 v[28:31], a[156:159], v[124:127], v[28:31]
  ds_read_b64_tr_b16 v[118:119], v148 offset:10752
  s_waitcnt lgkmcnt(8)
  v_mfma_f32_16x16x32_bf16 v[32:35], a[144:147], v[128:131], v[32:35]
  ds_read_b64_tr_b16 v[120:121], v149 offset:2048
  s_add_u32 m0, s94, 49152
  v_mfma_f32_16x16x32_bf16 v[32:35], a[148:151], v[132:135], v[32:35]
  ds_read_b64_tr_b16 v[122:123], v149 offset:2560
  buffer_load_dwordx4 v2, s[8:11], s62 offen lds
  v_mfma_f32_16x16x32_bf16 v[36:39], a[152:155], v[128:131], v[36:39]
  ds_read_b64_tr_b16 v[124:125], v149 offset:10240
  v_add_u32 v146, 16384, v8
  v_mfma_f32_16x16x32_bf16 v[36:39], a[156:159], v[132:135], v[36:39]
  ds_read_b64_tr_b16 v[126:127], v149 offset:10752
  s_waitcnt lgkmcnt(8)
  v_mfma_f32_16x16x32_bf16 v[40:43], a[144:147], v[136:139], v[40:43]
  ds_read_b64_tr_b16 v[128:129], v150 offset:2048
  v_mfma_f32_16x16x32_bf16 v[40:43], a[148:151], v[140:143], v[40:43]
  ds_read_b64_tr_b16 v[130:131], v150 offset:2560
  v_mfma_f32_16x16x32_bf16 v[44:47], a[152:155], v[136:139], v[44:47]
  ds_read_b64_tr_b16 v[132:133], v150 offset:10240
  v_add_u32 v147, 16384, v9
  v_mfma_f32_16x16x32_bf16 v[44:47], a[156:159], v[140:143], v[44:47]
  ds_read_b64_tr_b16 v[134:135], v150 offset:10752
  s_waitcnt lgkmcnt(8)
  v_mfma_f32_16x16x32_bf16 v[48:51], a[144:147], v[112:115], v[48:51]
  ds_read_b64_tr_b16 v[136:137], v151 offset:2048
  v_mfma_f32_16x16x32_bf16 v[48:51], a[148:151], v[116:119], v[48:51]
  ds_read_b64_tr_b16 v[138:139], v151 offset:2560
  buffer_load_dwordx4 v2, s[8:11], s62 offen offset:2048 lds
  v_mfma_f32_16x16x32_bf16 v[52:55], a[152:155], v[112:115], v[52:55]
  ds_read_b64_tr_b16 v[140:141], v151 offset:10240
  v_mfma_f32_16x16x32_bf16 v[52:55], a[156:159], v[116:119], v[52:55]
  ds_read_b64_tr_b16 v[142:143], v151 offset:10752
  s_waitcnt lgkmcnt(8)
  v_mfma_f32_16x16x32_bf16 v[56:59], a[144:147], v[120:123], v[56:59]
  s_waitcnt vmcnt(14)
  s_barrier
  ds_read_b64_tr_b16 v[112:113], v144 offset:0
  s_add_u32 m0, s94, 50176
  v_mfma_f32_16x16x32_bf16 v[56:59], a[148:151], v[124:127], v[56:59]
  ds_read_b64_tr_b16 v[114:115], v144 offset:512
  buffer_load_dwordx4 v3, s[8:11], s62 offen lds
  v_mfma_f32_16x16x32_bf16 v[60:63], a[152:155], v[120:123], v[60:63]
  ds_read_b64_tr_b16 v[116:117], v144 offset:8192
  v_mfma_f32_16x16x32_bf16 v[60:63], a[156:159], v[124:127], v[60:63]
  ds_read_b64_tr_b16 v[118:119], v144 offset:8704
  s_waitcnt lgkmcnt(8)
  v_mfma_f32_16x16x32_bf16 v[64:67], a[144:147], v[128:131], v[64:67]
  ds_read_b64_tr_b16 v[120:121], v145 offset:0
  v_mfma_f32_16x16x32_bf16 v[64:67], a[148:151], v[132:135], v[64:67]
  ds_read_b64_tr_b16 v[122:123], v145 offset:512
  buffer_load_dwordx4 v3, s[8:11], s62 offen offset:2048 lds
  v_mfma_f32_16x16x32_bf16 v[68:71], a[152:155], v[128:131], v[68:71]
  ds_read_b64_tr_b16 v[124:125], v145 offset:8192
  v_mfma_f32_16x16x32_bf16 v[68:71], a[156:159], v[132:135], v[68:71]
  ds_read_b64_tr_b16 v[126:127], v145 offset:8704
  s_waitcnt lgkmcnt(8)
  v_mfma_f32_16x16x32_bf16 v[72:75], a[144:147], v[136:139], v[72:75]
  ds_read_b64_tr_b16 v[128:129], v146 offset:0
  v_mfma_f32_16x16x32_bf16 v[72:75], a[148:151], v[140:143], v[72:75]
  ds_read_b64_tr_b16 v[130:131], v146 offset:512
  v_mfma_f32_16x16x32_bf16 v[76:79], a[152:155], v[136:139], v[76:79]
  ds_read_b64_tr_b16 v[132:133], v146 offset:8192
  v_mfma_f32_16x16x32_bf16 v[76:79], a[156:159], v[140:143], v[76:79]
  ds_read_b64_tr_b16 v[134:135], v146 offset:8704
  s_waitcnt lgkmcnt(8)
  v_mfma_f32_16x16x32_bf16 v[16:19], a[160:163], v[112:115], v[16:19]
  ds_read_b64_tr_b16 v[136:137], v147 offset:0
  v_mfma_f32_16x16x32_bf16 v[16:19], a[164:167], v[116:119], v[16:19]
  ds_read_b64_tr_b16 v[138:139], v147 offset:512
  buffer_load_dwordx4 a[208:211], v252, s[4:7], s47 offen sc1
  v_mfma_f32_16x16x32_bf16 v[20:23], a[168:171], v[112:115], v[20:23]
  ds_read_b64_tr_b16 v[140:141], v147 offset:8192
  v_add_u32 v148, 32768, v6
  v_mfma_f32_16x16x32_bf16 v[20:23], a[172:175], v[116:119], v[20:23]
  ds_read_b64_tr_b16 v[142:143], v147 offset:8704
  s_waitcnt lgkmcnt(8)
  v_mfma_f32_16x16x32_bf16 v[24:27], a[160:163], v[120:123], v[24:27]
  ds_read_b64_tr_b16 v[112:113], v144 offset:2048
  v_mfma_f32_16x16x32_bf16 v[24:27], a[164:167], v[124:127], v[24:27]
  ds_read_b64_tr_b16 v[114:115], v144 offset:2560
  buffer_load_dwordx4 a[212:215], v252, s[4:7], s47 offen offset:1024 sc1
  v_mfma_f32_16x16x32_bf16 v[28:31], a[168:171], v[120:123], v[28:31]
  ds_read_b64_tr_b16 v[116:117], v144 offset:10240
  v_add_u32 v149, 32768, v7
  v_mfma_f32_16x16x32_bf16 v[28:31], a[172:175], v[124:127], v[28:31]
  ds_read_b64_tr_b16 v[118:119], v144 offset:10752
  s_waitcnt lgkmcnt(8)
  v_mfma_f32_16x16x32_bf16 v[32:35], a[160:163], v[128:131], v[32:35]
  ds_read_b64_tr_b16 v[120:121], v145 offset:2048
  v_mfma_f32_16x16x32_bf16 v[32:35], a[164:167], v[132:135], v[32:35]
  ds_read_b64_tr_b16 v[122:123], v145 offset:2560
  buffer_load_dwordx4 a[216:219], v253, s[4:7], s47 offen sc1
  v_mfma_f32_16x16x32_bf16 v[36:39], a[168:171], v[128:131], v[36:39]
  ds_read_b64_tr_b16 v[124:125], v145 offset:10240
  v_add_u32 v150, 32768, v8
  v_mfma_f32_16x16x32_bf16 v[36:39], a[172:175], v[132:135], v[36:39]
  ds_read_b64_tr_b16 v[126:127], v145 offset:10752
  s_waitcnt lgkmcnt(8)
  v_mfma_f32_16x16x32_bf16 v[40:43], a[160:163], v[136:139], v[40:43]
  ds_read_b64_tr_b16 v[128:129], v146 offset:2048
  v_mfma_f32_16x16x32_bf16 v[40:43], a[164:167], v[140:143], v[40:43]
  ds_read_b64_tr_b16 v[130:131], v146 offset:2560
  v_mfma_f32_16x16x32_bf16 v[44:47], a[168:171], v[136:139], v[44:47]
  ds_read_b64_tr_b16 v[132:133], v146 offset:10240
  v_add_u32 v151, 32768, v9
  v_mfma_f32_16x16x32_bf16 v[44:47], a[172:175], v[140:143], v[44:47]
  ds_read_b64_tr_b16 v[134:135], v146 offset:10752
  s_waitcnt lgkmcnt(8)
  v_mfma_f32_16x16x32_bf16 v[48:51], a[160:163], v[112:115], v[48:51]
  ds_read_b64_tr_b16 v[136:137], v147 offset:2048
  v_mfma_f32_16x16x32_bf16 v[48:51], a[164:167], v[116:119], v[48:51]
  ds_read_b64_tr_b16 v[138:139], v147 offset:2560
  buffer_load_dwordx4 a[220:223], v253, s[4:7], s47 offen offset:1024 sc1
  v_mfma_f32_16x16x32_bf16 v[52:55], a[168:171], v[112:115], v[52:55]
  ds_read_b64_tr_b16 v[140:141], v147 offset:10240
  v_mfma_f32_16x16x32_bf16 v[52:55], a[172:175], v[116:119], v[52:55]
  ds_read_b64_tr_b16 v[142:143], v147 offset:10752
  s_waitcnt lgkmcnt(8)
  v_mfma_f32_16x16x32_bf16 v[56:59], a[160:163], v[120:123], v[56:59]
  s_waitcnt vmcnt(12)
  s_barrier
  ds_read_b64_tr_b16 v[112:113], v148 offset:0
  s_add_u32 m0, s94, 65536
  v_mfma_f32_16x16x32_bf16 v[56:59], a[164:167], v[124:127], v[56:59]
  ds_read_b64_tr_b16 v[114:115], v148 offset:512
  buffer_load_dwordx4 v2, s[8:11], s63 offen lds
  v_mfma_f32_16x16x32_bf16 v[60:63], a[168:171], v[120:123], v[60:63]
  ds_read_b64_tr_b16 v[116:117], v148 offset:8192
  v_mfma_f32_16x16x32_bf16 v[60:63], a[172:175], v[124:127], v[60:63]
  ds_read_b64_tr_b16 v[118:119], v148 offset:8704
  s_waitcnt lgkmcnt(8)
  v_mfma_f32_16x16x32_bf16 v[64:67], a[160:163], v[128:131], v[64:67]
  ds_read_b64_tr_b16 v[120:121], v149 offset:0
  v_mfma_f32_16x16x32_bf16 v[64:67], a[164:167], v[132:135], v[64:67]
  ds_read_b64_tr_b16 v[122:123], v149 offset:512
  buffer_load_dwordx4 v2, s[8:11], s63 offen offset:2048 lds
  v_mfma_f32_16x16x32_bf16 v[68:71], a[168:171], v[128:131], v[68:71]
  ds_read_b64_tr_b16 v[124:125], v149 offset:8192
  v_mfma_f32_16x16x32_bf16 v[68:71], a[172:175], v[132:135], v[68:71]
  ds_read_b64_tr_b16 v[126:127], v149 offset:8704
  s_waitcnt lgkmcnt(8)
  v_mfma_f32_16x16x32_bf16 v[72:75], a[160:163], v[136:139], v[72:75]
  ds_read_b64_tr_b16 v[128:129], v150 offset:0
  v_mfma_f32_16x16x32_bf16 v[72:75], a[164:167], v[140:143], v[72:75]
  ds_read_b64_tr_b16 v[130:131], v150 offset:512
  v_mfma_f32_16x16x32_bf16 v[76:79], a[168:171], v[136:139], v[76:79]
  ds_read_b64_tr_b16 v[132:133], v150 offset:8192
  v_mfma_f32_16x16x32_bf16 v[76:79], a[172:175], v[140:143], v[76:79]
  ds_read_b64_tr_b16 v[134:135], v150 offset:8704
  s_waitcnt lgkmcnt(8)
  v_mfma_f32_16x16x32_bf16 v[16:19], a[176:179], v[112:115], v[16:19]
  ds_read_b64_tr_b16 v[136:137], v151 offset:0
  s_add_u32 m0, s94, 66560
  v_mfma_f32_16x16x32_bf16 v[16:19], a[180:183], v[116:119], v[16:19]
  ds_read_b64_tr_b16 v[138:139], v151 offset:512
  buffer_load_dwordx4 v3, s[8:11], s63 offen lds
  v_mfma_f32_16x16x32_bf16 v[20:23], a[184:187], v[112:115], v[20:23]
  ds_read_b64_tr_b16 v[140:141], v151 offset:8192
  v_add_u32 v144, 49152, v6
  v_mfma_f32_16x16x32_bf16 v[20:23], a[188:191], v[116:119], v[20:23]
  ds_read_b64_tr_b16 v[142:143], v151 offset:8704
  s_waitcnt lgkmcnt(8)
  v_mfma_f32_16x16x32_bf16 v[24:27], a[176:179], v[120:123], v[24:27]
  ds_read_b64_tr_b16 v[112:113], v148 offset:2048
  v_mfma_f32_16x16x32_bf16 v[24:27], a[180:183], v[124:127], v[24:27]
  ds_read_b64_tr_b16 v[114:115], v148 offset:2560
  buffer_load_dwordx4 v3, s[8:11], s63 offen offset:2048 lds
  v_mfma_f32_16x16x32_bf16 v[28:31], a[184:187], v[120:123], v[28:31]
  ds_read_b64_tr_b16 v[116:117], v148 offset:10240
  v_add_u32 v145, 49152, v7
  v_mfma_f32_16x16x32_bf16 v[28:31], a[188:191], v[124:127], v[28:31]
  ds_read_b64_tr_b16 v[118:119], v148 offset:10752
  s_waitcnt lgkmcnt(8)
  v_mfma_f32_16x16x32_bf16 v[32:35], a[176:179], v[128:131], v[32:35]
  ds_read_b64_tr_b16 v[120:121], v149 offset:2048
  v_mfma_f32_16x16x32_bf16 v[32:35], a[180:183], v[132:135], v[32:35]
  ds_read_b64_tr_b16 v[122:123], v149 offset:2560
  buffer_load_dwordx4 a[224:227], v252, s[4:7], s48 offen sc1
  v_mfma_f32_16x16x32_bf16 v[36:39], a[184:187], v[128:131], v[36:39]
  ds_read_b64_tr_b16 v[124:125], v149 offset:10240
  v_add_u32 v146, 49152, v8
  v_mfma_f32_16x16x32_bf16 v[36:39], a[188:191], v[132:135], v[36:39]
  ds_read_b64_tr_b16 v[126:127], v149 offset:10752
  s_waitcnt lgkmcnt(8)
  v_mfma_f32_16x16x32_bf16 v[40:43], a[176:179], v[136:139], v[40:43]
  ds_read_b64_tr_b16 v[128:129], v150 offset:2048
  v_mfma_f32_16x16x32_bf16 v[40:43], a[180:183], v[140:143], v[40:43]
  ds_read_b64_tr_b16 v[130:131], v150 offset:2560
  v_mfma_f32_16x16x32_bf16 v[44:47], a[184:187], v[136:139], v[44:47]
  ds_read_b64_tr_b16 v[132:133], v150 offset:10240
  v_add_u32 v147, 49152, v9
  v_mfma_f32_16x16x32_bf16 v[44:47], a[188:191], v[140:143], v[44:47]
  ds_read_b64_tr_b16 v[134:135], v150 offset:10752
  s_waitcnt lgkmcnt(8)
  v_mfma_f32_16x16x32_bf16 v[48:51], a[176:179], v[112:115], v[48:51]
  ds_read_b64_tr_b16 v[136:137], v151 offset:2048
  v_mfma_f32_16x16x32_bf16 v[48:51], a[180:183], v[116:119], v[48:51]
  ds_read_b64_tr_b16 v[138:139], v151 offset:2560
  buffer_load_dwordx4 a[228:231], v252, s[4:7], s48 offen offset:1024 sc1
  v_mfma_f32_16x16x32_bf16 v[52:55], a[184:187], v[112:115], v[52:55]
  ds_read_b64_tr_b16 v[140:141], v151 offset:10240
  v_mfma_f32_16x16x32_bf16 v[52:55], a[188:191], v[116:119], v[52:55]
  ds_read_b64_tr_b16 v[142:143], v151 offset:10752
  s_waitcnt lgkmcnt(8)
  v_mfma_f32_16x16x32_bf16 v[56:59], a[176:179], v[120:123], v[56:59]
  s_waitcnt vmcnt(10)
  s_barrier
  ds_read_b64_tr_b16 v[112:113], v144 offset:0
  v_mfma_f32_16x16x32_bf16 v[56:59], a[180:183], v[124:127], v[56:59]
  ds_read_b64_tr_b16 v[114:115], v144 offset:512
  buffer_load_dwordx4 a[232:235], v253, s[4:7], s48 offen sc1
  v_mfma_f32_16x16x32_bf16 v[60:63], a[184:187], v[120:123], v[60:63]
  ds_read_b64_tr_b16 v[116:117], v144 offset:8192
  v_mfma_f32_16x16x32_bf16 v[60:63], a[188:191], v[124:127], v[60:63]
  ds_read_b64_tr_b16 v[118:119], v144 offset:8704
  s_waitcnt lgkmcnt(8)
  v_mfma_f32_16x16x32_bf16 v[64:67], a[176:179], v[128:131], v[64:67]
  ds_read_b64_tr_b16 v[120:121], v145 offset:0
  v_mfma_f32_16x16x32_bf16 v[64:67], a[180:183], v[132:135], v[64:67]
  ds_read_b64_tr_b16 v[122:123], v145 offset:512
  buffer_load_dwordx4 a[236:239], v253, s[4:7], s48 offen offset:1024 sc1
  v_mfma_f32_16x16x32_bf16 v[68:71], a[184:187], v[128:131], v[68:71]
  ds_read_b64_tr_b16 v[124:125], v145 offset:8192
  v_mfma_f32_16x16x32_bf16 v[68:71], a[188:191], v[132:135], v[68:71]
  ds_read_b64_tr_b16 v[126:127], v145 offset:8704
  s_waitcnt lgkmcnt(8)
  v_mfma_f32_16x16x32_bf16 v[72:75], a[176:179], v[136:139], v[72:75]
  ds_read_b64_tr_b16 v[128:129], v146 offset:0
  v_mfma_f32_16x16x32_bf16 v[72:75], a[180:183], v[140:143], v[72:75]
  ds_read_b64_tr_b16 v[130:131], v146 offset:512
  v_mfma_f32_16x16x32_bf16 v[76:79], a[184:187], v[136:139], v[76:79]
  ds_read_b64_tr_b16 v[132:133], v146 offset:8192
  v_mfma_f32_16x16x32_bf16 v[76:79], a[188:191], v[140:143], v[76:79]
  ds_read_b64_tr_b16 v[134:135], v146 offset:8704
  s_waitcnt lgkmcnt(8)
  v_mfma_f32_16x16x32_bf16 v[16:19], a[192:195], v[112:115], v[16:19]
  ds_read_b64_tr_b16 v[136:137], v147 offset:0
  s_add_u32 m0, s94, 81920
  v_mfma_f32_16x16x32_bf16 v[16:19], a[196:199], v[116:119], v[16:19]
  ds_read_b64_tr_b16 v[138:139], v147 offset:512
  buffer_load_dwordx4 v2, s[8:11], s64 offen lds
  v_mfma_f32_16x16x32_bf16 v[20:23], a[200:203], v[112:115], v[20:23]
  ds_read_b64_tr_b16 v[140:141], v147 offset:8192
  v_add_u32 v148, 65536, v6
  v_mfma_f32_16x16x32_bf16 v[20:23], a[204:207], v[116:119], v[20:23]
  ds_read_b64_tr_b16 v[142:143], v147 offset:8704
  s_waitcnt lgkmcnt(8)
  v_mfma_f32_16x16x32_bf16 v[24:27], a[192:195], v[120:123], v[24:27]
  ds_read_b64_tr_b16 v[112:113], v144 offset:2048
  v_mfma_f32_16x16x32_bf16 v[24:27], a[196:199], v[124:127], v[24:27]
  ds_read_b64_tr_b16 v[114:115], v144 offset:2560
  buffer_load_dwordx4 v2, s[8:11], s64 offen offset:2048 lds
  v_mfma_f32_16x16x32_bf16 v[28:31], a[200:203], v[120:123], v[28:31]
  ds_read_b64_tr_b16 v[116:117], v144 offset:10240
  v_add_u32 v149, 65536, v7
  v_mfma_f32_16x16x32_bf16 v[28:31], a[204:207], v[124:127], v[28:31]
  ds_read_b64_tr_b16 v[118:119], v144 offset:10752
  s_waitcnt lgkmcnt(8)
  v_mfma_f32_16x16x32_bf16 v[32:35], a[192:195], v[128:131], v[32:35]
  ds_read_b64_tr_b16 v[120:121], v145 offset:2048
  s_add_u32 m0, s94, 82944
  v_mfma_f32_16x16x32_bf16 v[32:35], a[196:199], v[132:135], v[32:35]
  ds_read_b64_tr_b16 v[122:123], v145 offset:2560
  buffer_load_dwordx4 v3, s[8:11], s64 offen lds
  v_mfma_f32_16x16x32_bf16 v[36:39], a[200:203], v[128:131], v[36:39]
  ds_read_b64_tr_b16 v[124:125], v145 offset:10240
  v_add_u32 v150, 65536, v8
  v_mfma_f32_16x16x32_bf16 v[36:39], a[204:207], v[132:135], v[36:39]
  ds_read_b64_tr_b16 v[126:127], v145 offset:10752
  s_waitcnt lgkmcnt(8)
  v_mfma_f32_16x16x32_bf16 v[40:43], a[192:195], v[136:139], v[40:43]
  ds_read_b64_tr_b16 v[128:129], v146 offset:2048
  v_mfma_f32_16x16x32_bf16 v[40:43], a[196:199], v[140:143], v[40:43]
  ds_read_b64_tr_b16 v[130:131], v146 offset:2560
  v_mfma_f32_16x16x32_bf16 v[44:47], a[200:203], v[136:139], v[44:47]
  ds_read_b64_tr_b16 v[132:133], v146 offset:10240
  v_add_u32 v151, 65536, v9
  v_mfma_f32_16x16x32_bf16 v[44:47], a[204:207], v[140:143], v[44:47]
  ds_read_b64_tr_b16 v[134:135], v146 offset:10752
  s_waitcnt lgkmcnt(8)
  v_mfma_f32_16x16x32_bf16 v[48:51], a[192:195], v[112:115], v[48:51]
  ds_read_b64_tr_b16 v[136:137], v147 offset:2048
  v_mfma_f32_16x16x32_bf16 v[48:51], a[196:199], v[116:119], v[48:51]
  ds_read_b64_tr_b16 v[138:139], v147 offset:2560
  buffer_load_dwordx4 v3, s[8:11], s64 offen offset:2048 lds
  v_mfma_f32_16x16x32_bf16 v[52:55], a[200:203], v[112:115], v[52:55]
  ds_read_b64_tr_b16 v[140:141], v147 offset:10240
  v_mfma_f32_16x16x32_bf16 v[52:55], a[204:207], v[116:119], v[52:55]
  ds_read_b64_tr_b16 v[142:143], v147 offset:10752
  s_waitcnt lgkmcnt(8)
  v_mfma_f32_16x16x32_bf16 v[56:59], a[192:195], v[120:123], v[56:59]
  s_waitcnt vmcnt(8)
  s_barrier
  ds_read_b64_tr_b16 v[112:113], v148 offset:0
  v_mfma_f32_16x16x32_bf16 v[56:59], a[196:199], v[124:127], v[56:59]
  ds_read_b64_tr_b16 v[114:115], v148 offset:512
  buffer_load_dwordx4 a[240:243], v252, s[4:7], s49 offen sc1
  v_mfma_f32_16x16x32_bf16 v[60:63], a[200:203], v[120:123], v[60:63]
  ds_read_b64_tr_b16 v[116:117], v148 offset:8192
  v_mfma_f32_16x16x32_bf16 v[60:63], a[204:207], v[124:127], v[60:63]
  ds_read_b64_tr_b16 v[118:119], v148 offset:8704
  s_waitcnt lgkmcnt(8)
  v_mfma_f32_16x16x32_bf16 v[64:67], a[192:195], v[128:131], v[64:67]
  ds_read_b64_tr_b16 v[120:121], v149 offset:0
  v_mfma_f32_16x16x32_bf16 v[64:67], a[196:199], v[132:135], v[64:67]
  ds_read_b64_tr_b16 v[122:123], v149 offset:512
  buffer_load_dwordx4 a[244:247], v252, s[4:7], s49 offen offset:1024 sc1
  v_mfma_f32_16x16x32_bf16 v[68:71], a[200:203], v[128:131], v[68:71]
  ds_read_b64_tr_b16 v[124:125], v149 offset:8192
  v_mfma_f32_16x16x32_bf16 v[68:71], a[204:207], v[132:135], v[68:71]
  ds_read_b64_tr_b16 v[126:127], v149 offset:8704
  s_waitcnt lgkmcnt(8)
  v_mfma_f32_16x16x32_bf16 v[72:75], a[192:195], v[136:139], v[72:75]
  ds_read_b64_tr_b16 v[128:129], v150 offset:0
  v_mfma_f32_16x16x32_bf16 v[72:75], a[196:199], v[140:143], v[72:75]
  ds_read_b64_tr_b16 v[130:131], v150 offset:512
  v_mfma_f32_16x16x32_bf16 v[76:79], a[200:203], v[136:139], v[76:79]
  ds_read_b64_tr_b16 v[132:133], v150 offset:8192
  v_mfma_f32_16x16x32_bf16 v[76:79], a[204:207], v[140:143], v[76:79]
  ds_read_b64_tr_b16 v[134:135], v150 offset:8704
  s_waitcnt lgkmcnt(8)
  v_mfma_f32_16x16x32_bf16 v[16:19], a[208:211], v[112:115], v[16:19]
  ds_read_b64_tr_b16 v[136:137], v151 offset:0
  v_mfma_f32_16x16x32_bf16 v[16:19], a[212:215], v[116:119], v[16:19]
  ds_read_b64_tr_b16 v[138:139], v151 offset:512
  buffer_load_dwordx4 a[248:251], v253, s[4:7], s49 offen sc1
  v_mfma_f32_16x16x32_bf16 v[20:23], a[216:219], v[112:115], v[20:23]
  ds_read_b64_tr_b16 v[140:141], v151 offset:8192
  v_add_u32 v144, 81920, v6
  v_mfma_f32_16x16x32_bf16 v[20:23], a[220:223], v[116:119], v[20:23]
  ds_read_b64_tr_b16 v[142:143], v151 offset:8704
  s_waitcnt lgkmcnt(8)
  v_mfma_f32_16x16x32_bf16 v[24:27], a[208:211], v[120:123], v[24:27]
  ds_read_b64_tr_b16 v[112:113], v148 offset:2048
  v_mfma_f32_16x16x32_bf16 v[24:27], a[212:215], v[124:127], v[24:27]
  ds_read_b64_tr_b16 v[114:115], v148 offset:2560
  buffer_load_dwordx4 a[252:255], v253, s[4:7], s49 offen offset:1024 sc1
  v_mfma_f32_16x16x32_bf16 v[28:31], a[216:219], v[120:123], v[28:31]
  ds_read_b64_tr_b16 v[116:117], v148 offset:10240
  v_add_u32 v145, 81920, v7
  v_mfma_f32_16x16x32_bf16 v[28:31], a[220:223], v[124:127], v[28:31]
  ds_read_b64_tr_b16 v[118:119], v148 offset:10752
  s_waitcnt lgkmcnt(8)
  v_mfma_f32_16x16x32_bf16 v[32:35], a[208:211], v[128:131], v[32:35]
  ds_read_b64_tr_b16 v[120:121], v149 offset:2048
  s_add_u32 m0, s94, 98304
  v_mfma_f32_16x16x32_bf16 v[32:35], a[212:215], v[132:135], v[32:35]
  ds_read_b64_tr_b16 v[122:123], v149 offset:2560
  buffer_load_dwordx4 v2, s[8:11], s65 offen lds
  v_mfma_f32_16x16x32_bf16 v[36:39], a[216:219], v[128:131], v[36:39]
  ds_read_b64_tr_b16 v[124:125], v149 offset:10240
  v_add_u32 v146, 81920, v8
  v_mfma_f32_16x16x32_bf16 v[36:39], a[220:223], v[132:135], v[36:39]
  ds_read_b64_tr_b16 v[126:127], v149 offset:10752
  s_waitcnt lgkmcnt(8)
  v_mfma_f32_16x16x32_bf16 v[40:43], a[208:211], v[136:139], v[40:43]
  ds_read_b64_tr_b16 v[128:129], v150 offset:2048
  v_mfma_f32_16x16x32_bf16 v[40:43], a[212:215], v[140:143], v[40:43]
  ds_read_b64_tr_b16 v[130:131], v150 offset:2560
  v_mfma_f32_16x16x32_bf16 v[44:47], a[216:219], v[136:139], v[44:47]
  ds_read_b64_tr_b16 v[132:133], v150 offset:10240
  v_add_u32 v147, 81920, v9
  v_mfma_f32_16x16x32_bf16 v[44:47], a[220:223], v[140:143], v[44:47]
  ds_read_b64_tr_b16 v[134:135], v150 offset:10752
  s_waitcnt lgkmcnt(8)
  v_mfma_f32_16x16x32_bf16 v[48:51], a[208:211], v[112:115], v[48:51]
  ds_read_b64_tr_b16 v[136:137], v151 offset:2048
  v_mfma_f32_16x16x32_bf16 v[48:51], a[212:215], v[116:119], v[48:51]
  ds_read_b64_tr_b16 v[138:139], v151 offset:2560
  buffer_load_dwordx4 v2, s[8:11], s65 offen offset:2048 lds
  v_mfma_f32_16x16x32_bf16 v[52:55], a[216:219], v[112:115], v[52:55]
  ds_read_b64_tr_b16 v[140:141], v151 offset:10240
  v_mfma_f32_16x16x32_bf16 v[52:55], a[220:223], v[116:119], v[52:55]
  ds_read_b64_tr_b16 v[142:143], v151 offset:10752
  s_waitcnt lgkmcnt(8)
  v_mfma_f32_16x16x32_bf16 v[56:59], a[208:211], v[120:123], v[56:59]
  s_waitcnt vmcnt(6)
  s_barrier
  ds_read_b64_tr_b16 v[112:113], v144 offset:0
  s_add_u32 m0, s94, 99328
  v_mfma_f32_16x16x32_bf16 v[56:59], a[212:215], v[124:127], v[56:59]
  ds_read_b64_tr_b16 v[114:115], v144 offset:512
  buffer_load_dwordx4 v3, s[8:11], s65 offen lds
  v_mfma_f32_16x16x32_bf16 v[60:63], a[216:219], v[120:123], v[60:63]
  ds_read_b64_tr_b16 v[116:117], v144 offset:8192
  v_mfma_f32_16x16x32_bf16 v[60:63], a[220:223], v[124:127], v[60:63]
  ds_read_b64_tr_b16 v[118:119], v144 offset:8704
  s_waitcnt lgkmcnt(8)
  v_mfma_f32_16x16x32_bf16 v[64:67], a[208:211], v[128:131], v[64:67]
  ds_read_b64_tr_b16 v[120:121], v145 offset:0
  v_mfma_f32_16x16x32_bf16 v[64:67], a[212:215], v[132:135], v[64:67]
  ds_read_b64_tr_b16 v[122:123], v145 offset:512
  buffer_load_dwordx4 v3, s[8:11], s65 offen offset:2048 lds
  v_mfma_f32_16x16x32_bf16 v[68:71], a[216:219], v[128:131], v[68:71]
  ds_read_b64_tr_b16 v[124:125], v145 offset:8192
  v_mfma_f32_16x16x32_bf16 v[68:71], a[220:223], v[132:135], v[68:71]
  ds_read_b64_tr_b16 v[126:127], v145 offset:8704
  s_waitcnt lgkmcnt(8)
  v_mfma_f32_16x16x32_bf16 v[72:75], a[208:211], v[136:139], v[72:75]
  ds_read_b64_tr_b16 v[128:129], v146 offset:0
  v_mfma_f32_16x16x32_bf16 v[72:75], a[212:215], v[140:143], v[72:75]
  ds_read_b64_tr_b16 v[130:131], v146 offset:512
  v_mfma_f32_16x16x32_bf16 v[76:79], a[216:219], v[136:139], v[76:79]
  ds_read_b64_tr_b16 v[132:133], v146 offset:8192
  v_mfma_f32_16x16x32_bf16 v[76:79], a[220:223], v[140:143], v[76:79]
  ds_read_b64_tr_b16 v[134:135], v146 offset:8704
  s_waitcnt lgkmcnt(8)
  v_mfma_f32_16x16x32_bf16 v[16:19], a[224:227], v[112:115], v[16:19]
  ds_read_b64_tr_b16 v[136:137], v147 offset:0
  s_add_u32 m0, s94, 114688
  v_mfma_f32_16x16x32_bf16 v[16:19], a[228:231], v[116:119], v[16:19]
  ds_read_b64_tr_b16 v[138:139], v147 offset:512
  buffer_load_dwordx4 v4, s[8:11], s50 offen lds
  v_mfma_f32_16x16x32_bf16 v[20:23], a[232:235], v[112:115], v[20:23]
  ds_read_b64_tr_b16 v[140:141], v147 offset:8192
  v_add_u32 v148, 98304, v6
  v_mfma_f32_16x16x32_bf16 v[20:23], a[236:239], v[116:119], v[20:23]
  ds_read_b64_tr_b16 v[142:143], v147 offset:8704
  s_waitcnt lgkmcnt(8)
  v_mfma_f32_16x16x32_bf16 v[24:27], a[224:227], v[120:123], v[24:27]
  ds_read_b64_tr_b16 v[112:113], v144 offset:2048
  s_add_u32 m0, s94, 115712
  v_mfma_f32_16x16x32_bf16 v[24:27], a[228:231], v[124:127], v[24:27]
  ds_read_b64_tr_b16 v[114:115], v144 offset:2560
  buffer_load_dwordx4 v5, s[8:11], s50 offen lds
  v_mfma_f32_16x16x32_bf16 v[28:31], a[232:235], v[120:123], v[28:31]
  ds_read_b64_tr_b16 v[116:117], v144 offset:10240
  v_add_u32 v149, 98304, v7
  v_mfma_f32_16x16x32_bf16 v[28:31], a[236:239], v[124:127], v[28:31]
  ds_read_b64_tr_b16 v[118:119], v144 offset:10752
  s_waitcnt lgkmcnt(8)
  v_mfma_f32_16x16x32_bf16 v[32:35], a[224:227], v[128:131], v[32:35]
  ds_read_b64_tr_b16 v[120:121], v145 offset:2048
  s_add_u32 m0, s94, 116736
  v_mfma_f32_16x16x32_bf16 v[32:35], a[228:231], v[132:135], v[32:35]
  ds_read_b64_tr_b16 v[122:123], v145 offset:2560
  buffer_load_dwordx4 v4, s[8:11], s51 offen lds
  v_mfma_f32_16x16x32_bf16 v[36:39], a[232:235], v[128:131], v[36:39]
  ds_read_b64_tr_b16 v[124:125], v145 offset:10240
  v_add_u32 v150, 98304, v8
  v_mfma_f32_16x16x32_bf16 v[36:39], a[236:239], v[132:135], v[36:39]
  ds_read_b64_tr_b16 v[126:127], v145 offset:10752
  s_waitcnt lgkmcnt(8)
  v_mfma_f32_16x16x32_bf16 v[40:43], a[224:227], v[136:139], v[40:43]
  ds_read_b64_tr_b16 v[128:129], v146 offset:2048
  v_mfma_f32_16x16x32_bf16 v[40:43], a[228:231], v[140:143], v[40:43]
  ds_read_b64_tr_b16 v[130:131], v146 offset:2560
  v_mfma_f32_16x16x32_bf16 v[44:47], a[232:235], v[136:139], v[44:47]
  ds_read_b64_tr_b16 v[132:133], v146 offset:10240
  v_add_u32 v151, 98304, v9
  v_mfma_f32_16x16x32_bf16 v[44:47], a[236:239], v[140:143], v[44:47]
  ds_read_b64_tr_b16 v[134:135], v146 offset:10752
  s_waitcnt lgkmcnt(8)
  v_mfma_f32_16x16x32_bf16 v[48:51], a[224:227], v[112:115], v[48:51]
  ds_read_b64_tr_b16 v[136:137], v147 offset:2048
  s_add_u32 m0, s94, 117760
  v_mfma_f32_16x16x32_bf16 v[48:51], a[228:231], v[116:119], v[48:51]
  ds_read_b64_tr_b16 v[138:139], v147 offset:2560
  buffer_load_dwordx4 v5, s[8:11], s51 offen lds
  v_mfma_f32_16x16x32_bf16 v[52:55], a[232:235], v[112:115], v[52:55]
  ds_read_b64_tr_b16 v[140:141], v147 offset:10240
  v_mfma_f32_16x16x32_bf16 v[52:55], a[236:239], v[116:119], v[52:55]
  ds_read_b64_tr_b16 v[142:143], v147 offset:10752
  s_waitcnt lgkmcnt(8)
  v_mfma_f32_16x16x32_bf16 v[56:59], a[224:227], v[120:123], v[56:59]
  s_waitcnt vmcnt(4)
  s_barrier
  ds_read_b64_tr_b16 v[112:113], v148 offset:0
  s_add_u32 m0, s94, 131072
  v_mfma_f32_16x16x32_bf16 v[56:59], a[228:231], v[124:127], v[56:59]
  ds_read_b64_tr_b16 v[114:115], v148 offset:512
  buffer_load_dwordx4 v4, s[8:11], s52 offen lds
  v_mfma_f32_16x16x32_bf16 v[60:63], a[232:235], v[120:123], v[60:63]
  ds_read_b64_tr_b16 v[116:117], v148 offset:8192
  v_mfma_f32_16x16x32_bf16 v[60:63], a[236:239], v[124:127], v[60:63]
  ds_read_b64_tr_b16 v[118:119], v148 offset:8704
  s_waitcnt lgkmcnt(8)
  v_mfma_f32_16x16x32_bf16 v[64:67], a[224:227], v[128:131], v[64:67]
  ds_read_b64_tr_b16 v[120:121], v149 offset:0
  s_add_u32 m0, s94, 132096
  v_mfma_f32_16x16x32_bf16 v[64:67], a[228:231], v[132:135], v[64:67]
  ds_read_b64_tr_b16 v[122:123], v149 offset:512
  buffer_load_dwordx4 v5, s[8:11], s52 offen lds
  v_mfma_f32_16x16x32_bf16 v[68:71], a[232:235], v[128:131], v[68:71]
  ds_read_b64_tr_b16 v[124:125], v149 offset:8192
  v_mfma_f32_16x16x32_bf16 v[68:71], a[236:239], v[132:135], v[68:71]
  ds_read_b64_tr_b16 v[126:127], v149 offset:8704
  s_waitcnt lgkmcnt(8)
  v_mfma_f32_16x16x32_bf16 v[72:75], a[224:227], v[136:139], v[72:75]
  ds_read_b64_tr_b16 v[128:129], v150 offset:0
  v_mfma_f32_16x16x32_bf16 v[72:75], a[228:231], v[140:143], v[72:75]
  ds_read_b64_tr_b16 v[130:131], v150 offset:512
  v_mfma_f32_16x16x32_bf16 v[76:79], a[232:235], v[136:139], v[76:79]
  ds_read_b64_tr_b16 v[132:133], v150 offset:8192
  v_mfma_f32_16x16x32_bf16 v[76:79], a[236:239], v[140:143], v[76:79]
  ds_read_b64_tr_b16 v[134:135], v150 offset:8704
  s_waitcnt lgkmcnt(8)
  v_mfma_f32_16x16x32_bf16 v[16:19], a[240:243], v[112:115], v[16:19]
  ds_read_b64_tr_b16 v[136:137], v151 offset:0
  s_add_u32 m0, s94, 133120
  v_mfma_f32_16x16x32_bf16 v[16:19], a[244:247], v[116:119], v[16:19]
  ds_read_b64_tr_b16 v[138:139], v151 offset:512
  buffer_load_dwordx4 v4, s[8:11], s53 offen lds
  v_mfma_f32_16x16x32_bf16 v[20:23], a[248:251], v[112:115], v[20:23]
  ds_read_b64_tr_b16 v[140:141], v151 offset:8192
  v_add_u32 v144, 114688, v6
  v_mfma_f32_16x16x32_bf16 v[20:23], a[252:255], v[116:119], v[20:23]
  ds_read_b64_tr_b16 v[142:143], v151 offset:8704
  s_waitcnt lgkmcnt(8)
  v_mfma_f32_16x16x32_bf16 v[24:27], a[240:243], v[120:123], v[24:27]
  ds_read_b64_tr_b16 v[112:113], v148 offset:2048
  s_add_u32 m0, s94, 134144
  v_mfma_f32_16x16x32_bf16 v[24:27], a[244:247], v[124:127], v[24:27]
  ds_read_b64_tr_b16 v[114:115], v148 offset:2560
  buffer_load_dwordx4 v5, s[8:11], s53 offen lds
  v_mfma_f32_16x16x32_bf16 v[28:31], a[248:251], v[120:123], v[28:31]
  ds_read_b64_tr_b16 v[116:117], v148 offset:10240
  v_add_u32 v145, 114688, v7
  v_mfma_f32_16x16x32_bf16 v[28:31], a[252:255], v[124:127], v[28:31]
  ds_read_b64_tr_b16 v[118:119], v148 offset:10752
  s_waitcnt lgkmcnt(8)
  v_mfma_f32_16x16x32_bf16 v[32:35], a[240:243], v[128:131], v[32:35]
  ds_read_b64_tr_b16 v[120:121], v149 offset:2048
  s_add_u32 m0, s94, 0
  v_mfma_f32_16x16x32_bf16 v[32:35], a[244:247], v[132:135], v[32:35]
  ds_read_b64_tr_b16 v[122:123], v149 offset:2560
  buffer_load_dwordx4 v4, s[8:11], s54 offen lds
  v_mfma_f32_16x16x32_bf16 v[36:39], a[248:251], v[128:131], v[36:39]
  ds_read_b64_tr_b16 v[124:125], v149 offset:10240
  v_add_u32 v146, 114688, v8
  v_mfma_f32_16x16x32_bf16 v[36:39], a[252:255], v[132:135], v[36:39]
  ds_read_b64_tr_b16 v[126:127], v149 offset:10752
  s_waitcnt lgkmcnt(8)
  v_mfma_f32_16x16x32_bf16 v[40:43], a[240:243], v[136:139], v[40:43]
  ds_read_b64_tr_b16 v[128:129], v150 offset:2048
  v_mfma_f32_16x16x32_bf16 v[40:43], a[244:247], v[140:143], v[40:43]
  ds_read_b64_tr_b16 v[130:131], v150 offset:2560
  v_mfma_f32_16x16x32_bf16 v[44:47], a[248:251], v[136:139], v[44:47]
  ds_read_b64_tr_b16 v[132:133], v150 offset:10240
  v_add_u32 v147, 114688, v9
  v_mfma_f32_16x16x32_bf16 v[44:47], a[252:255], v[140:143], v[44:47]
  ds_read_b64_tr_b16 v[134:135], v150 offset:10752
  s_waitcnt lgkmcnt(8)
  v_mfma_f32_16x16x32_bf16 v[48:51], a[240:243], v[112:115], v[48:51]
  ds_read_b64_tr_b16 v[136:137], v151 offset:2048
  s_add_u32 m0, s94, 1024
  v_mfma_f32_16x16x32_bf16 v[48:51], a[244:247], v[116:119], v[48:51]
  ds_read_b64_tr_b16 v[138:139], v151 offset:2560
  buffer_load_dwordx4 v5, s[8:11], s54 offen lds
  v_mfma_f32_16x16x32_bf16 v[52:55], a[248:251], v[112:115], v[52:55]
  ds_read_b64_tr_b16 v[140:141], v151 offset:10240
  v_mfma_f32_16x16x32_bf16 v[52:55], a[252:255], v[116:119], v[52:55]
  ds_read_b64_tr_b16 v[142:143], v151 offset:10752
  s_waitcnt lgkmcnt(8)
  v_mfma_f32_16x16x32_bf16 v[56:59], a[240:243], v[120:123], v[56:59]
  s_waitcnt vmcnt(6)
  s_barrier
  ds_read_b64_tr_b16 v[112:113], v144 offset:0
  s_add_u32 m0, s94, 2048
  v_mfma_f32_16x16x32_bf16 v[56:59], a[244:247], v[124:127], v[56:59]
  ds_read_b64_tr_b16 v[114:115], v144 offset:512
  buffer_load_dwordx4 v4, s[8:11], s55 offen lds
  v_mfma_f32_16x16x32_bf16 v[60:63], a[248:251], v[120:123], v[60:63]
  ds_read_b64_tr_b16 v[116:117], v144 offset:8192
  v_mfma_f32_16x16x32_bf16 v[60:63], a[252:255], v[124:127], v[60:63]
  ds_read_b64_tr_b16 v[118:119], v144 offset:8704
  s_waitcnt lgkmcnt(8)
  v_mfma_f32_16x16x32_bf16 v[64:67], a[240:243], v[128:131], v[64:67]
  ds_read_b64_tr_b16 v[120:121], v145 offset:0
  s_add_u32 m0, s94, 3072
  v_mfma_f32_16x16x32_bf16 v[64:67], a[244:247], v[132:135], v[64:67]
  ds_read_b64_tr_b16 v[122:123], v145 offset:512
  buffer_load_dwordx4 v5, s[8:11], s55 offen lds
  v_mfma_f32_16x16x32_bf16 v[68:71], a[248:251], v[128:131], v[68:71]
  ds_read_b64_tr_b16 v[124:125], v145 offset:8192
  v_mfma_f32_16x16x32_bf16 v[68:71], a[252:255], v[132:135], v[68:71]
  ds_read_b64_tr_b16 v[126:127], v145 offset:8704
  s_waitcnt lgkmcnt(8)
  v_mfma_f32_16x16x32_bf16 v[72:75], a[240:243], v[136:139], v[72:75]
  ds_read_b64_tr_b16 v[128:129], v146 offset:0
  v_mfma_f32_16x16x32_bf16 v[72:75], a[244:247], v[140:143], v[72:75]
  ds_read_b64_tr_b16 v[130:131], v146 offset:512
  v_mfma_f32_16x16x32_bf16 v[76:79], a[248:251], v[136:139], v[76:79]
  ds_read_b64_tr_b16 v[132:133], v146 offset:8192
  v_mfma_f32_16x16x32_bf16 v[76:79], a[252:255], v[140:143], v[76:79]
  ds_read_b64_tr_b16 v[134:135], v146 offset:8704
  s_waitcnt lgkmcnt(8)
  v_mfma_f32_16x16x32_bf16 v[80:83], v[112:115], a[0:3], 0
  ds_read_b64_tr_b16 v[136:137], v147 offset:0
  s_add_u32 m0, s94, 16384
  v_mov_b32 v232, 0x3f803f80
  v_mov_b32 v233, 0x3f803f80
  v_mov_b32 v234, 0x3f803f80
  v_mov_b32 v235, 0x3f803f80
  v_mul_f32 v236, 0x3fb8aa3b, v16
  v_mul_f32 v237, 0x3fb8aa3b, v17
  v_mfma_f32_16x16x32_bf16 v[80:83], v[116:119], a[4:7], v[80:83]
  ds_read_b64_tr_b16 v[138:139], v147 offset:512
  buffer_load_dwordx4 v4, s[8:11], s56 offen lds
  v_mul_f32 v238, 0x3fb8aa3b, v18
  v_mul_f32 v239, 0x3fb8aa3b, v19
  v_mul_f32 v240, 0x3fb8aa3b, v20
  v_mul_f32 v241, 0x3fb8aa3b, v21
  v_mul_f32 v242, 0x3fb8aa3b, v22
  v_mul_f32 v243, 0x3fb8aa3b, v23
  v_mfma_f32_16x16x32_bf16 v[84:87], v[112:115], a[8:11], 0
  ds_read_b64_tr_b16 v[140:141], v147 offset:8192
  v_add_u32 v148, 131072, v6
  v_exp_f32 v236, v236 clamp
  v_exp_f32 v237, v237 clamp
  v_exp_f32 v238, v238 clamp
  v_exp_f32 v239, v239 clamp
  v_exp_f32 v240, v240 clamp
  v_exp_f32 v241, v241 clamp
  v_mfma_f32_16x16x32_bf16 v[84:87], v[116:119], a[12:15], v[84:87]
  ds_read_b64_tr_b16 v[142:143], v147 offset:8704
  v_exp_f32 v242, v242 clamp
  v_exp_f32 v243, v243 clamp
  v_add_f32 v236, 0x358637bd, v236
  v_add_f32 v237, 0x358637bd, v237
  v_add_f32 v238, 0x358637bd, v238
  v_add_f32 v239, 0x358637bd, v239
  s_waitcnt lgkmcnt(8)
  v_mfma_f32_16x16x32_bf16 v[88:91], v[120:123], a[0:3], 0
  ds_read_b64_tr_b16 v[112:113], v144 offset:2048
  s_add_u32 m0, s94, 17408
  v_add_f32 v240, 0x358637bd, v240
  v_add_f32 v241, 0x358637bd, v241
  v_add_f32 v242, 0x358637bd, v242
  v_add_f32 v243, 0x358637bd, v243
  v_add_f32 v16, v16, v236
  v_add_f32 v17, v17, v237
  v_mfma_f32_16x16x32_bf16 v[88:91], v[124:127], a[4:7], v[88:91]
  ds_read_b64_tr_b16 v[114:115], v144 offset:2560
  buffer_load_dwordx4 v5, s[8:11], s56 offen lds
  v_add_f32 v18, v18, v238
  v_add_f32 v19, v19, v239
  v_add_f32 v20, v20, v240
  v_add_f32 v21, v21, v241
  v_add_f32 v22, v22, v242
  v_add_f32 v23, v23, v243
  v_mfma_f32_16x16x32_bf16 v[92:95], v[120:123], a[8:11], 0
  ds_read_b64_tr_b16 v[116:117], v144 offset:10240
  v_add_u32 v149, 131072, v7
  v_max_f32 v16, v16, v236
  v_max_f32 v17, v17, v237
  v_max_f32 v18, v18, v238
  v_max_f32 v19, v19, v239
  v_max_f32 v20, v20, v240
  v_max_f32 v21, v21, v241
  v_mfma_f32_16x16x32_bf16 v[92:95], v[124:127], a[12:15], v[92:95]
  ds_read_b64_tr_b16 v[118:119], v144 offset:10752
  v_max_f32 v22, v22, v242
  v_max_f32 v23, v23, v243
  v_cvt_pk_bf16_f32 v152, v16, v17
  v_cvt_pk_bf16_f32 v153, v18, v19
  v_cvt_pk_bf16_f32 v154, v20, v21
  v_cvt_pk_bf16_f32 v155, v22, v23
  s_waitcnt lgkmcnt(8)
  v_mfma_f32_16x16x32_bf16 v[96:99], v[128:131], a[0:3], 0
  ds_read_b64_tr_b16 v[120:121], v145 offset:2048
  s_add_u32 m0, s94, 18432
  v_cvt_pk_bf16_f32 v168, v48, v49
  v_cvt_pk_bf16_f32 v169, v50, v51
  v_cvt_pk_bf16_f32 v170, v52, v53
  v_cvt_pk_bf16_f32 v171, v54, v55
  v_mul_f32 v236, 0x3fb8aa3b, v24
  v_mul_f32 v237, 0x3fb8aa3b, v25
  v_mfma_f32_16x16x32_bf16 v[96:99], v[132:135], a[4:7], v[96:99]
  ds_read_b64_tr_b16 v[122:123], v145 offset:2560
  buffer_load_dwordx4 v4, s[8:11], s57 offen lds
  v_mul_f32 v238, 0x3fb8aa3b, v26
  v_mul_f32 v239, 0x3fb8aa3b, v27
  v_mul_f32 v240, 0x3fb8aa3b, v28
  v_mul_f32 v241, 0x3fb8aa3b, v29
  v_mul_f32 v242, 0x3fb8aa3b, v30
  v_mul_f32 v243, 0x3fb8aa3b, v31
  v_mfma_f32_16x16x32_bf16 v[100:103], v[128:131], a[8:11], 0
  ds_read_b64_tr_b16 v[124:125], v145 offset:10240
  v_add_u32 v150, 131072, v8
  v_exp_f32 v236, v236 clamp
  v_exp_f32 v237, v237 clamp
  v_exp_f32 v238, v238 clamp
  v_exp_f32 v239, v239 clamp
  v_exp_f32 v240, v240 clamp
  v_exp_f32 v241, v241 clamp
  v_mfma_f32_16x16x32_bf16 v[100:103], v[132:135], a[12:15], v[100:103]
  ds_read_b64_tr_b16 v[126:127], v145 offset:10752
  v_exp_f32 v242, v242 clamp
  v_exp_f32 v243, v243 clamp
  v_add_f32 v236, 0x358637bd, v236
  v_add_f32 v237, 0x358637bd, v237
  v_add_f32 v238, 0x358637bd, v238
  v_add_f32 v239, 0x358637bd, v239
  s_waitcnt lgkmcnt(8)
  v_mfma_f32_16x16x32_bf16 v[104:107], v[136:139], a[0:3], 0
  ds_read_b64_tr_b16 v[128:129], v146 offset:2048
  v_add_f32 v240, 0x358637bd, v240
  v_add_f32 v241, 0x358637bd, v241
  v_add_f32 v242, 0x358637bd, v242
  v_add_f32 v243, 0x358637bd, v243
  v_add_f32 v24, v24, v236
  v_add_f32 v25, v25, v237
  v_mfma_f32_16x16x32_bf16 v[104:107], v[140:143], a[4:7], v[104:107]
  ds_read_b64_tr_b16 v[130:131], v146 offset:2560
  v_add_f32 v26, v26, v238
  v_add_f32 v27, v27, v239
  v_add_f32 v28, v28, v240
  v_add_f32 v29, v29, v241
  v_add_f32 v30, v30, v242
  v_add_f32 v31, v31, v243
  v_mfma_f32_16x16x32_bf16 v[108:111], v[136:139], a[8:11], 0
  ds_read_b64_tr_b16 v[132:133], v146 offset:10240
  v_add_u32 v151, 131072, v9
  v_max_f32 v24, v24, v236
  v_max_f32 v25, v25, v237
  v_max_f32 v26, v26, v238
  v_max_f32 v27, v27, v239
  v_max_f32 v28, v28, v240
  v_max_f32 v29, v29, v241
  v_mfma_f32_16x16x32_bf16 v[108:111], v[140:143], a[12:15], v[108:111]
  ds_read_b64_tr_b16 v[134:135], v146 offset:10752
  v_max_f32 v30, v30, v242
  v_max_f32 v31, v31, v243
  v_cvt_pk_bf16_f32 v156, v24, v25
  v_cvt_pk_bf16_f32 v157, v26, v27
  v_cvt_pk_bf16_f32 v158, v28, v29
  v_cvt_pk_bf16_f32 v159, v30, v31
  s_waitcnt lgkmcnt(8)
  v_mfma_f32_16x16x32_bf16 v[80:83], v[112:115], a[16:19], v[80:83]
  ds_read_b64_tr_b16 v[136:137], v147 offset:2048
  s_add_u32 m0, s94, 19456
  v_cvt_pk_bf16_f32 v172, v56, v57
  v_cvt_pk_bf16_f32 v173, v58, v59
  v_cvt_pk_bf16_f32 v174, v60, v61
  v_cvt_pk_bf16_f32 v175, v62, v63
  v_mul_f32 v236, 0x3fb8aa3b, v32
  v_mul_f32 v237, 0x3fb8aa3b, v33
  v_mfma_f32_16x16x32_bf16 v[80:83], v[116:119], a[20:23], v[80:83]
  ds_read_b64_tr_b16 v[138:139], v147 offset:2560
  buffer_load_dwordx4 v5, s[8:11], s57 offen lds
  v_mul_f32 v238, 0x3fb8aa3b, v34
  v_mul_f32 v239, 0x3fb8aa3b, v35
  v_mul_f32 v240, 0x3fb8aa3b, v36
  v_mul_f32 v241, 0x3fb8aa3b, v37
  v_mul_f32 v242, 0x3fb8aa3b, v38
  v_mul_f32 v243, 0x3fb8aa3b, v39
  v_mfma_f32_16x16x32_bf16 v[84:87], v[112:115], a[24:27], v[84:87]
  ds_read_b64_tr_b16 v[140:141], v147 offset:10240
  v_exp_f32 v236, v236 clamp
  v_exp_f32 v237, v237 clamp
  v_exp_f32 v238, v238 clamp
  v_exp_f32 v239, v239 clamp
  v_exp_f32 v240, v240 clamp
  v_exp_f32 v241, v241 clamp
  v_mfma_f32_16x16x32_bf16 v[84:87], v[116:119], a[28:31], v[84:87]
  ds_read_b64_tr_b16 v[142:143], v147 offset:10752
  v_exp_f32 v242, v242 clamp
  v_exp_f32 v243, v243 clamp
  v_add_f32 v236, 0x358637bd, v236
  v_add_f32 v237, 0x358637bd, v237
  v_add_f32 v238, 0x358637bd, v238
  v_add_f32 v239, 0x358637bd, v239
  s_waitcnt lgkmcnt(8)
  v_mfma_f32_16x16x32_bf16 v[88:91], v[120:123], a[16:19], v[88:91]
  s_waitcnt vmcnt(8)
  s_barrier
  ds_read_b64_tr_b16 v[112:113], v148 offset:0
  s_add_u32 m0, s94, 32768
  v_add_f32 v240, 0x358637bd, v240
  v_add_f32 v241, 0x358637bd, v241
  v_add_f32 v242, 0x358637bd, v242
  v_add_f32 v243, 0x358637bd, v243
  v_add_f32 v32, v32, v236
  v_add_f32 v33, v33, v237
  v_mfma_f32_16x16x32_bf16 v[88:91], v[124:127], a[20:23], v[88:91]
  ds_read_b64_tr_b16 v[114:115], v148 offset:512
  buffer_load_dwordx4 v4, s[8:11], s58 offen lds
  v_add_f32 v34, v34, v238
  v_add_f32 v35, v35, v239
  v_add_f32 v36, v36, v240
  v_add_f32 v37, v37, v241
  v_add_f32 v38, v38, v242
  v_add_f32 v39, v39, v243
  v_mfma_f32_16x16x32_bf16 v[92:95], v[120:123], a[24:27], v[92:95]
  ds_read_b64_tr_b16 v[116:117], v148 offset:8192
  v_max_f32 v32, v32, v236
  v_max_f32 v33, v33, v237
  v_max_f32 v34, v34, v238
  v_max_f32 v35, v35, v239
  v_max_f32 v36, v36, v240
  v_max_f32 v37, v37, v241
  v_mfma_f32_16x16x32_bf16 v[92:95], v[124:127], a[28:31], v[92:95]
  ds_read_b64_tr_b16 v[118:119], v148 offset:8704
  v_max_f32 v38, v38, v242
  v_max_f32 v39, v39, v243
  v_cvt_pk_bf16_f32 v160, v32, v33
  v_cvt_pk_bf16_f32 v161, v34, v35
  v_cvt_pk_bf16_f32 v162, v36, v37
  v_cvt_pk_bf16_f32 v163, v38, v39
  s_waitcnt lgkmcnt(8)
  v_mfma_f32_16x16x32_bf16 v[96:99], v[128:131], a[16:19], v[96:99]
  ds_read_b64_tr_b16 v[120:121], v149 offset:0
  s_add_u32 m0, s94, 33792
  v_cvt_pk_bf16_f32 v176, v64, v65
  v_cvt_pk_bf16_f32 v177, v66, v67
  v_cvt_pk_bf16_f32 v178, v68, v69
  v_cvt_pk_bf16_f32 v179, v70, v71
  v_mul_f32 v236, 0x3fb8aa3b, v40
  v_mul_f32 v237, 0x3fb8aa3b, v41
  v_mfma_f32_16x16x32_bf16 v[96:99], v[132:135], a[20:23], v[96:99]
  ds_read_b64_tr_b16 v[122:123], v149 offset:512
  buffer_load_dwordx4 v5, s[8:11], s58 offen lds
  v_mul_f32 v238, 0x3fb8aa3b, v42
  v_mul_f32 v239, 0x3fb8aa3b, v43
  v_mul_f32 v240, 0x3fb8aa3b, v44
  v_mul_f32 v241, 0x3fb8aa3b, v45
  v_mul_f32 v242, 0x3fb8aa3b, v46
  v_mul_f32 v243, 0x3fb8aa3b, v47
  v_mfma_f32_16x16x32_bf16 v[100:103], v[128:131], a[24:27], v[100:103]
  ds_read_b64_tr_b16 v[124:125], v149 offset:8192
  v_exp_f32 v236, v236 clamp
  v_exp_f32 v237, v237 clamp
  v_exp_f32 v238, v238 clamp
  v_exp_f32 v239, v239 clamp
  v_exp_f32 v240, v240 clamp
  v_exp_f32 v241, v241 clamp
  v_mfma_f32_16x16x32_bf16 v[100:103], v[132:135], a[28:31], v[100:103]
  ds_read_b64_tr_b16 v[126:127], v149 offset:8704
  v_exp_f32 v242, v242 clamp
  v_exp_f32 v243, v243 clamp
  v_add_f32 v236, 0x358637bd, v236
  v_add_f32 v237, 0x358637bd, v237
  v_add_f32 v238, 0x358637bd, v238
  v_add_f32 v239, 0x358637bd, v239
  s_waitcnt lgkmcnt(8)
  v_mfma_f32_16x16x32_bf16 v[104:107], v[136:139], a[16:19], v[104:107]
  ds_read_b64_tr_b16 v[128:129], v150 offset:0
  v_add_f32 v240, 0x358637bd, v240
  v_add_f32 v241, 0x358637bd, v241
  v_add_f32 v242, 0x358637bd, v242
  v_add_f32 v243, 0x358637bd, v243
  v_add_f32 v40, v40, v236
  v_add_f32 v41, v41, v237
  v_mfma_f32_16x16x32_bf16 v[104:107], v[140:143], a[20:23], v[104:107]
  ds_read_b64_tr_b16 v[130:131], v150 offset:512
  v_add_f32 v42, v42, v238
  v_add_f32 v43, v43, v239
  v_add_f32 v44, v44, v240
  v_add_f32 v45, v45, v241
  v_add_f32 v46, v46, v242
  v_add_f32 v47, v47, v243
  v_mfma_f32_16x16x32_bf16 v[108:111], v[136:139], a[24:27], v[108:111]
  ds_read_b64_tr_b16 v[132:133], v150 offset:8192
  v_max_f32 v40, v40, v236
  v_max_f32 v41, v41, v237
  v_max_f32 v42, v42, v238
  v_max_f32 v43, v43, v239
  v_max_f32 v44, v44, v240
  v_max_f32 v45, v45, v241
  v_mfma_f32_16x16x32_bf16 v[108:111], v[140:143], a[28:31], v[108:111]
  ds_read_b64_tr_b16 v[134:135], v150 offset:8704
  v_max_f32 v46, v46, v242
  v_max_f32 v47, v47, v243
  v_cvt_pk_bf16_f32 v164, v40, v41
  v_cvt_pk_bf16_f32 v165, v42, v43
  v_cvt_pk_bf16_f32 v166, v44, v45
  v_cvt_pk_bf16_f32 v167, v46, v47
  s_waitcnt lgkmcnt(8)
  v_mfma_f32_16x16x32_bf16 v[80:83], v[112:115], a[32:35], v[80:83]
  ds_read_b64_tr_b16 v[136:137], v151 offset:0
  s_add_u32 m0, s94, 34816
  v_cvt_pk_bf16_f32 v180, v72, v73
  v_cvt_pk_bf16_f32 v181, v74, v75
  v_cvt_pk_bf16_f32 v182, v76, v77
  v_cvt_pk_bf16_f32 v183, v78, v79
  s_and_b32 s79, s30, 1
  s_lshl_b32 s79, s79, 13
  s_lshr_b32 s80, s30, 1
  s_mul_i32 s80, s80, 65536
  s_add_u32 s79, s79, s80
  s_add_u32 s79, s79, 81920
  v_add_u32 v10, s79, v1
  v_mfma_f32_16x16x32_bf16 v[80:83], v[116:119], a[36:39], v[80:83]
  ds_read_b64_tr_b16 v[138:139], v151 offset:512
  buffer_load_dwordx4 v4, s[8:11], s59 offen lds
  v_lshrrev_b32 v11, 4, v0
  s_lshl_b32 s79, s30, 8
  s_add_u32 s79, s79, 98304
  v_lshl_add_u32 v11, v11, 4, s79
  v_mfma_f32_16x16x32_bf16 v[184:187], v[152:155], v[168:171], 0
  v_mfma_f32_16x16x32_bf16 v[188:191], v[156:159], v[168:171], 0
  v_mfma_f32_16x16x32_bf16 v[192:195], v[152:155], v[172:175], 0
  v_mfma_f32_16x16x32_bf16 v[84:87], v[112:115], a[40:43], v[84:87]
  ds_read_b64_tr_b16 v[140:141], v151 offset:8192
  v_add_u32 v144, 0, v6
  v_mfma_f32_16x16x32_bf16 v[196:199], v[156:159], v[172:175], 0
  v_mfma_f32_16x16x32_bf16 v[200:203], v[160:163], v[176:179], 0
  v_mfma_f32_16x16x32_bf16 v[204:207], v[164:167], v[176:179], 0
  v_mfma_f32_16x16x32_bf16 v[208:211], v[160:163], v[180:183], 0
  v_mfma_f32_16x16x32_bf16 v[212:215], v[164:167], v[180:183], 0
  v_mfma_f32_16x16x32_bf16 v[216:219], v[152:155], v[232:235], 0
  v_mfma_f32_16x16x32_bf16 v[84:87], v[116:119], a[44:47], v[84:87]
  ds_read_b64_tr_b16 v[142:143], v151 offset:8704
  v_mfma_f32_16x16x32_bf16 v[220:223], v[156:159], v[232:235], 0
  v_mfma_f32_16x16x32_bf16 v[224:227], v[160:163], v[232:235], 0
  v_mfma_f32_16x16x32_bf16 v[228:231], v[164:167], v[232:235], 0
  s_lshl_b32 s79, s30, 11
  v_add_u32 v14, s79, v1
  s_waitcnt lgkmcnt(8)
  v_mfma_f32_16x16x32_bf16 v[88:91], v[120:123], a[32:35], v[88:91]
  ds_read_b64_tr_b16 v[112:113], v148 offset:2048
  s_add_u32 m0, s94, 35840
  ds_write_b128 v10, v[184:187] offset:0
  ds_write_b128 v10, v[188:191] offset:1024
  ds_write_b128 v10, v[192:195] offset:2048
  ds_write_b128 v10, v[196:199] offset:3072
  ds_write_b128 v10, v[200:203] offset:4096
  ds_write_b128 v10, v[204:207] offset:5120
  v_mfma_f32_16x16x32_bf16 v[88:91], v[124:127], a[36:39], v[88:91]
  s_waitcnt lgkmcnt(12)
  ds_read_b64_tr_b16 v[114:115], v148 offset:2560
  buffer_load_dwordx4 v5, s[8:11], s59 offen lds
  ds_write_b128 v10, v[208:211] offset:6144
  ds_write_b128 v10, v[212:215] offset:7168
  s_mov_b32 exec_lo, 0x00010001
  s_mov_b32 exec_hi, 0x00010001
  s_waitcnt lgkmcnt(12)
  ds_write_b128 v11, v[216:219] offset:0
  ds_write_b128 v11, v[220:223] offset:64
  ds_write_b128 v11, v[224:227] offset:128
  s_waitcnt lgkmcnt(12)
  ds_write_b128 v11, v[228:231] offset:192
  s_mov_b64 exec, -1
  v_and_b32 v11, 15, v0
  v_lshlrev_b32 v11, 2, v11
  s_lshl_b32 s79, s30, 6
  s_add_u32 s79, s79, 98304
  v_mfma_f32_16x16x32_bf16 v[92:95], v[120:123], a[40:43], v[92:95]
  ds_read_b64_tr_b16 v[116:117], v148 offset:10240
  v_add_u32 v145, 0, v7
  v_add_u32 v12, s79, v11
  v_mfma_f32_16x16x32_bf16 v[92:95], v[124:127], a[44:47], v[92:95]
  ds_read_b64_tr_b16 v[118:119], v148 offset:10752
  v_mfma_f32_16x16x32_bf16 v[96:99], v[128:131], a[32:35], v[96:99]
  s_waitcnt lgkmcnt(12)
  ds_read_b64_tr_b16 v[120:121], v149 offset:2048
  s_add_u32 m0, s94, 49152
  s_waitcnt lgkmcnt(3)
  s_barrier
  v_add_u32 v13, 81920, v14
  ds_read_b128 v[16:19], v13 offset:0
  ds_read_b128 v[20:23], v13 offset:1024
  ds_read_b32 v48, v12 offset:0
  v_mfma_f32_16x16x32_bf16 v[96:99], v[132:135], a[36:39], v[96:99]
  ds_read_b64_tr_b16 v[122:123], v149 offset:2560
  buffer_load_dwordx4 v4, s[8:11], s60 offen lds
  v_add_u32 v13, 90112, v14
  ds_read_b128 v[24:27], v13 offset:0
  ds_read_b128 v[28:31], v13 offset:1024
  ds_read_b32 v49, v12 offset:256
  v_add_u32 v13, 147456, v14
  ds_read_b128 v[32:35], v13 offset:0
  v_mfma_f32_16x16x32_bf16 v[100:103], v[128:131], a[40:43], v[100:103]
  ds_read_b64_tr_b16 v[124:125], v149 offset:10240
  v_add_u32 v146, 0, v8
  ds_read_b128 v[36:39], v13 offset:1024
  ds_read_b32 v50, v12 offset:512
  v_add_u32 v13, 155648, v14
  ds_read_b128 v[40:43], v13 offset:0
  s_waitcnt lgkmcnt(12)
  ds_read_b128 v[44:47], v13 offset:1024
  ds_read_b32 v51, v12 offset:768
  v_mfma_f32_16x16x32_bf16 v[100:103], v[132:135], a[44:47], v[100:103]
  ds_read_b64_tr_b16 v[126:127], v149 offset:10752
  v_mfma_f32_16x16x32_bf16 v[104:107], v[136:139], a[32:35], v[104:107]
  s_waitcnt lgkmcnt(12)
  ds_read_b64_tr_b16 v[128:129], v150 offset:2048
  v_mfma_f32_16x16x32_bf16 v[104:107], v[140:143], a[36:39], v[104:107]
  ds_read_b64_tr_b16 v[130:131], v150 offset:2560
  s_waitcnt lgkmcnt(2)
  v_add_f32 v16, v16, v24
  v_add_f32 v32, v32, v40
  v_add_f32 v17, v17, v25
  v_add_f32 v33, v33, v41
  v_mfma_f32_16x16x32_bf16 v[108:111], v[136:139], a[40:43], v[108:111]
  ds_read_b64_tr_b16 v[132:133], v150 offset:10240
  v_add_u32 v147, 0, v9
  v_add_f32 v18, v18, v26
  v_add_f32 v34, v34, v42
  v_add_f32 v19, v19, v27
  v_add_f32 v35, v35, v43
  v_add_f32 v20, v20, v28
  v_add_f32 v36, v36, v44
  v_mfma_f32_16x16x32_bf16 v[108:111], v[140:143], a[44:47], v[108:111]
  ds_read_b64_tr_b16 v[134:135], v150 offset:10752
  v_add_f32 v21, v21, v29
  v_add_f32 v37, v37, v45
  v_add_f32 v22, v22, v30
  v_add_f32 v38, v38, v46
  v_add_f32 v23, v23, v31
  v_add_f32 v39, v39, v47
  s_mov_b32 s74, 61440
  buffer_load_dwordx4 v[244:247], v1, s[4:7], s74 offen sc1
  v_mfma_f32_16x16x32_bf16 v[80:83], v[112:115], a[48:51], v[80:83]
  ds_read_b64_tr_b16 v[136:137], v151 offset:2048
  s_add_u32 m0, s94, 50176
  v_add_f32 v48, v48, v49
  v_add_f32 v50, v50, v51
  v_add_f32 v16, v16, v32
  v_add_f32 v17, v17, v33
  v_add_f32 v18, v18, v34
  v_add_f32 v19, v19, v35
  v_mfma_f32_16x16x32_bf16 v[80:83], v[116:119], a[52:55], v[80:83]
  ds_read_b64_tr_b16 v[138:139], v151 offset:2560
  buffer_load_dwordx4 v5, s[8:11], s60 offen lds
  v_add_f32 v20, v20, v36
  v_add_f32 v21, v21, v37
  v_add_f32 v22, v22, v38
  v_add_f32 v23, v23, v39
  v_add_f32 v48, v48, v50
  v_cvt_pk_bf16_f32 v24, v16, v17
  v_mfma_f32_16x16x32_bf16 v[84:87], v[112:115], a[56:59], v[84:87]
  ds_read_b64_tr_b16 v[140:141], v151 offset:10240
  v_cvt_pk_bf16_f32 v25, v18, v19
  v_cvt_pk_bf16_f32 v26, v20, v21
  v_cvt_pk_bf16_f32 v27, v22, v23
  s_lshl_b32 s79, s29, 4
  s_add_u32 s79, s79, s28
  s_lshl_b32 s80, s79, 8
  s_lshl_b32 s81, s32, 16
  s_add_u32 s80, s80, s81
  s_lshl_b32 s81, s30, 6
  s_add_u32 s80, s80, s81
  s_add_u32 s80, s80, 4194304
  s_mov_b64 exec, 0xffff
  buffer_store_dword v48, v11, s[4:7], s80 offen sc1
  s_mov_b64 exec, -1
  s_lshl_b32 s80, s79, 12
  s_lshl_b32 s81, s30, 10
  s_add_u32 s80, s80, s81
  s_lshl_b32 s81, s32, 20
  s_add_u32 s80, s80, s81
  s_add_u32 s80, s80, 2097152
  buffer_store_dwordx4 v[24:27], v1, s[4:7], s80 offen sc1
  s_lshl_b32 s79, s32, 4
  s_add_u32 s79, s79, s29
  s_lshl_b32 s79, s79, 2
  s_add_u32 s79, s79, s30
  s_lshl_b32 s79, s79, 7
  s_add_u32 s82, s79, 20480
  s_lshl_b32 s83, s28, 2
  s_add_u32 s83, s83, s82
  v_mfma_f32_16x16x32_bf16 v[84:87], v[116:119], a[60:63], v[84:87]
  ds_read_b64_tr_b16 v[142:143], v151 offset:10752
  v_mfma_f32_16x16x32_bf16 v[88:91], v[120:123], a[48:51], v[88:91]
  s_waitcnt vmcnt(13)
  s_barrier
  ds_read_b64_tr_b16 v[112:113], v144 offset:0
  s_add_u32 m0, s94, 51200
  v_mfma_f32_16x16x32_bf16 v[88:91], v[124:127], a[52:55], v[88:91]
  ds_read_b64_tr_b16 v[114:115], v144 offset:512
  buffer_load_dwordx4 v4, s[8:11], s61 offen lds
  v_mfma_f32_16x16x32_bf16 v[92:95], v[120:123], a[56:59], v[92:95]
  ds_read_b64_tr_b16 v[116:117], v144 offset:8192
  v_mfma_f32_16x16x32_bf16 v[92:95], v[124:127], a[60:63], v[92:95]
  ds_read_b64_tr_b16 v[118:119], v144 offset:8704
  s_waitcnt lgkmcnt(8)
  v_mfma_f32_16x16x32_bf16 v[96:99], v[128:131], a[48:51], v[96:99]
  ds_read_b64_tr_b16 v[120:121], v145 offset:0
  s_add_u32 m0, s94, 52224
  v_mfma_f32_16x16x32_bf16 v[96:99], v[132:135], a[52:55], v[96:99]
  ds_read_b64_tr_b16 v[122:123], v145 offset:512
  buffer_load_dwordx4 v5, s[8:11], s61 offen lds
  v_mfma_f32_16x16x32_bf16 v[100:103], v[128:131], a[56:59], v[100:103]
  ds_read_b64_tr_b16 v[124:125], v145 offset:8192
  v_mfma_f32_16x16x32_bf16 v[100:103], v[132:135], a[60:63], v[100:103]
  ds_read_b64_tr_b16 v[126:127], v145 offset:8704
  s_waitcnt lgkmcnt(8)
  v_mfma_f32_16x16x32_bf16 v[104:107], v[136:139], a[48:51], v[104:107]
  ds_read_b64_tr_b16 v[128:129], v146 offset:0
  v_mfma_f32_16x16x32_bf16 v[104:107], v[140:143], a[52:55], v[104:107]
  ds_read_b64_tr_b16 v[130:131], v146 offset:512
  v_mfma_f32_16x16x32_bf16 v[108:111], v[136:139], a[56:59], v[108:111]
  ds_read_b64_tr_b16 v[132:133], v146 offset:8192
  v_mfma_f32_16x16x32_bf16 v[108:111], v[140:143], a[60:63], v[108:111]
  ds_read_b64_tr_b16 v[134:135], v146 offset:8704
  s_waitcnt lgkmcnt(8)
  v_mfma_f32_16x16x32_bf16 v[80:83], v[112:115], a[64:67], v[80:83]
  ds_read_b64_tr_b16 v[136:137], v147 offset:0
  s_add_u32 m0, s94, 65536
  v_mfma_f32_16x16x32_bf16 v[80:83], v[116:119], a[68:71], v[80:83]
  ds_read_b64_tr_b16 v[138:139], v147 offset:512
  buffer_load_dwordx4 v4, s[8:11], s62 offen lds
  v_mfma_f32_16x16x32_bf16 v[84:87], v[112:115], a[72:75], v[84:87]
  ds_read_b64_tr_b16 v[140:141], v147 offset:8192
  v_add_u32 v148, 16384, v6
  v_mfma_f32_16x16x32_bf16 v[84:87], v[116:119], a[76:79], v[84:87]
  ds_read_b64_tr_b16 v[142:143], v147 offset:8704
  s_waitcnt lgkmcnt(8)
  v_mfma_f32_16x16x32_bf16 v[88:91], v[120:123], a[64:67], v[88:91]
  ds_read_b64_tr_b16 v[112:113], v144 offset:2048
  s_add_u32 m0, s94, 66560
  v_mfma_f32_16x16x32_bf16 v[88:91], v[124:127], a[68:71], v[88:91]
  ds_read_b64_tr_b16 v[114:115], v144 offset:2560
  buffer_load_dwordx4 v5, s[8:11], s62 offen lds
  v_mfma_f32_16x16x32_bf16 v[92:95], v[120:123], a[72:75], v[92:95]
  ds_read_b64_tr_b16 v[116:117], v144 offset:10240
  v_add_u32 v149, 16384, v7
  v_mfma_f32_16x16x32_bf16 v[92:95], v[124:127], a[76:79], v[92:95]
  ds_read_b64_tr_b16 v[118:119], v144 offset:10752
  s_waitcnt lgkmcnt(8)
  v_mfma_f32_16x16x32_bf16 v[96:99], v[128:131], a[64:67], v[96:99]
  ds_read_b64_tr_b16 v[120:121], v145 offset:2048
  s_add_u32 m0, s94, 67584
  v_mfma_f32_16x16x32_bf16 v[96:99], v[132:135], a[68:71], v[96:99]
  ds_read_b64_tr_b16 v[122:123], v145 offset:2560
  buffer_load_dwordx4 v4, s[8:11], s63 offen lds
  v_mfma_f32_16x16x32_bf16 v[100:103], v[128:131], a[72:75], v[100:103]
  ds_read_b64_tr_b16 v[124:125], v145 offset:10240
  v_add_u32 v150, 16384, v8
  v_mfma_f32_16x16x32_bf16 v[100:103], v[132:135], a[76:79], v[100:103]
  ds_read_b64_tr_b16 v[126:127], v145 offset:10752
  s_waitcnt lgkmcnt(8)
  v_mfma_f32_16x16x32_bf16 v[104:107], v[136:139], a[64:67], v[104:107]
  ds_read_b64_tr_b16 v[128:129], v146 offset:2048
  v_mfma_f32_16x16x32_bf16 v[104:107], v[140:143], a[68:71], v[104:107]
  ds_read_b64_tr_b16 v[130:131], v146 offset:2560
  v_mfma_f32_16x16x32_bf16 v[108:111], v[136:139], a[72:75], v[108:111]
  ds_read_b64_tr_b16 v[132:133], v146 offset:10240
  v_add_u32 v151, 16384, v9
  v_mfma_f32_16x16x32_bf16 v[108:111], v[140:143], a[76:79], v[108:111]
  ds_read_b64_tr_b16 v[134:135], v146 offset:10752
  s_waitcnt lgkmcnt(8)
  v_mfma_f32_16x16x32_bf16 v[80:83], v[112:115], a[80:83], v[80:83]
  ds_read_b64_tr_b16 v[136:137], v147 offset:2048
  s_add_u32 m0, s94, 68608
  v_mfma_f32_16x16x32_bf16 v[80:83], v[116:119], a[84:87], v[80:83]
  ds_read_b64_tr_b16 v[138:139], v147 offset:2560
  buffer_load_dwordx4 v5, s[8:11], s63 offen lds
  v_mfma_f32_16x16x32_bf16 v[84:87], v[112:115], a[88:91], v[84:87]
  ds_read_b64_tr_b16 v[140:141], v147 offset:10240
  v_mfma_f32_16x16x32_bf16 v[84:87], v[116:119], a[92:95], v[84:87]
  ds_read_b64_tr_b16 v[142:143], v147 offset:10752
  s_waitcnt lgkmcnt(8)
  v_mfma_f32_16x16x32_bf16 v[88:91], v[120:123], a[80:83], v[88:91]
  s_waitcnt vmcnt(15)
  s_barrier
  ds_read_b64_tr_b16 v[112:113], v148 offset:0
  s_add_u32 m0, s94, 114688
  v_mfma_f32_16x16x32_bf16 v[88:91], v[124:127], a[84:87], v[88:91]
  ds_read_b64_tr_b16 v[114:115], v148 offset:512
  buffer_load_dwordx4 v4, s[8:11], s64 offen lds
  v_mfma_f32_16x16x32_bf16 v[92:95], v[120:123], a[88:91], v[92:95]
  ds_read_b64_tr_b16 v[116:117], v148 offset:8192
  v_mfma_f32_16x16x32_bf16 v[92:95], v[124:127], a[92:95], v[92:95]
  ds_read_b64_tr_b16 v[118:119], v148 offset:8704
  s_waitcnt lgkmcnt(8)
  v_mfma_f32_16x16x32_bf16 v[96:99], v[128:131], a[80:83], v[96:99]
  ds_read_b64_tr_b16 v[120:121], v149 offset:0
  s_add_u32 m0, s94, 115712
  v_mfma_f32_16x16x32_bf16 v[96:99], v[132:135], a[84:87], v[96:99]
  ds_read_b64_tr_b16 v[122:123], v149 offset:512
  buffer_load_dwordx4 v5, s[8:11], s64 offen lds
  v_mfma_f32_16x16x32_bf16 v[100:103], v[128:131], a[88:91], v[100:103]
  ds_read_b64_tr_b16 v[124:125], v149 offset:8192
  v_mfma_f32_16x16x32_bf16 v[100:103], v[132:135], a[92:95], v[100:103]
  ds_read_b64_tr_b16 v[126:127], v149 offset:8704
  s_waitcnt lgkmcnt(8)
  v_mfma_f32_16x16x32_bf16 v[104:107], v[136:139], a[80:83], v[104:107]
  ds_read_b64_tr_b16 v[128:129], v150 offset:0
  v_mfma_f32_16x16x32_bf16 v[104:107], v[140:143], a[84:87], v[104:107]
  ds_read_b64_tr_b16 v[130:131], v150 offset:512
  v_mfma_f32_16x16x32_bf16 v[108:111], v[136:139], a[88:91], v[108:111]
  ds_read_b64_tr_b16 v[132:133], v150 offset:8192
  v_mfma_f32_16x16x32_bf16 v[108:111], v[140:143], a[92:95], v[108:111]
  ds_read_b64_tr_b16 v[134:135], v150 offset:8704
  s_waitcnt lgkmcnt(8)
  v_mfma_f32_16x16x32_bf16 v[80:83], v[112:115], a[96:99], v[80:83]
  ds_read_b64_tr_b16 v[136:137], v151 offset:0
  s_add_u32 m0, s94, 116736
  v_mfma_f32_16x16x32_bf16 v[80:83], v[116:119], a[100:103], v[80:83]
  ds_read_b64_tr_b16 v[138:139], v151 offset:512
  buffer_load_dwordx4 v4, s[8:11], s65 offen lds
  v_mfma_f32_16x16x32_bf16 v[84:87], v[112:115], a[104:107], v[84:87]
  ds_read_b64_tr_b16 v[140:141], v151 offset:8192
  v_add_u32 v144, 32768, v6
  v_mfma_f32_16x16x32_bf16 v[84:87], v[116:119], a[108:111], v[84:87]
  ds_read_b64_tr_b16 v[142:143], v151 offset:8704
  s_waitcnt lgkmcnt(8)
  v_mfma_f32_16x16x32_bf16 v[88:91], v[120:123], a[96:99], v[88:91]
  ds_read_b64_tr_b16 v[112:113], v148 offset:2048
  s_add_u32 m0, s94, 117760
  v_mfma_f32_16x16x32_bf16 v[88:91], v[124:127], a[100:103], v[88:91]
  ds_read_b64_tr_b16 v[114:115], v148 offset:2560
  buffer_load_dwordx4 v5, s[8:11], s65 offen lds
  v_mfma_f32_16x16x32_bf16 v[92:95], v[120:123], a[104:107], v[92:95]
  ds_read_b64_tr_b16 v[116:117], v148 offset:10240
  v_add_u32 v145, 32768, v7
  v_mfma_f32_16x16x32_bf16 v[92:95], v[124:127], a[108:111], v[92:95]
  ds_read_b64_tr_b16 v[118:119], v148 offset:10752
  s_waitcnt lgkmcnt(8)
  v_mfma_f32_16x16x32_bf16 v[96:99], v[128:131], a[96:99], v[96:99]
  ds_read_b64_tr_b16 v[120:121], v149 offset:2048
  v_mfma_f32_16x16x32_bf16 v[96:99], v[132:135], a[100:103], v[96:99]
  ds_read_b64_tr_b16 v[122:123], v149 offset:2560
  v_mfma_f32_16x16x32_bf16 v[100:103], v[128:131], a[104:107], v[100:103]
  ds_read_b64_tr_b16 v[124:125], v149 offset:10240
  v_add_u32 v146, 32768, v8
  v_mfma_f32_16x16x32_bf16 v[100:103], v[132:135], a[108:111], v[100:103]
  ds_read_b64_tr_b16 v[126:127], v149 offset:10752
  s_waitcnt lgkmcnt(8)
  v_mfma_f32_16x16x32_bf16 v[104:107], v[136:139], a[96:99], v[104:107]
  ds_read_b64_tr_b16 v[128:129], v150 offset:2048
  v_mfma_f32_16x16x32_bf16 v[104:107], v[140:143], a[100:103], v[104:107]
  ds_read_b64_tr_b16 v[130:131], v150 offset:2560
  v_mfma_f32_16x16x32_bf16 v[108:111], v[136:139], a[104:107], v[108:111]
  ds_read_b64_tr_b16 v[132:133], v150 offset:10240
  v_add_u32 v147, 32768, v9
  v_mfma_f32_16x16x32_bf16 v[108:111], v[140:143], a[108:111], v[108:111]
  ds_read_b64_tr_b16 v[134:135], v150 offset:10752
  s_waitcnt vmcnt(13)
  s_mov_b32 s95, 131072
L_p0w_8:
  v_xor_b32 v244, s31, v244
  v_xor_b32 v245, s31, v245
  v_xor_b32 v246, s31, v246
  v_xor_b32 v247, s31, v247
  v_or3_b32 v244, v244, v245, v246
  v_or_b32 v244, v244, v247
  v_cmp_ne_u32 vcc, 0, v244
  s_cbranch_vccz L_p0w_8_ok
  buffer_load_dwordx4 v[244:247], v1, s[4:7], s74 offen sc1
  s_waitcnt vmcnt(0)
  s_sub_u32 s95, s95, 1
  s_cmp_lg_u32 s95, 0
  s_cbranch_scc1 L_p0w_8
L_p0w_8_ok:
  s_waitcnt lgkmcnt(8)
  v_mfma_f32_16x16x32_bf16 v[80:83], v[112:115], a[112:115], v[80:83]
  ds_read_b64_tr_b16 v[136:137], v151 offset:2048
  v_mfma_f32_16x16x32_bf16 v[80:83], v[116:119], a[116:119], v[80:83]
  ds_read_b64_tr_b16 v[138:139], v151 offset:2560
  v_mfma_f32_16x16x32_bf16 v[84:87], v[112:115], a[120:123], v[84:87]
  ds_read_b64_tr_b16 v[140:141], v151 offset:10240
  v_mfma_f32_16x16x32_bf16 v[84:87], v[116:119], a[124:127], v[84:87]
  ds_read_b64_tr_b16 v[142:143], v151 offset:10752
  s_waitcnt lgkmcnt(8)
  v_mfma_f32_16x16x32_bf16 v[88:91], v[120:123], a[112:115], v[88:91]
  s_barrier
  ds_read_b64_tr_b16 v[112:113], v144 offset:0
  s_waitcnt vmcnt(10)
  v_mov_b32 v10, s31
  v_mov_b32 v11, 0
  s_mov_b64 exec, 1
  buffer_store_dword v10, v11, s[4:7], s83 offen sc1
  s_mov_b64 exec, -1
  v_and_b32 v15, 15, v0
  v_lshlrev_b32 v15, 2, v15
  v_mfma_f32_16x16x32_bf16 v[88:91], v[124:127], a[116:119], v[88:91]
  ds_read_b64_tr_b16 v[114:115], v144 offset:512
  v_mfma_f32_16x16x32_bf16 v[92:95], v[120:123], a[120:123], v[92:95]
  ds_read_b64_tr_b16 v[116:117], v144 offset:8192
  v_mfma_f32_16x16x32_bf16 v[92:95], v[124:127], a[124:127], v[92:95]
  ds_read_b64_tr_b16 v[118:119], v144 offset:8704
  s_waitcnt lgkmcnt(8)
  v_mfma_f32_16x16x32_bf16 v[96:99], v[128:131], a[112:115], v[96:99]
  ds_read_b64_tr_b16 v[120:121], v145 offset:0
  s_add_u32 m0, s94, 0
  s_add_u32 s77, s76, s34
  v_mfma_f32_16x16x32_bf16 v[96:99], v[132:135], a[116:119], v[96:99]
  ds_read_b64_tr_b16 v[122:123], v145 offset:512
  buffer_load_dwordx4 v1, s[4:7], s77 offen sc1 lds
  v_mfma_f32_16x16x32_bf16 v[100:103], v[128:131], a[120:123], v[100:103]
  ds_read_b64_tr_b16 v[124:125], v145 offset:8192
  v_mfma_f32_16x16x32_bf16 v[100:103], v[132:135], a[124:127], v[100:103]
  ds_read_b64_tr_b16 v[126:127], v145 offset:8704
  s_waitcnt lgkmcnt(8)
  v_mfma_f32_16x16x32_bf16 v[104:107], v[136:139], a[112:115], v[104:107]
  ds_read_b64_tr_b16 v[128:129], v146 offset:0
  v_mfma_f32_16x16x32_bf16 v[104:107], v[140:143], a[116:119], v[104:107]
  ds_read_b64_tr_b16 v[130:131], v146 offset:512
  v_mfma_f32_16x16x32_bf16 v[108:111], v[136:139], a[120:123], v[108:111]
  ds_read_b64_tr_b16 v[132:133], v146 offset:8192
  v_mfma_f32_16x16x32_bf16 v[108:111], v[140:143], a[124:127], v[108:111]
  ds_read_b64_tr_b16 v[134:135], v146 offset:8704
  s_waitcnt lgkmcnt(8)
  v_mfma_f32_16x16x32_bf16 v[80:83], v[112:115], a[128:131], v[80:83]
  ds_read_b64_tr_b16 v[136:137], v147 offset:0
  v_mfma_f32_16x16x32_bf16 v[80:83], v[116:119], a[132:135], v[80:83]
  ds_read_b64_tr_b16 v[138:139], v147 offset:512
  buffer_load_dwordx4 v1, s[4:7], s77 offen offset:1024 sc1 lds
  v_mfma_f32_16x16x32_bf16 v[84:87], v[112:115], a[136:139], v[84:87]
  ds_read_b64_tr_b16 v[140:141], v147 offset:8192
  v_add_u32 v148, 49152, v6
  v_mfma_f32_16x16x32_bf16 v[84:87], v[116:119], a[140:143], v[84:87]
  ds_read_b64_tr_b16 v[142:143], v147 offset:8704
  s_waitcnt lgkmcnt(8)
  v_mfma_f32_16x16x32_bf16 v[88:91], v[120:123], a[128:131], v[88:91]
  ds_read_b64_tr_b16 v[112:113], v144 offset:2048
  s_add_u32 m0, s94, 2048
  s_add_u32 s77, s76, s35
  v_mfma_f32_16x16x32_bf16 v[88:91], v[124:127], a[132:135], v[88:91]
  ds_read_b64_tr_b16 v[114:115], v144 offset:2560
  buffer_load_dwordx4 v1, s[4:7], s77 offen sc1 lds
  v_mfma_f32_16x16x32_bf16 v[92:95], v[120:123], a[136:139], v[92:95]
  ds_read_b64_tr_b16 v[116:117], v144 offset:10240
  v_add_u32 v149, 49152, v7
  v_mfma_f32_16x16x32_bf16 v[92:95], v[124:127], a[140:143], v[92:95]
  ds_read_b64_tr_b16 v[118:119], v144 offset:10752
  s_waitcnt lgkmcnt(8)
  v_mfma_f32_16x16x32_bf16 v[96:99], v[128:131], a[128:131], v[96:99]
  ds_read_b64_tr_b16 v[120:121], v145 offset:2048
  v_mfma_f32_16x16x32_bf16 v[96:99], v[132:135], a[132:135], v[96:99]
  ds_read_b64_tr_b16 v[122:123], v145 offset:2560
  buffer_load_dwordx4 v1, s[4:7], s77 offen offset:1024 sc1 lds
  v_mfma_f32_16x16x32_bf16 v[100:103], v[128:131], a[136:139], v[100:103]
  ds_read_b64_tr_b16 v[124:125], v145 offset:10240
  v_add_u32 v150, 49152, v8
  v_mfma_f32_16x16x32_bf16 v[100:103], v[132:135], a[140:143], v[100:103]
  ds_read_b64_tr_b16 v[126:127], v145 offset:10752
  s_waitcnt lgkmcnt(8)
  v_mfma_f32_16x16x32_bf16 v[104:107], v[136:139], a[128:131], v[104:107]
  ds_read_b64_tr_b16 v[128:129], v146 offset:2048
  v_mfma_f32_16x16x32_bf16 v[104:107], v[140:143], a[132:135], v[104:107]
  ds_read_b64_tr_b16 v[130:131], v146 offset:2560
  v_mfma_f32_16x16x32_bf16 v[108:111], v[136:139], a[136:139], v[108:111]
  ds_read_b64_tr_b16 v[132:133], v146 offset:10240
  v_add_u32 v151, 49152, v9
  v_mfma_f32_16x16x32_bf16 v[108:111], v[140:143], a[140:143], v[108:111]
  ds_read_b64_tr_b16 v[134:135], v146 offset:10752
  s_waitcnt lgkmcnt(8)
  v_mfma_f32_16x16x32_bf16 v[80:83], v[112:115], a[144:147], v[80:83]
  ds_read_b64_tr_b16 v[136:137], v147 offset:2048
  v_mfma_f32_16x16x32_bf16 v[80:83], v[116:119], a[148:151], v[80:83]
  ds_read_b64_tr_b16 v[138:139], v147 offset:2560
  v_mfma_f32_16x16x32_bf16 v[84:87], v[112:115], a[152:155], v[84:87]
  ds_read_b64_tr_b16 v[140:141], v147 offset:10240
  v_mfma_f32_16x16x32_bf16 v[84:87], v[116:119], a[156:159], v[84:87]
  ds_read_b64_tr_b16 v[142:143], v147 offset:10752
  s_waitcnt lgkmcnt(8)
  v_mfma_f32_16x16x32_bf16 v[88:91], v[120:123], a[144:147], v[88:91]
  s_waitcnt vmcnt(12)
  s_barrier
  ds_read_b64_tr_b16 v[112:113], v148 offset:0
  v_mfma_f32_16x16x32_bf16 v[88:91], v[124:127], a[148:151], v[88:91]
  ds_read_b64_tr_b16 v[114:115], v148 offset:512
  v_mfma_f32_16x16x32_bf16 v[92:95], v[120:123], a[152:155], v[92:95]
  ds_read_b64_tr_b16 v[116:117], v148 offset:8192
  v_mfma_f32_16x16x32_bf16 v[92:95], v[124:127], a[156:159], v[92:95]
  ds_read_b64_tr_b16 v[118:119], v148 offset:8704
  s_waitcnt lgkmcnt(8)
  v_mfma_f32_16x16x32_bf16 v[96:99], v[128:131], a[144:147], v[96:99]
  ds_read_b64_tr_b16 v[120:121], v149 offset:0
  s_add_u32 m0, s94, 16384
  s_add_u32 s77, s76, s36
  v_mfma_f32_16x16x32_bf16 v[96:99], v[132:135], a[148:151], v[96:99]
  ds_read_b64_tr_b16 v[122:123], v149 offset:512
  buffer_load_dwordx4 v1, s[4:7], s77 offen sc1 lds
  v_mfma_f32_16x16x32_bf16 v[100:103], v[128:131], a[152:155], v[100:103]
  ds_read_b64_tr_b16 v[124:125], v149 offset:8192
  v_mfma_f32_16x16x32_bf16 v[100:103], v[132:135], a[156:159], v[100:103]
  ds_read_b64_tr_b16 v[126:127], v149 offset:8704
  s_waitcnt lgkmcnt(8)
  v_mfma_f32_16x16x32_bf16 v[104:107], v[136:139], a[144:147], v[104:107]
  ds_read_b64_tr_b16 v[128:129], v150 offset:0
  v_mfma_f32_16x16x32_bf16 v[104:107], v[140:143], a[148:151], v[104:107]
  ds_read_b64_tr_b16 v[130:131], v150 offset:512
  v_mfma_f32_16x16x32_bf16 v[108:111], v[136:139], a[152:155], v[108:111]
  ds_read_b64_tr_b16 v[132:133], v150 offset:8192
  v_mfma_f32_16x16x32_bf16 v[108:111], v[140:143], a[156:159], v[108:111]
  ds_read_b64_tr_b16 v[134:135], v150 offset:8704
  s_waitcnt lgkmcnt(8)
  v_mfma_f32_16x16x32_bf16 v[80:83], v[112:115], a[160:163], v[80:83]
  ds_read_b64_tr_b16 v[136:137], v151 offset:0
  v_mfma_f32_16x16x32_bf16 v[80:83], v[116:119], a[164:167], v[80:83]
  ds_read_b64_tr_b16 v[138:139], v151 offset:512
  buffer_load_dwordx4 v1, s[4:7], s77 offen offset:1024 sc1 lds
  v_mfma_f32_16x16x32_bf16 v[84:87], v[112:115], a[168:171], v[84:87]
  ds_read_b64_tr_b16 v[140:141], v151 offset:8192
  v_add_u32 v144, 65536, v6
  v_mfma_f32_16x16x32_bf16 v[84:87], v[116:119], a[172:175], v[84:87]
  ds_read_b64_tr_b16 v[142:143], v151 offset:8704
  s_waitcnt lgkmcnt(8)
  v_mfma_f32_16x16x32_bf16 v[88:91], v[120:123], a[160:163], v[88:91]
  ds_read_b64_tr_b16 v[112:113], v148 offset:2048
  s_add_u32 m0, s94, 18432
  s_add_u32 s77, s76, s37
  v_mfma_f32_16x16x32_bf16 v[88:91], v[124:127], a[164:167], v[88:91]
  ds_read_b64_tr_b16 v[114:115], v148 offset:2560
  buffer_load_dwordx4 v1, s[4:7], s77 offen sc1 lds
  v_mfma_f32_16x16x32_bf16 v[92:95], v[120:123], a[168:171], v[92:95]
  ds_read_b64_tr_b16 v[116:117], v148 offset:10240
  v_add_u32 v145, 65536, v7
  v_mfma_f32_16x16x32_bf16 v[92:95], v[124:127], a[172:175], v[92:95]
  ds_read_b64_tr_b16 v[118:119], v148 offset:10752
  s_waitcnt lgkmcnt(8)
  v_mfma_f32_16x16x32_bf16 v[96:99], v[128:131], a[160:163], v[96:99]
  ds_read_b64_tr_b16 v[120:121], v149 offset:2048
  v_mfma_f32_16x16x32_bf16 v[96:99], v[132:135], a[164:167], v[96:99]
  ds_read_b64_tr_b16 v[122:123], v149 offset:2560
  buffer_load_dwordx4 v1, s[4:7], s77 offen offset:1024 sc1 lds
  v_mfma_f32_16x16x32_bf16 v[100:103], v[128:131], a[168:171], v[100:103]
  ds_read_b64_tr_b16 v[124:125], v149 offset:10240
  v_add_u32 v146, 65536, v8
  v_mfma_f32_16x16x32_bf16 v[100:103], v[132:135], a[172:175], v[100:103]
  ds_read_b64_tr_b16 v[126:127], v149 offset:10752
  s_waitcnt lgkmcnt(8)
  v_mfma_f32_16x16x32_bf16 v[104:107], v[136:139], a[160:163], v[104:107]
  ds_read_b64_tr_b16 v[128:129], v150 offset:2048
  v_mfma_f32_16x16x32_bf16 v[104:107], v[140:143], a[164:167], v[104:107]
  ds_read_b64_tr_b16 v[130:131], v150 offset:2560
  v_mfma_f32_16x16x32_bf16 v[108:111], v[136:139], a[168:171], v[108:111]
  ds_read_b64_tr_b16 v[132:133], v150 offset:10240
  v_add_u32 v147, 65536, v9
  v_mfma_f32_16x16x32_bf16 v[108:111], v[140:143], a[172:175], v[108:111]
  ds_read_b64_tr_b16 v[134:135], v150 offset:10752
  s_waitcnt lgkmcnt(8)
  v_mfma_f32_16x16x32_bf16 v[80:83], v[112:115], a[176:179], v[80:83]
  ds_read_b64_tr_b16 v[136:137], v151 offset:2048
  s_add_u32 m0, s94, 81920
  s_add_u32 s77, s76, s42
  v_mfma_f32_16x16x32_bf16 v[80:83], v[116:119], a[180:183], v[80:83]
  ds_read_b64_tr_b16 v[138:139], v151 offset:2560
  buffer_load_dwordx4 v1, s[4:7], s77 offen sc1 lds
  v_mfma_f32_16x16x32_bf16 v[84:87], v[112:115], a[184:187], v[84:87]
  ds_read_b64_tr_b16 v[140:141], v151 offset:10240
  v_mfma_f32_16x16x32_bf16 v[84:87], v[116:119], a[188:191], v[84:87]
  ds_read_b64_tr_b16 v[142:143], v151 offset:10752
  s_waitcnt lgkmcnt(8)
  v_mfma_f32_16x16x32_bf16 v[88:91], v[120:123], a[176:179], v[88:91]
  s_waitcnt vmcnt(13)
  s_barrier
  ds_read_b64_tr_b16 v[112:113], v144 offset:0
  v_mfma_f32_16x16x32_bf16 v[88:91], v[124:127], a[180:183], v[88:91]
  ds_read_b64_tr_b16 v[114:115], v144 offset:512
  buffer_load_dwordx4 v1, s[4:7], s77 offen offset:1024 sc1 lds
  v_mfma_f32_16x16x32_bf16 v[92:95], v[120:123], a[184:187], v[92:95]
  ds_read_b64_tr_b16 v[116:117], v144 offset:8192
  v_mfma_f32_16x16x32_bf16 v[92:95], v[124:127], a[188:191], v[92:95]
  ds_read_b64_tr_b16 v[118:119], v144 offset:8704
  s_waitcnt lgkmcnt(8)
  v_mfma_f32_16x16x32_bf16 v[96:99], v[128:131], a[176:179], v[96:99]
  ds_read_b64_tr_b16 v[120:121], v145 offset:0
  s_add_u32 m0, s94, 83968
  s_add_u32 s77, s76, s43
  v_mfma_f32_16x16x32_bf16 v[96:99], v[132:135], a[180:183], v[96:99]
  ds_read_b64_tr_b16 v[122:123], v145 offset:512
  buffer_load_dwordx4 v1, s[4:7], s77 offen sc1 lds
  v_mfma_f32_16x16x32_bf16 v[100:103], v[128:131], a[184:187], v[100:103]
  ds_read_b64_tr_b16 v[124:125], v145 offset:8192
  v_mfma_f32_16x16x32_bf16 v[100:103], v[132:135], a[188:191], v[100:103]
  ds_read_b64_tr_b16 v[126:127], v145 offset:8704
  s_waitcnt lgkmcnt(8)
  v_mfma_f32_16x16x32_bf16 v[104:107], v[136:139], a[176:179], v[104:107]
  ds_read_b64_tr_b16 v[128:129], v146 offset:0
  v_mfma_f32_16x16x32_bf16 v[104:107], v[140:143], a[180:183], v[104:107]
  ds_read_b64_tr_b16 v[130:131], v146 offset:512
  v_mfma_f32_16x16x32_bf16 v[108:111], v[136:139], a[184:187], v[108:111]
  ds_read_b64_tr_b16 v[132:133], v146 offset:8192
  v_mfma_f32_16x16x32_bf16 v[108:111], v[140:143], a[188:191], v[108:111]
  ds_read_b64_tr_b16 v[134:135], v146 offset:8704
  s_waitcnt lgkmcnt(8)
  v_mfma_f32_16x16x32_bf16 v[80:83], v[112:115], a[192:195], v[80:83]
  ds_read_b64_tr_b16 v[136:137], v147 offset:0
  v_mfma_f32_16x16x32_bf16 v[80:83], v[116:119], a[196:199], v[80:83]
  ds_read_b64_tr_b16 v[138:139], v147 offset:512
  buffer_load_dwordx4 v1, s[4:7], s77 offen offset:1024 sc1 lds
  v_mfma_f32_16x16x32_bf16 v[84:87], v[112:115], a[200:203], v[84:87]
  ds_read_b64_tr_b16 v[140:141], v147 offset:8192
  v_add_u32 v148, 114688, v6
  v_mfma_f32_16x16x32_bf16 v[84:87], v[116:119], a[204:207], v[84:87]
  ds_read_b64_tr_b16 v[142:143], v147 offset:8704
  s_waitcnt lgkmcnt(8)
  v_mfma_f32_16x16x32_bf16 v[88:91], v[120:123], a[192:195], v[88:91]
  ds_read_b64_tr_b16 v[112:113], v144 offset:2048
  s_add_u32 m0, s94, 98304
  s_add_u32 s77, s76, s44
  v_mfma_f32_16x16x32_bf16 v[88:91], v[124:127], a[196:199], v[88:91]
  ds_read_b64_tr_b16 v[114:115], v144 offset:2560
  buffer_load_dwordx4 v1, s[4:7], s77 offen sc1 lds
  v_mfma_f32_16x16x32_bf16 v[92:95], v[120:123], a[200:203], v[92:95]
  ds_read_b64_tr_b16 v[116:117], v144 offset:10240
  v_add_u32 v149, 114688, v7
  v_mfma_f32_16x16x32_bf16 v[92:95], v[124:127], a[204:207], v[92:95]
  ds_read_b64_tr_b16 v[118:119], v144 offset:10752
  s_waitcnt lgkmcnt(8)
  v_mfma_f32_16x16x32_bf16 v[96:99], v[128:131], a[192:195], v[96:99]
  ds_read_b64_tr_b16 v[120:121], v145 offset:2048
  v_mfma_f32_16x16x32_bf16 v[96:99], v[132:135], a[196:199], v[96:99]
  ds_read_b64_tr_b16 v[122:123], v145 offset:2560
  buffer_load_dwordx4 v1, s[4:7], s77 offen offset:1024 sc1 lds
  v_mfma_f32_16x16x32_bf16 v[100:103], v[128:131], a[200:203], v[100:103]
  ds_read_b64_tr_b16 v[124:125], v145 offset:10240
  v_add_u32 v150, 114688, v8
  v_mfma_f32_16x16x32_bf16 v[100:103], v[132:135], a[204:207], v[100:103]
  ds_read_b64_tr_b16 v[126:127], v145 offset:10752
  s_waitcnt lgkmcnt(8)
  v_mfma_f32_16x16x32_bf16 v[104:107], v[136:139], a[192:195], v[104:107]
  ds_read_b64_tr_b16 v[128:129], v146 offset:2048
  v_mfma_f32_16x16x32_bf16 v[104:107], v[140:143], a[196:199], v[104:107]
  ds_read_b64_tr_b16 v[130:131], v146 offset:2560
  v_mfma_f32_16x16x32_bf16 v[108:111], v[136:139], a[200:203], v[108:111]
  ds_read_b64_tr_b16 v[132:133], v146 offset:10240
  v_add_u32 v151, 114688, v9
  v_mfma_f32_16x16x32_bf16 v[108:111], v[140:143], a[204:207], v[108:111]
  ds_read_b64_tr_b16 v[134:135], v146 offset:10752
  s_waitcnt lgkmcnt(8)
  v_mfma_f32_16x16x32_bf16 v[80:83], v[112:115], a[208:211], v[80:83]
  ds_read_b64_tr_b16 v[136:137], v147 offset:2048
  s_add_u32 m0, s94, 100352
  s_add_u32 s77, s76, s45
  buffer_load_dword v14, v15, s[4:7], s82 offen sc1
  v_mfma_f32_16x16x32_bf16 v[80:83], v[116:119], a[212:215], v[80:83]
  ds_read_b64_tr_b16 v[138:139], v147 offset:2560
  buffer_load_dwordx4 v1, s[4:7], s77 offen sc1 lds
  v_mfma_f32_16x16x32_bf16 v[84:87], v[112:115], a[216:219], v[84:87]
  ds_read_b64_tr_b16 v[140:141], v147 offset:10240
  v_mfma_f32_16x16x32_bf16 v[84:87], v[116:119], a[220:223], v[84:87]
  ds_read_b64_tr_b16 v[142:143], v147 offset:10752
  s_waitcnt lgkmcnt(8)
  v_mfma_f32_16x16x32_bf16 v[88:91], v[120:123], a[208:211], v[88:91]
  s_waitcnt vmcnt(16)
  s_barrier
  ds_read_b64_tr_b16 v[112:113], v148 offset:0
  v_mfma_f32_16x16x32_bf16 v[88:91], v[124:127], a[212:215], v[88:91]
  ds_read_b64_tr_b16 v[114:115], v148 offset:512
  buffer_load_dwordx4 v1, s[4:7], s77 offen offset:1024 sc1 lds
  v_mfma_f32_16x16x32_bf16 v[92:95], v[120:123], a[216:219], v[92:95]
  ds_read_b64_tr_b16 v[116:117], v148 offset:8192
  v_mfma_f32_16x16x32_bf16 v[92:95], v[124:127], a[220:223], v[92:95]
  ds_read_b64_tr_b16 v[118:119], v148 offset:8704
  s_waitcnt lgkmcnt(8)
  v_mfma_f32_16x16x32_bf16 v[96:99], v[128:131], a[208:211], v[96:99]
  ds_read_b64_tr_b16 v[120:121], v149 offset:0
  s_add_u32 m0, s94, 32768
  s_add_u32 s77, s76, s38
  v_mfma_f32_16x16x32_bf16 v[96:99], v[132:135], a[212:215], v[96:99]
  ds_read_b64_tr_b16 v[122:123], v149 offset:512
  buffer_load_dwordx4 v1, s[4:7], s77 offen sc1 lds
  v_mfma_f32_16x16x32_bf16 v[100:103], v[128:131], a[216:219], v[100:103]
  ds_read_b64_tr_b16 v[124:125], v149 offset:8192
  v_mfma_f32_16x16x32_bf16 v[100:103], v[132:135], a[220:223], v[100:103]
  ds_read_b64_tr_b16 v[126:127], v149 offset:8704
  s_waitcnt lgkmcnt(8)
  v_mfma_f32_16x16x32_bf16 v[104:107], v[136:139], a[208:211], v[104:107]
  ds_read_b64_tr_b16 v[128:129], v150 offset:0
  v_mfma_f32_16x16x32_bf16 v[104:107], v[140:143], a[212:215], v[104:107]
  ds_read_b64_tr_b16 v[130:131], v150 offset:512
  v_mfma_f32_16x16x32_bf16 v[108:111], v[136:139], a[216:219], v[108:111]
  ds_read_b64_tr_b16 v[132:133], v150 offset:8192
  v_mfma_f32_16x16x32_bf16 v[108:111], v[140:143], a[220:223], v[108:111]
  ds_read_b64_tr_b16 v[134:135], v150 offset:8704
  s_waitcnt lgkmcnt(8)
  v_mfma_f32_16x16x32_bf16 v[80:83], v[112:115], a[224:227], v[80:83]
  ds_read_b64_tr_b16 v[136:137], v151 offset:0
  v_mfma_f32_16x16x32_bf16 v[80:83], v[116:119], a[228:231], v[80:83]
  ds_read_b64_tr_b16 v[138:139], v151 offset:512
  buffer_load_dwordx4 v1, s[4:7], s77 offen offset:1024 sc1 lds
  v_mfma_f32_16x16x32_bf16 v[84:87], v[112:115], a[232:235], v[84:87]
  ds_read_b64_tr_b16 v[140:141], v151 offset:8192
  v_mfma_f32_16x16x32_bf16 v[84:87], v[116:119], a[236:239], v[84:87]
  ds_read_b64_tr_b16 v[142:143], v151 offset:8704
  s_waitcnt lgkmcnt(8)
  v_mfma_f32_16x16x32_bf16 v[88:91], v[120:123], a[224:227], v[88:91]
  ds_read_b64_tr_b16 v[112:113], v148 offset:2048
  s_add_u32 m0, s94, 34816
  s_add_u32 s77, s76, s39
  v_mfma_f32_16x16x32_bf16 v[88:91], v[124:127], a[228:231], v[88:91]
  ds_read_b64_tr_b16 v[114:115], v148 offset:2560
  buffer_load_dwordx4 v1, s[4:7], s77 offen sc1 lds
  v_mfma_f32_16x16x32_bf16 v[92:95], v[120:123], a[232:235], v[92:95]
  ds_read_b64_tr_b16 v[116:117], v148 offset:10240
  v_mfma_f32_16x16x32_bf16 v[92:95], v[124:127], a[236:239], v[92:95]
  ds_read_b64_tr_b16 v[118:119], v148 offset:10752
  s_waitcnt lgkmcnt(8)
  v_mfma_f32_16x16x32_bf16 v[96:99], v[128:131], a[224:227], v[96:99]
  ds_read_b64_tr_b16 v[120:121], v149 offset:2048
  v_mfma_f32_16x16x32_bf16 v[96:99], v[132:135], a[228:231], v[96:99]
  ds_read_b64_tr_b16 v[122:123], v149 offset:2560
  buffer_load_dwordx4 v1, s[4:7], s77 offen offset:1024 sc1 lds
  v_mfma_f32_16x16x32_bf16 v[100:103], v[128:131], a[232:235], v[100:103]
  ds_read_b64_tr_b16 v[124:125], v149 offset:10240
  v_mfma_f32_16x16x32_bf16 v[100:103], v[132:135], a[236:239], v[100:103]
  ds_read_b64_tr_b16 v[126:127], v149 offset:10752
  s_waitcnt lgkmcnt(8)
  v_mfma_f32_16x16x32_bf16 v[104:107], v[136:139], a[224:227], v[104:107]
  ds_read_b64_tr_b16 v[128:129], v150 offset:2048
  v_mfma_f32_16x16x32_bf16 v[104:107], v[140:143], a[228:231], v[104:107]
  ds_read_b64_tr_b16 v[130:131], v150 offset:2560
  v_mfma_f32_16x16x32_bf16 v[108:111], v[136:139], a[232:235], v[108:111]
  ds_read_b64_tr_b16 v[132:133], v150 offset:10240
  v_mfma_f32_16x16x32_bf16 v[108:111], v[140:143], a[236:239], v[108:111]
  ds_read_b64_tr_b16 v[134:135], v150 offset:10752
  s_waitcnt lgkmcnt(8)
  v_mfma_f32_16x16x32_bf16 v[80:83], v[112:115], a[240:243], v[80:83]
  ds_read_b64_tr_b16 v[136:137], v151 offset:2048
  s_add_u32 m0, s94, 49152
  s_add_u32 s77, s76, s40
  v_mfma_f32_16x16x32_bf16 v[80:83], v[116:119], a[244:247], v[80:83]
  ds_read_b64_tr_b16 v[138:139], v151 offset:2560
  buffer_load_dwordx4 v1, s[4:7], s77 offen sc1 lds
  v_mfma_f32_16x16x32_bf16 v[84:87], v[112:115], a[248:251], v[84:87]
  ds_read_b64_tr_b16 v[140:141], v151 offset:10240
  v_mfma_f32_16x16x32_bf16 v[84:87], v[116:119], a[252:255], v[84:87]
  ds_read_b64_tr_b16 v[142:143], v151 offset:10752
  s_waitcnt lgkmcnt(8)
  v_mfma_f32_16x16x32_bf16 v[88:91], v[120:123], a[240:243], v[88:91]
  v_mfma_f32_16x16x32_bf16 v[88:91], v[124:127], a[244:247], v[88:91]
  buffer_load_dwordx4 v1, s[4:7], s77 offen offset:1024 sc1 lds
  v_mfma_f32_16x16x32_bf16 v[92:95], v[120:123], a[248:251], v[92:95]
  v_mfma_f32_16x16x32_bf16 v[92:95], v[124:127], a[252:255], v[92:95]
  s_waitcnt lgkmcnt(4)
  v_mfma_f32_16x16x32_bf16 v[96:99], v[128:131], a[240:243], v[96:99]
  s_add_u32 m0, s94, 51200
  s_add_u32 s77, s76, s41
  v_mfma_f32_16x16x32_bf16 v[96:99], v[132:135], a[244:247], v[96:99]
  buffer_load_dwordx4 v1, s[4:7], s77 offen sc1 lds
  v_mfma_f32_16x16x32_bf16 v[100:103], v[128:131], a[248:251], v[100:103]
  v_mfma_f32_16x16x32_bf16 v[100:103], v[132:135], a[252:255], v[100:103]
  s_waitcnt lgkmcnt(0)
  v_mfma_f32_16x16x32_bf16 v[104:107], v[136:139], a[240:243], v[104:107]
  v_mfma_f32_16x16x32_bf16 v[104:107], v[140:143], a[244:247], v[104:107]
  v_mfma_f32_16x16x32_bf16 v[108:111], v[136:139], a[248:251], v[108:111]
  v_mfma_f32_16x16x32_bf16 v[108:111], v[140:143], a[252:255], v[108:111]
  buffer_load_dwordx4 v1, s[4:7], s77 offen offset:1024 sc1 lds
  s_barrier
  s_waitcnt vmcnt(10)
  v_cmp_ne_u32 vcc, s31, v14
  s_cbranch_vccz L_s1q_9
  v_and_b32 v10, 15, v0
  v_lshlrev_b32 v10, 2, v10
  s_mov_b32 s95, 131072
  buffer_load_dword v44, v10, s[4:7], s82 offen sc1
L_poll_10:
  s_waitcnt vmcnt(0)
  v_cmp_ne_u32 vcc, s31, v44
  s_cbranch_vccz L_poll_10_done
  buffer_load_dword v44, v10, s[4:7], s82 offen sc1
  s_sub_u32 s95, s95, 1
  s_cmp_lg_u32 s95, 0
  s_cbranch_scc1 L_poll_10
L_poll_10_done:
L_s1q_9:
  s_lshl_b32 s80, s29, 16
  s_lshl_b32 s81, s30, 10
  s_add_u32 s80, s80, s81
  s_lshl_b32 s81, s32, 20
  s_add_u32 s80, s80, s81
  s_add_u32 s80, s80, 2097152
  s_lshl_b32 s83, s29, 12
  s_lshl_b32 s81, s32, 16
  s_add_u32 s83, s83, s81
  s_lshl_b32 s81, s30, 6
  s_add_u32 s83, s83, s81
  s_add_u32 s83, s83, 4194304
  v_lshrrev_b32 v11, 2, v0
  v_lshlrev_b32 v11, 8, v11
  v_and_b32 v12, 3, v0
  v_lshl_add_u32 v11, v12, 4, v11
  buffer_load_dwordx4 v[168:171], v11, s[4:7], s83 offen sc1
  s_add_u32 s81, s80, 0
  buffer_load_dwordx4 v[16:19], v1, s[4:7], s81 offen sc1
  s_add_u32 s81, s80, 4096
  buffer_load_dwordx4 v[20:23], v1, s[4:7], s81 offen sc1
  v_mul_f32 v236, 0x3fb8aa3b, v80
  v_mul_f32 v237, 0x3fb8aa3b, v81
  v_mul_f32 v238, 0x3fb8aa3b, v82
  v_mul_f32 v239, 0x3fb8aa3b, v83
  v_mul_f32 v240, 0x3fb8aa3b, v84
  v_mul_f32 v241, 0x3fb8aa3b, v85
  v_mul_f32 v242, 0x3fb8aa3b, v86
  v_mul_f32 v243, 0x3fb8aa3b, v87
  s_add_u32 s81, s80, 8192
  buffer_load_dwordx4 v[24:27], v1, s[4:7], s81 offen sc1
  v_exp_f32 v236, v236 clamp
  v_exp_f32 v237, v237 clamp
  v_exp_f32 v238, v238 clamp
  v_exp_f32 v239, v239 clamp
  v_exp_f32 v240, v240 clamp
  v_exp_f32 v241, v241 clamp
  v_exp_f32 v242, v242 clamp
  v_exp_f32 v243, v243 clamp
  s_add_u32 s81, s80, 12288
  buffer_load_dwordx4 v[28:31], v1, s[4:7], s81 offen sc1
  v_add_f32 v236, 0x358637bd, v236
  v_add_f32 v237, 0x358637bd, v237
  v_add_f32 v238, 0x358637bd, v238
  v_add_f32 v239, 0x358637bd, v239
  v_add_f32 v240, 0x358637bd, v240
  v_add_f32 v241, 0x358637bd, v241
  v_add_f32 v242, 0x358637bd, v242
  v_add_f32 v243, 0x358637bd, v243
  s_add_u32 s81, s80, 16384
  buffer_load_dwordx4 v[32:35], v1, s[4:7], s81 offen sc1
  v_add_f32 v80, v80, v236
  v_add_f32 v81, v81, v237
  v_add_f32 v82, v82, v238
  v_add_f32 v83, v83, v239
  v_add_f32 v84, v84, v240
  v_add_f32 v85, v85, v241
  v_add_f32 v86, v86, v242
  v_add_f32 v87, v87, v243
  s_add_u32 s81, s80, 20480
  buffer_load_dwordx4 v[36:39], v1, s[4:7], s81 offen sc1
  v_max_f32 v80, v80, v236
  v_max_f32 v81, v81, v237
  v_max_f32 v82, v82, v238
  v_max_f32 v83, v83, v239
  v_max_f32 v84, v84, v240
  v_max_f32 v85, v85, v241
  v_max_f32 v86, v86, v242
  v_max_f32 v87, v87, v243
  s_add_u32 s81, s80, 24576
  buffer_load_dwordx4 v[40:43], v1, s[4:7], s81 offen sc1
  v_mul_f32 v236, 0x3fb8aa3b, v88
  v_mul_f32 v237, 0x3fb8aa3b, v89
  v_mul_f32 v238, 0x3fb8aa3b, v90
  v_mul_f32 v239, 0x3fb8aa3b, v91
  v_mul_f32 v240, 0x3fb8aa3b, v92
  v_mul_f32 v241, 0x3fb8aa3b, v93
  v_mul_f32 v242, 0x3fb8aa3b, v94
  v_mul_f32 v243, 0x3fb8aa3b, v95
  s_add_u32 s81, s80, 28672
  buffer_load_dwordx4 v[44:47], v1, s[4:7], s81 offen sc1
  v_exp_f32 v236, v236 clamp
  v_exp_f32 v237, v237 clamp
  v_exp_f32 v238, v238 clamp
  v_exp_f32 v239, v239 clamp
  v_exp_f32 v240, v240 clamp
  v_exp_f32 v241, v241 clamp
  v_exp_f32 v242, v242 clamp
  v_exp_f32 v243, v243 clamp
  s_add_u32 s81, s80, 32768
  buffer_load_dwordx4 v[48:51], v1, s[4:7], s81 offen sc1
  v_add_f32 v236, 0x358637bd, v236
  v_add_f32 v237, 0x358637bd, v237
  v_add_f32 v238, 0x358637bd, v238
  v_add_f32 v239, 0x358637bd, v239
  v_add_f32 v240, 0x358637bd, v240
  v_add_f32 v241, 0x358637bd, v241
  v_add_f32 v242, 0x358637bd, v242
  v_add_f32 v243, 0x358637bd, v243
  s_add_u32 s81, s80, 36864
  buffer_load_dwordx4 v[52:55], v1, s[4:7], s81 offen sc1
  v_add_f32 v88, v88, v236
  v_add_f32 v89, v89, v237
  v_add_f32 v90, v90, v238
  v_add_f32 v91, v91, v239
  v_add_f32 v92, v92, v240
  v_add_f32 v93, v93, v241
  v_add_f32 v94, v94, v242
  v_add_f32 v95, v95, v243
  s_add_u32 s81, s80, 40960
  buffer_load_dwordx4 v[56:59], v1, s[4:7], s81 offen sc1
  v_max_f32 v88, v88, v236
  v_max_f32 v89, v89, v237
  v_max_f32 v90, v90, v238
  v_max_f32 v91, v91, v239
  v_max_f32 v92, v92, v240
  v_max_f32 v93, v93, v241
  v_max_f32 v94, v94, v242
  v_max_f32 v95, v95, v243
  s_add_u32 s81, s80, 45056
  buffer_load_dwordx4 v[60:63], v1, s[4:7], s81 offen sc1
  v_mul_f32 v236, 0x3fb8aa3b, v96
  v_mul_f32 v237, 0x3fb8aa3b, v97
  v_mul_f32 v238, 0x3fb8aa3b, v98
  v_mul_f32 v239, 0x3fb8aa3b, v99
  v_mul_f32 v240, 0x3fb8aa3b, v100
  v_mul_f32 v241, 0x3fb8aa3b, v101
  v_mul_f32 v242, 0x3fb8aa3b, v102
  v_mul_f32 v243, 0x3fb8aa3b, v103
  s_add_u32 s81, s80, 49152
  buffer_load_dwordx4 v[64:67], v1, s[4:7], s81 offen sc1
  v_exp_f32 v236, v236 clamp
  v_exp_f32 v237, v237 clamp
  v_exp_f32 v238, v238 clamp
  v_exp_f32 v239, v239 clamp
  v_exp_f32 v240, v240 clamp
  v_exp_f32 v241, v241 clamp
  v_exp_f32 v242, v242 clamp
  v_exp_f32 v243, v243 clamp
  s_add_u32 s81, s80, 53248
  buffer_load_dwordx4 v[68:71], v1, s[4:7], s81 offen sc1
  v_add_f32 v236, 0x358637bd, v236
  v_add_f32 v237, 0x358637bd, v237
  v_add_f32 v238, 0x358637bd, v238
  v_add_f32 v239, 0x358637bd, v239
  v_add_f32 v240, 0x358637bd, v240
  v_add_f32 v241, 0x358637bd, v241
  v_add_f32 v242, 0x358637bd, v242
  v_add_f32 v243, 0x358637bd, v243
  s_add_u32 s81, s80, 57344
  buffer_load_dwordx4 v[72:75], v1, s[4:7], s81 offen sc1
  v_add_f32 v96, v96, v236
  v_add_f32 v97, v97, v237
  v_add_f32 v98, v98, v238
  v_add_f32 v99, v99, v239
  v_add_f32 v100, v100, v240
  v_add_f32 v101, v101, v241
  v_add_f32 v102, v102, v242
  v_add_f32 v103, v103, v243
  s_add_u32 s81, s80, 61440
  buffer_load_dwordx4 v[76:79], v1, s[4:7], s81 offen sc1
  v_max_f32 v96, v96, v236
  v_max_f32 v97, v97, v237
  v_max_f32 v98, v98, v238
  v_max_f32 v99, v99, v239
  v_max_f32 v100, v100, v240
  v_max_f32 v101, v101, v241
  v_max_f32 v102, v102, v242
  v_max_f32 v103, v103, v243
  s_add_u32 m0, s94, 65536
  s_add_u32 s77, s76, s46
  buffer_load_dwordx4 v1, s[4:7], s77 offen sc1 lds
  v_mul_f32 v236, 0x3fb8aa3b, v104
  v_mul_f32 v237, 0x3fb8aa3b, v105
  v_mul_f32 v238, 0x3fb8aa3b, v106
  v_mul_f32 v239, 0x3fb8aa3b, v107
  v_mul_f32 v240, 0x3fb8aa3b, v108
  v_mul_f32 v241, 0x3fb8aa3b, v109
  v_mul_f32 v242, 0x3fb8aa3b, v110
  v_mul_f32 v243, 0x3fb8aa3b, v111
  buffer_load_dwordx4 v1, s[4:7], s77 offen offset:1024 sc1 lds
  v_exp_f32 v236, v236 clamp
  v_exp_f32 v237, v237 clamp
  v_exp_f32 v238, v238 clamp
  v_exp_f32 v239, v239 clamp
  v_exp_f32 v240, v240 clamp
  v_exp_f32 v241, v241 clamp
  v_exp_f32 v242, v242 clamp
  v_exp_f32 v243, v243 clamp
  s_add_u32 m0, s94, 67584
  s_add_u32 s77, s76, s47
  buffer_load_dwordx4 v1, s[4:7], s77 offen sc1 lds
  v_add_f32 v236, 0x358637bd, v236
  v_add_f32 v237, 0x358637bd, v237
  v_add_f32 v238, 0x358637bd, v238
  v_add_f32 v239, 0x358637bd, v239
  v_add_f32 v240, 0x358637bd, v240
  v_add_f32 v241, 0x358637bd, v241
  v_add_f32 v242, 0x358637bd, v242
  v_add_f32 v243, 0x358637bd, v243
  buffer_load_dwordx4 v1, s[4:7], s77 offen offset:1024 sc1 lds
  v_add_f32 v104, v104, v236
  v_add_f32 v105, v105, v237
  v_add_f32 v106, v106, v238
  v_add_f32 v107, v107, v239
  v_add_f32 v108, v108, v240
  v_add_f32 v109, v109, v241
  v_add_f32 v110, v110, v242
  v_add_f32 v111, v111, v243
  s_add_u32 m0, s94, 114688
  s_add_u32 s77, s76, s48
  buffer_load_dwordx4 v1, s[4:7], s77 offen sc1 lds
  v_max_f32 v104, v104, v236
  v_max_f32 v105, v105, v237
  v_max_f32 v106, v106, v238
  v_max_f32 v107, v107, v239
  v_max_f32 v108, v108, v240
  v_max_f32 v109, v109, v241
  v_max_f32 v110, v110, v242
  v_max_f32 v111, v111, v243
  buffer_load_dwordx4 v1, s[4:7], s77 offen offset:1024 sc1 lds
  v_cvt_pk_bf16_f32 v152, v80, v81
  v_cvt_pk_bf16_f32 v153, v82, v83
  v_cvt_pk_bf16_f32 v154, v88, v89
  v_cvt_pk_bf16_f32 v155, v90, v91
  v_cvt_pk_bf16_f32 v156, v84, v85
  v_cvt_pk_bf16_f32 v157, v86, v87
  v_cvt_pk_bf16_f32 v158, v92, v93
  v_cvt_pk_bf16_f32 v159, v94, v95
  s_add_u32 m0, s94, 116736
  s_add_u32 s77, s76, s49
  buffer_load_dwordx4 v1, s[4:7], s77 offen sc1 lds
  v_cvt_pk_bf16_f32 v160, v96, v97
  v_cvt_pk_bf16_f32 v161, v98, v99
  v_cvt_pk_bf16_f32 v162, v104, v105
  v_cvt_pk_bf16_f32 v163, v106, v107
  v_cvt_pk_bf16_f32 v164, v100, v101
  v_cvt_pk_bf16_f32 v165, v102, v103
  v_cvt_pk_bf16_f32 v166, v108, v109
  v_cvt_pk_bf16_f32 v167, v110, v111
  buffer_load_dwordx4 v1, s[4:7], s77 offen offset:1024 sc1 lds
  s_waitcnt vmcnt(24)
  v_add_f32_dpp v172, v168, v168 row_ror:4 row_mask:0xf bank_mask:0xf
  v_add_f32_dpp v173, v169, v169 row_ror:4 row_mask:0xf bank_mask:0xf
  v_add_f32_dpp v174, v170, v170 row_ror:4 row_mask:0xf bank_mask:0xf
  v_add_f32_dpp v175, v171, v171 row_ror:4 row_mask:0xf bank_mask:0xf
  v_mov_b32 v168, v172
  v_mov_b32 v169, v173
  v_mov_b32 v170, v174
  v_mov_b32 v171, v175
  v_add_f32_dpp v172, v168, v168 row_ror:8 row_mask:0xf bank_mask:0xf
  v_add_f32_dpp v173, v169, v169 row_ror:8 row_mask:0xf bank_mask:0xf
  v_add_f32_dpp v174, v170, v170 row_ror:8 row_mask:0xf bank_mask:0xf
  v_add_f32_dpp v175, v171, v171 row_ror:8 row_mask:0xf bank_mask:0xf
  v_mov_b32 v168, v172
  v_mov_b32 v169, v173
  v_mov_b32 v170, v174
  v_mov_b32 v171, v175
  v_mov_b32 v172, v168
  v_mov_b32 v173, v169
  v_mov_b32 v174, v170
  v_mov_b32 v175, v171
  v_permlane16_swap_b32 v168, v172
  v_permlane16_swap_b32 v169, v173
  v_permlane16_swap_b32 v170, v174
  v_permlane16_swap_b32 v171, v175
  v_add_f32 v168, v168, v172
  v_add_f32 v169, v169, v173
  v_add_f32 v170, v170, v174
  v_add_f32 v171, v171, v175
  v_mov_b32 v172, v168
  v_mov_b32 v173, v169
  v_mov_b32 v174, v170
  v_mov_b32 v175, v171
  v_permlane32_swap_b32 v168, v172
  v_permlane32_swap_b32 v169, v173
  v_permlane32_swap_b32 v170, v174
  v_permlane32_swap_b32 v171, v175
  v_add_f32 v168, v168, v172
  v_add_f32 v169, v169, v173
  v_add_f32 v170, v170, v174
  v_add_f32 v171, v171, v175
  v_mov_b32 v120, 0x00003f80
  v_mov_b32 v121, 0x3f800000
  v_mov_b32 v112, 0
  v_mov_b32 v113, 0
  v_mov_b32 v114, 0
  v_mov_b32 v115, 0
  v_mov_b32 v116, 0
  v_mov_b32 v117, 0
  v_mov_b32 v118, 0
  v_mov_b32 v119, 0
  s_waitcnt vmcnt(23)
  v_dot2_f32_bf16 v112, v16, v120, v112
  v_dot2_f32_bf16 v113, v16, v121, v113
  v_dot2_f32_bf16 v114, v17, v120, v114
  v_dot2_f32_bf16 v115, v17, v121, v115
  v_dot2_f32_bf16 v116, v18, v120, v116
  v_dot2_f32_bf16 v117, v18, v121, v117
  v_dot2_f32_bf16 v118, v19, v120, v118
  v_dot2_f32_bf16 v119, v19, v121, v119
  s_waitcnt vmcnt(22)
  v_dot2_f32_bf16 v112, v20, v120, v112
  v_dot2_f32_bf16 v113, v20, v121, v113
  v_dot2_f32_bf16 v114, v21, v120, v114
  v_dot2_f32_bf16 v115, v21, v121, v115
  v_dot2_f32_bf16 v116, v22, v120, v116
  v_dot2_f32_bf16 v117, v22, v121, v117
  v_dot2_f32_bf16 v118, v23, v120, v118
  v_dot2_f32_bf16 v119, v23, v121, v119
  s_waitcnt vmcnt(21)
  v_dot2_f32_bf16 v112, v24, v120, v112
  v_dot2_f32_bf16 v113, v24, v121, v113
  v_dot2_f32_bf16 v114, v25, v120, v114
  v_dot2_f32_bf16 v115, v25, v121, v115
  v_dot2_f32_bf16 v116, v26, v120, v116
  v_dot2_f32_bf16 v117, v26, v121, v117
  v_dot2_f32_bf16 v118, v27, v120, v118
  v_dot2_f32_bf16 v119, v27, v121, v119
  s_waitcnt vmcnt(20)
  v_dot2_f32_bf16 v112, v28, v120, v112
  v_dot2_f32_bf16 v113, v28, v121, v113
  v_dot2_f32_bf16 v114, v29, v120, v114
  v_dot2_f32_bf16 v115, v29, v121, v115
  v_dot2_f32_bf16 v116, v30, v120, v116
  v_dot2_f32_bf16 v117, v30, v121, v117
  v_dot2_f32_bf16 v118, v31, v120, v118
  v_dot2_f32_bf16 v119, v31, v121, v119
  s_waitcnt vmcnt(19)
  v_dot2_f32_bf16 v112, v32, v120, v112
  v_dot2_f32_bf16 v113, v32, v121, v113
  v_dot2_f32_bf16 v114, v33, v120, v114
  v_dot2_f32_bf16 v115, v33, v121, v115
  v_dot2_f32_bf16 v116, v34, v120, v116
  v_dot2_f32_bf16 v117, v34, v121, v117
  v_dot2_f32_bf16 v118, v35, v120, v118
  v_dot2_f32_bf16 v119, v35, v121, v119
  s_waitcnt vmcnt(18)
  v_dot2_f32_bf16 v112, v36, v120, v112
  v_dot2_f32_bf16 v113, v36, v121, v113
  v_dot2_f32_bf16 v114, v37, v120, v114
  v_dot2_f32_bf16 v115, v37, v121, v115
  v_dot2_f32_bf16 v116, v38, v120, v116
  v_dot2_f32_bf16 v117, v38, v121, v117
  v_dot2_f32_bf16 v118, v39, v120, v118
  v_dot2_f32_bf16 v119, v39, v121, v119
  s_waitcnt vmcnt(17)
  v_dot2_f32_bf16 v112, v40, v120, v112
  v_dot2_f32_bf16 v113, v40, v121, v113
  v_dot2_f32_bf16 v114, v41, v120, v114
  v_dot2_f32_bf16 v115, v41, v121, v115
  v_dot2_f32_bf16 v116, v42, v120, v116
  v_dot2_f32_bf16 v117, v42, v121, v117
  v_dot2_f32_bf16 v118, v43, v120, v118
  v_dot2_f32_bf16 v119, v43, v121, v119
  s_waitcnt vmcnt(16)
  v_dot2_f32_bf16 v112, v44, v120, v112
  v_dot2_f32_bf16 v113, v44, v121, v113
  v_dot2_f32_bf16 v114, v45, v120, v114
  v_dot2_f32_bf16 v115, v45, v121, v115
  v_dot2_f32_bf16 v116, v46, v120, v116
  v_dot2_f32_bf16 v117, v46, v121, v117
  v_dot2_f32_bf16 v118, v47, v120, v118
  v_dot2_f32_bf16 v119, v47, v121, v119
  s_waitcnt vmcnt(15)
  v_dot2_f32_bf16 v112, v48, v120, v112
  v_dot2_f32_bf16 v113, v48, v121, v113
  v_dot2_f32_bf16 v114, v49, v120, v114
  v_dot2_f32_bf16 v115, v49, v121, v115
  v_dot2_f32_bf16 v116, v50, v120, v116
  v_dot2_f32_bf16 v117, v50, v121, v117
  v_dot2_f32_bf16 v118, v51, v120, v118
  v_dot2_f32_bf16 v119, v51, v121, v119
  s_waitcnt vmcnt(14)
  v_dot2_f32_bf16 v112, v52, v120, v112
  v_dot2_f32_bf16 v113, v52, v121, v113
  v_dot2_f32_bf16 v114, v53, v120, v114
  v_dot2_f32_bf16 v115, v53, v121, v115
  v_dot2_f32_bf16 v116, v54, v120, v116
  v_dot2_f32_bf16 v117, v54, v121, v117
  v_dot2_f32_bf16 v118, v55, v120, v118
  v_dot2_f32_bf16 v119, v55, v121, v119
  s_waitcnt vmcnt(13)
  v_dot2_f32_bf16 v112, v56, v120, v112
  v_dot2_f32_bf16 v113, v56, v121, v113
  v_dot2_f32_bf16 v114, v57, v120, v114
  v_dot2_f32_bf16 v115, v57, v121, v115
  v_dot2_f32_bf16 v116, v58, v120, v116
  v_dot2_f32_bf16 v117, v58, v121, v117
  v_dot2_f32_bf16 v118, v59, v120, v118
  v_dot2_f32_bf16 v119, v59, v121, v119
  s_waitcnt vmcnt(12)
  v_dot2_f32_bf16 v112, v60, v120, v112
  v_dot2_f32_bf16 v113, v60, v121, v113
  v_dot2_f32_bf16 v114, v61, v120, v114
  v_dot2_f32_bf16 v115, v61, v121, v115
  v_dot2_f32_bf16 v116, v62, v120, v116
  v_dot2_f32_bf16 v117, v62, v121, v117
  v_dot2_f32_bf16 v118, v63, v120, v118
  v_dot2_f32_bf16 v119, v63, v121, v119
  s_waitcnt vmcnt(11)
  v_dot2_f32_bf16 v112, v64, v120, v112
  v_dot2_f32_bf16 v113, v64, v121, v113
  v_dot2_f32_bf16 v114, v65, v120, v114
  v_dot2_f32_bf16 v115, v65, v121, v115
  v_dot2_f32_bf16 v116, v66, v120, v116
  v_dot2_f32_bf16 v117, v66, v121, v117
  v_dot2_f32_bf16 v118, v67, v120, v118
  v_dot2_f32_bf16 v119, v67, v121, v119
  s_waitcnt vmcnt(10)
  v_dot2_f32_bf16 v112, v68, v120, v112
  v_dot2_f32_bf16 v113, v68, v121, v113
  v_dot2_f32_bf16 v114, v69, v120, v114
  v_dot2_f32_bf16 v115, v69, v121, v115
  v_dot2_f32_bf16 v116, v70, v120, v116
  v_dot2_f32_bf16 v117, v70, v121, v117
  v_dot2_f32_bf16 v118, v71, v120, v118
  v_dot2_f32_bf16 v119, v71, v121, v119
  s_waitcnt vmcnt(9)
  v_dot2_f32_bf16 v112, v72, v120, v112
  v_dot2_f32_bf16 v113, v72, v121, v113
  v_dot2_f32_bf16 v114, v73, v120, v114
  v_dot2_f32_bf16 v115, v73, v121, v115
  v_dot2_f32_bf16 v116, v74, v120, v116
  v_dot2_f32_bf16 v117, v74, v121, v117
  v_dot2_f32_bf16 v118, v75, v120, v118
  v_dot2_f32_bf16 v119, v75, v121, v119
  s_waitcnt vmcnt(8)
  v_dot2_f32_bf16 v112, v76, v120, v112
  v_dot2_f32_bf16 v113, v76, v121, v113
  v_dot2_f32_bf16 v114, v77, v120, v114
  v_dot2_f32_bf16 v115, v77, v121, v115
  v_dot2_f32_bf16 v116, v78, v120, v116
  v_dot2_f32_bf16 v117, v78, v121, v117
  v_dot2_f32_bf16 v118, v79, v120, v118
  v_dot2_f32_bf16 v119, v79, v121, v119
  v_cvt_pk_bf16_f32 v124, v112, v113
  v_cvt_pk_bf16_f32 v125, v114, v115
  v_cvt_pk_bf16_f32 v126, v116, v117
  v_cvt_pk_bf16_f32 v127, v118, v119
  v_cvt_pk_bf16_f32 v96, v168, v169
  v_cvt_pk_bf16_f32 v97, v170, v171
  s_lshl_b32 s79, s30, 10
  s_add_u32 s79, s79, 147456
  v_add_u32 v10, s79, v1
  ds_write_b128 v10, v[124:127]
  v_lshlrev_b32 v11, 3, v0
  s_lshl_b32 s79, s30, 5
  s_add_u32 s79, s79, 151552
  v_add_u32 v11, s79, v11
  s_mov_b64 exec, 15
  ds_write_b64 v11, v[96:97]
  s_mov_b64 exec, -1
  s_waitcnt lgkmcnt(0)
  s_barrier
  v_add_u32 v10, 147456, v1
  v_lshrrev_b32 v11, 4, v0
  v_lshlrev_b32 v11, 3, v11
  v_add_u32 v11, 151552, v11
  ds_read_b128 v[16:19], v10 offset:0
  ds_read_b128 v[20:23], v10 offset:1024
  ds_read_b128 v[24:27], v10 offset:2048
  ds_read_b128 v[28:31], v10 offset:3072
  ds_read2_b64 v[32:35], v11 offset0:0 offset1:4
  ds_read2_b64 v[36:39], v11 offset0:8 offset1:12
  s_waitcnt lgkmcnt(0)
  v_mfma_f32_16x16x32_bf16 v[80:83], v[32:35], v[152:155], 0
  v_mfma_f32_16x16x32_bf16 v[48:51], v[16:19], v[152:155], 0
  v_mfma_f32_16x16x32_bf16 v[52:55], v[20:23], v[152:155], 0
  v_mfma_f32_16x16x32_bf16 v[84:87], v[32:35], v[156:159], 0
  v_mfma_f32_16x16x32_bf16 v[56:59], v[16:19], v[156:159], 0
  v_mfma_f32_16x16x32_bf16 v[60:63], v[20:23], v[156:159], 0
  v_mfma_f32_16x16x32_bf16 v[88:91], v[36:39], v[160:163], 0
  v_mfma_f32_16x16x32_bf16 v[64:67], v[24:27], v[160:163], 0
  v_mfma_f32_16x16x32_bf16 v[68:71], v[28:31], v[160:163], 0
  v_mfma_f32_16x16x32_bf16 v[92:95], v[36:39], v[164:167], 0
  v_mfma_f32_16x16x32_bf16 v[72:75], v[24:27], v[164:167], 0
  v_mfma_f32_16x16x32_bf16 v[76:79], v[28:31], v[164:167], 0
  v_add_f32 v120, 0x358637bd, v80
  v_add_f32 v121, 0x358637bd, v84
  s_nop 0
  v_add_f32 v122, 0x358637bd, v88
  s_nop 1
  v_add_f32 v123, 0x358637bd, v92
  v_rcp_f32 v120, v120
  v_rcp_f32 v121, v121
  v_rcp_f32 v122, v122
  v_rcp_f32 v123, v123
  v_mul_f32 v48, v48, v120
  v_mul_f32 v49, v49, v120
  v_mul_f32 v50, v50, v120
  v_mul_f32 v51, v51, v120
  v_mul_f32 v52, v52, v120
  v_mul_f32 v53, v53, v120
  v_mul_f32 v54, v54, v120
  v_mul_f32 v55, v55, v120
  v_mul_f32 v56, v56, v121
  v_mul_f32 v57, v57, v121
  v_mul_f32 v58, v58, v121
  v_mul_f32 v59, v59, v121
  v_mul_f32 v60, v60, v121
  v_mul_f32 v61, v61, v121
  v_mul_f32 v62, v62, v121
  v_mul_f32 v63, v63, v121
  v_mul_f32 v64, v64, v122
  v_mul_f32 v65, v65, v122
  v_mul_f32 v66, v66, v122
  v_mul_f32 v67, v67, v122
  v_mul_f32 v68, v68, v122
  v_mul_f32 v69, v69, v122
  v_mul_f32 v70, v70, v122
  v_mul_f32 v71, v71, v122
  v_mul_f32 v72, v72, v123
  v_mul_f32 v73, v73, v123
  v_mul_f32 v74, v74, v123
  v_mul_f32 v75, v75, v123
  v_mul_f32 v76, v76, v123
  v_mul_f32 v77, v77, v123
  v_mul_f32 v78, v78, v123
  v_mul_f32 v79, v79, v123
  v_cvt_pk_bf16_f32 v16, v48, v49
  v_cvt_pk_bf16_f32 v17, v50, v51
  v_cvt_pk_bf16_f32 v18, v52, v53
  v_cvt_pk_bf16_f32 v19, v54, v55
  v_cvt_pk_bf16_f32 v20, v56, v57
  v_cvt_pk_bf16_f32 v21, v58, v59
  v_cvt_pk_bf16_f32 v22, v60, v61
  v_cvt_pk_bf16_f32 v23, v62, v63
  v_cvt_pk_bf16_f32 v24, v64, v65
  v_cvt_pk_bf16_f32 v25, v66, v67
  v_cvt_pk_bf16_f32 v26, v68, v69
  v_cvt_pk_bf16_f32 v27, v70, v71
  v_cvt_pk_bf16_f32 v28, v72, v73
  v_cvt_pk_bf16_f32 v29, v74, v75
  v_cvt_pk_bf16_f32 v30, v76, v77
  v_cvt_pk_bf16_f32 v31, v78, v79
  s_lshl_b32 s79, s28, 2
  s_add_u32 s79, s79, s30
  s_lshl_b32 s79, s79, 16
  s_lshl_b32 s80, s29, 11
  s_add_u32 s79, s79, s80
  s_lshl_b32 s80, s32, 22
  s_add_u32 s79, s79, s80
  s_add_u32 s79, s79, 33554432
  s_add_u32 s80, s79, 0x8000
  buffer_store_dwordx4 v[16:19], v1, s[4:7], s79 offen sc1
  buffer_store_dwordx4 v[20:23], v1, s[4:7], s80 offen sc1
  buffer_store_dwordx4 v[24:27], v1, s[4:7], s79 offen offset:1024 sc1
  buffer_store_dwordx4 v[28:31], v1, s[4:7], s80 offen offset:1024 sc1
  s_lshl_b32 s79, s32, 4
  s_add_u32 s79, s79, s28
  s_lshl_b32 s79, s79, 2
  s_add_u32 s79, s79, s30
  s_lshl_b32 s79, s79, 7
  s_add_u32 s82, s79, 36864
  s_lshl_b32 s80, s29, 2
  s_add_u32 s80, s80, s82
  s_waitcnt vmcnt(0)
  v_mov_b32 v10, s31
  v_mov_b32 v11, 0
  s_mov_b64 exec, 1
  buffer_store_dword v10, v11, s[4:7], s80 offen sc1
  s_mov_b64 exec, -1
  s_barrier
  v_lshrrev_b32 v12, 3, v0
  v_and_b32 v11, 7, v0
  v_xor_b32 v11, v11, v12
  v_lshlrev_b32 v11, 4, v11
  v_lshl_add_u32 v14, v12, 11, v11
  s_lshl_b32 s79, s28, 2
  s_add_u32 s79, s79, s30
  s_lshl_b32 s79, s79, 16
  s_lshl_b32 s80, s29, 7
  s_add_u32 s79, s79, s80
  s_lshl_b32 s80, s32, 23
  s_add_u32 s79, s79, s80
  s_add_u32 s84, s79, 16777216
  s_lshl_b32 s85, s30, 13
  s_add_u32 s85, s85, 131072
  s_lshl_b32 s79, s30, 13
  s_add_u32 s86, s79, 131072
  s_add_u32 s87, s86, 4096
  buffer_load_dwordx4 v[152:155], v1, s[4:7], s86 offen sc1
  buffer_load_dwordx4 v[156:159], v1, s[4:7], s86 offen offset:1024 sc1
  buffer_load_dwordx4 v[160:163], v1, s[4:7], s86 offen offset:2048 sc1
  buffer_load_dwordx4 v[164:167], v1, s[4:7], s86 offen offset:3072 sc1
  buffer_load_dwordx4 v[168:171], v1, s[4:7], s87 offen sc1
  buffer_load_dwordx4 v[172:175], v1, s[4:7], s87 offen offset:1024 sc1
  buffer_load_dwordx4 v[176:179], v1, s[4:7], s87 offen offset:2048 sc1
  buffer_load_dwordx4 v[180:183], v1, s[4:7], s87 offen offset:3072 sc1
  v_and_b32 v10, 15, v0
  v_lshlrev_b32 v10, 2, v10
  s_mov_b32 s95, 131072
  buffer_load_dword v44, v10, s[4:7], s82 offen sc1
L_poll_11:
  s_waitcnt vmcnt(0)
  v_cmp_ne_u32 vcc, s31, v44
  s_cbranch_vccz L_poll_11_done
  buffer_load_dword v44, v10, s[4:7], s82 offen sc1
  s_sub_u32 s95, s95, 1
  s_cmp_lg_u32 s95, 0
  s_cbranch_scc1 L_poll_11
L_poll_11_done:
  s_lshl_b32 s79, s28, 2
  s_add_u32 s79, s79, s30
  s_lshl_b32 s79, s79, 16
  s_lshl_b32 s80, s32, 22
  s_add_u32 s79, s79, s80
  s_add_u32 s79, s79, 33554432
  v_add_u32 v252, s79, v1
  v_add_u32 v253, 0x8000, v252
  buffer_load_dwordx4 a[0:3], v252, s[4:7], s34 offen sc1
  buffer_load_dwordx4 a[4:7], v252, s[4:7], s34 offen offset:1024 sc1
  buffer_load_dwordx4 a[8:11], v253, s[4:7], s34 offen sc1
  buffer_load_dwordx4 a[12:15], v253, s[4:7], s34 offen offset:1024 sc1
  buffer_load_dwordx4 a[16:19], v252, s[4:7], s35 offen sc1
  buffer_load_dwordx4 a[20:23], v252, s[4:7], s35 offen offset:1024 sc1
  buffer_load_dwordx4 a[24:27], v253, s[4:7], s35 offen sc1
  buffer_load_dwordx4 a[28:31], v253, s[4:7], s35 offen offset:1024 sc1
  buffer_load_dwordx4 a[32:35], v252, s[4:7], s36 offen sc1
  buffer_load_dwordx4 a[36:39], v252, s[4:7], s36 offen offset:1024 sc1
  buffer_load_dwordx4 a[40:43], v253, s[4:7], s36 offen sc1
  buffer_load_dwordx4 a[44:47], v253, s[4:7], s36 offen offset:1024 sc1
  buffer_load_dwordx4 a[48:51], v252, s[4:7], s37 offen sc1
  buffer_load_dwordx4 a[52:55], v252, s[4:7], s37 offen offset:1024 sc1
  buffer_load_dwordx4 a[56:59], v253, s[4:7], s37 offen sc1
  buffer_load_dwordx4 a[60:63], v253, s[4:7], s37 offen offset:1024 sc1
  v_add_u32 v248, 0, v1
  v_add_u32 v144, 65536, v1
  v_add_u32 v249, 4096, v1
  v_add_u32 v145, 69632, v1
  v_add_u32 v250, 8192, v1
  v_add_u32 v146, 73728, v1
  v_add_u32 v251, 12288, v1
  v_add_u32 v147, 77824, v1
  ds_read_b128 v[112:115], v248 offset:0
  ds_read_b128 v[116:119], v248 offset:1024
  ds_read_b128 v[120:123], v249 offset:0
  ds_read_b128 v[124:127], v249 offset:1024
  ds_read_b128 v[128:131], v250 offset:0
  ds_read_b128 v[132:135], v250 offset:1024
  s_waitcnt vmcnt(12)
  s_waitcnt lgkmcnt(4)
  v_mfma_f32_16x16x32_bf16 v[16:19], v[112:115], a[0:3], 0
  ds_read_b128 v[136:139], v251 offset:0
  v_mfma_f32_16x16x32_bf16 v[16:19], v[116:119], a[4:7], v[16:19]
  ds_read_b128 v[140:143], v251 offset:1024
  v_mfma_f32_16x16x32_bf16 v[32:35], v[112:115], a[8:11], 0
  buffer_load_dwordx4 a[64:67], v252, s[4:7], s38 offen sc1
  v_mfma_f32_16x16x32_bf16 v[32:35], v[116:119], a[12:15], v[32:35]
  s_waitcnt lgkmcnt(4)
  v_mfma_f32_16x16x32_bf16 v[20:23], v[120:123], a[0:3], 0
  ds_read_b128 v[112:115], v248 offset:2048
  v_mfma_f32_16x16x32_bf16 v[20:23], v[124:127], a[4:7], v[20:23]
  ds_read_b128 v[116:119], v248 offset:3072
  v_mfma_f32_16x16x32_bf16 v[36:39], v[120:123], a[8:11], 0
  buffer_load_dwordx4 a[68:71], v252, s[4:7], s38 offen offset:1024 sc1
  v_mfma_f32_16x16x32_bf16 v[36:39], v[124:127], a[12:15], v[36:39]
  s_waitcnt lgkmcnt(4)
  v_mfma_f32_16x16x32_bf16 v[24:27], v[128:131], a[0:3], 0
  ds_read_b128 v[120:123], v249 offset:2048
  v_mfma_f32_16x16x32_bf16 v[24:27], v[132:135], a[4:7], v[24:27]
  ds_read_b128 v[124:127], v249 offset:3072
  v_mfma_f32_16x16x32_bf16 v[40:43], v[128:131], a[8:11], 0
  buffer_load_dwordx4 a[72:75], v253, s[4:7], s38 offen sc1
  v_mfma_f32_16x16x32_bf16 v[40:43], v[132:135], a[12:15], v[40:43]
  s_waitcnt lgkmcnt(4)
  v_mfma_f32_16x16x32_bf16 v[28:31], v[136:139], a[0:3], 0
  ds_read_b128 v[128:131], v250 offset:2048
  v_mfma_f32_16x16x32_bf16 v[28:31], v[140:143], a[4:7], v[28:31]
  ds_read_b128 v[132:135], v250 offset:3072
  v_mfma_f32_16x16x32_bf16 v[44:47], v[136:139], a[8:11], 0
  buffer_load_dwordx4 a[76:79], v253, s[4:7], s38 offen offset:1024 sc1
  v_mfma_f32_16x16x32_bf16 v[44:47], v[140:143], a[12:15], v[44:47]
  s_waitcnt vmcnt(12)
  s_waitcnt lgkmcnt(4)
  v_mfma_f32_16x16x32_bf16 v[16:19], v[112:115], a[16:19], v[16:19]
  ds_read_b128 v[136:139], v251 offset:2048
  v_mfma_f32_16x16x32_bf16 v[16:19], v[116:119], a[20:23], v[16:19]
  ds_read_b128 v[140:143], v251 offset:3072
  v_mfma_f32_16x16x32_bf16 v[32:35], v[112:115], a[24:27], v[32:35]
  buffer_load_dwordx4 a[80:83], v252, s[4:7], s39 offen sc1
  v_mfma_f32_16x16x32_bf16 v[32:35], v[116:119], a[28:31], v[32:35]
  s_waitcnt lgkmcnt(4)
  v_mfma_f32_16x16x32_bf16 v[20:23], v[120:123], a[16:19], v[20:23]
  ds_read_b128 v[112:115], v248 offset:16384
  v_mfma_f32_16x16x32_bf16 v[20:23], v[124:127], a[20:23], v[20:23]
  ds_read_b128 v[116:119], v248 offset:17408
  v_mfma_f32_16x16x32_bf16 v[36:39], v[120:123], a[24:27], v[36:39]
  buffer_load_dwordx4 a[84:87], v252, s[4:7], s39 offen offset:1024 sc1
  v_mfma_f32_16x16x32_bf16 v[36:39], v[124:127], a[28:31], v[36:39]
  s_waitcnt lgkmcnt(4)
  v_mfma_f32_16x16x32_bf16 v[24:27], v[128:131], a[16:19], v[24:27]
  ds_read_b128 v[120:123], v249 offset:16384
  v_mfma_f32_16x16x32_bf16 v[24:27], v[132:135], a[20:23], v[24:27]
  ds_read_b128 v[124:127], v249 offset:17408
  v_mfma_f32_16x16x32_bf16 v[40:43], v[128:131], a[24:27], v[40:43]
  buffer_load_dwordx4 a[88:91], v253, s[4:7], s39 offen sc1
  v_mfma_f32_16x16x32_bf16 v[40:43], v[132:135], a[28:31], v[40:43]
  s_waitcnt lgkmcnt(4)
  v_mfma_f32_16x16x32_bf16 v[28:31], v[136:139], a[16:19], v[28:31]
  ds_read_b128 v[128:131], v250 offset:16384
  v_mfma_f32_16x16x32_bf16 v[28:31], v[140:143], a[20:23], v[28:31]
  ds_read_b128 v[132:135], v250 offset:17408
  v_mfma_f32_16x16x32_bf16 v[44:47], v[136:139], a[24:27], v[44:47]
  buffer_load_dwordx4 a[92:95], v253, s[4:7], s39 offen offset:1024 sc1
  v_mfma_f32_16x16x32_bf16 v[44:47], v[140:143], a[28:31], v[44:47]
  s_waitcnt vmcnt(12)
  s_waitcnt lgkmcnt(4)
  v_mfma_f32_16x16x32_bf16 v[16:19], v[112:115], a[32:35], v[16:19]
  ds_read_b128 v[136:139], v251 offset:16384
  v_and_b32 v10, 15, v0
  v_mfma_f32_16x16x32_bf16 v[16:19], v[116:119], a[36:39], v[16:19]
  ds_read_b128 v[140:143], v251 offset:17408
  v_lshrrev_b32 v11, 4, v0
  v_mfma_f32_16x16x32_bf16 v[32:35], v[112:115], a[40:43], v[32:35]
  buffer_load_dwordx4 a[96:99], v252, s[4:7], s40 offen sc1
  v_mfma_f32_16x16x32_bf16 v[32:35], v[116:119], a[44:47], v[32:35]
  v_lshlrev_b32 v11, 1, v11
  s_waitcnt lgkmcnt(4)
  v_mfma_f32_16x16x32_bf16 v[20:23], v[120:123], a[32:35], v[20:23]
  ds_read_b128 v[112:115], v248 offset:18432
  v_and_b32 v12, 7, v0
  v_mfma_f32_16x16x32_bf16 v[20:23], v[124:127], a[36:39], v[20:23]
  ds_read_b128 v[116:119], v248 offset:19456
  v_xor_b32 v11, v11, v12
  v_mfma_f32_16x16x32_bf16 v[36:39], v[120:123], a[40:43], v[36:39]
  buffer_load_dwordx4 a[100:103], v252, s[4:7], s40 offen offset:1024 sc1
  v_mfma_f32_16x16x32_bf16 v[36:39], v[124:127], a[44:47], v[36:39]
  v_lshlrev_b32 v11, 4, v11
  s_waitcnt lgkmcnt(4)
  v_mfma_f32_16x16x32_bf16 v[24:27], v[128:131], a[32:35], v[24:27]
  ds_read_b128 v[120:123], v249 offset:18432
  v_lshl_add_u32 v10, v10, 7, v11
  v_mfma_f32_16x16x32_bf16 v[24:27], v[132:135], a[36:39], v[24:27]
  ds_read_b128 v[124:127], v249 offset:19456
  v_add_u32 v216, s85, v10
  v_mfma_f32_16x16x32_bf16 v[40:43], v[128:131], a[40:43], v[40:43]
  buffer_load_dwordx4 a[104:107], v253, s[4:7], s40 offen sc1
  v_mfma_f32_16x16x32_bf16 v[40:43], v[132:135], a[44:47], v[40:43]
  v_xor_b32 v217, 16, v216
  s_waitcnt lgkmcnt(4)
  v_mfma_f32_16x16x32_bf16 v[28:31], v[136:139], a[32:35], v[28:31]
  ds_read_b128 v[128:131], v250 offset:18432
  v_add_u32 v218, s94, v10
  v_mfma_f32_16x16x32_bf16 v[28:31], v[140:143], a[36:39], v[28:31]
  ds_read_b128 v[132:135], v250 offset:19456
  v_xor_b32 v219, 16, v218
  v_mfma_f32_16x16x32_bf16 v[44:47], v[136:139], a[40:43], v[44:47]
  buffer_load_dwordx4 a[108:111], v253, s[4:7], s40 offen offset:1024 sc1
  v_mfma_f32_16x16x32_bf16 v[44:47], v[140:143], a[44:47], v[44:47]
  v_and_b32 v12, 31, v0
  s_waitcnt vmcnt(12)
  s_waitcnt lgkmcnt(4)
  v_mfma_f32_16x16x32_bf16 v[16:19], v[112:115], a[48:51], v[16:19]
  ds_read_b128 v[136:139], v251 offset:18432
  v_lshlrev_b32 v12, 4, v12
  v_mfma_f32_16x16x32_bf16 v[16:19], v[116:119], a[52:55], v[16:19]
  ds_read_b128 v[140:143], v251 offset:19456
  s_lshl_b32 s79, s30, 9
  v_mfma_f32_16x16x32_bf16 v[32:35], v[112:115], a[56:59], v[32:35]
  buffer_load_dwordx4 a[112:115], v252, s[4:7], s41 offen sc1
  v_mfma_f32_16x16x32_bf16 v[32:35], v[116:119], a[60:63], v[32:35]
  v_add_u32 v220, s79, v12
  s_waitcnt lgkmcnt(4)
  v_mfma_f32_16x16x32_bf16 v[20:23], v[120:123], a[48:51], v[20:23]
  ds_read_b128 v[112:115], v248 offset:32768
  v_and_b32 v13, 15, v0
  v_mfma_f32_16x16x32_bf16 v[20:23], v[124:127], a[52:55], v[20:23]
  ds_read_b128 v[116:119], v248 offset:33792
  v_lshrrev_b32 v12, 5, v0
  v_mfma_f32_16x16x32_bf16 v[36:39], v[120:123], a[56:59], v[36:39]
  buffer_load_dwordx4 a[116:119], v252, s[4:7], s41 offen offset:1024 sc1
  v_mfma_f32_16x16x32_bf16 v[36:39], v[124:127], a[60:63], v[36:39]
  v_lshl_add_u32 v13, v12, 4, v13
  s_waitcnt lgkmcnt(4)
  v_mfma_f32_16x16x32_bf16 v[24:27], v[128:131], a[48:51], v[24:27]
  ds_read_b128 v[120:123], v249 offset:32768
  v_lshlrev_b32 v13, 4, v13
  v_mfma_f32_16x16x32_bf16 v[24:27], v[132:135], a[52:55], v[24:27]
  ds_read_b128 v[124:127], v249 offset:33792
  v_bfe_u32 v12, v0, 4, 1
  v_mfma_f32_16x16x32_bf16 v[40:43], v[128:131], a[56:59], v[40:43]
  buffer_load_dwordx4 a[120:123], v253, s[4:7], s41 offen sc1
  v_mfma_f32_16x16x32_bf16 v[40:43], v[132:135], a[60:63], v[40:43]
  v_lshl_add_u32 v13, v12, 14, v13
  s_waitcnt lgkmcnt(4)
  v_mfma_f32_16x16x32_bf16 v[28:31], v[136:139], a[48:51], v[28:31]
  ds_read_b128 v[128:131], v250 offset:32768
  v_add_u32 v221, s79, v13
  v_mfma_f32_16x16x32_bf16 v[28:31], v[140:143], a[52:55], v[28:31]
  ds_read_b128 v[132:135], v250 offset:33792
  v_lshrrev_b32 v11, 3, v0
  v_mfma_f32_16x16x32_bf16 v[44:47], v[136:139], a[56:59], v[44:47]
  buffer_load_dwordx4 a[124:127], v253, s[4:7], s41 offen offset:1024 sc1
  v_mfma_f32_16x16x32_bf16 v[44:47], v[140:143], a[60:63], v[44:47]
  v_and_b32 v12, 7, v0
  s_waitcnt vmcnt(12)
  s_waitcnt lgkmcnt(4)
  v_mfma_f32_16x16x32_bf16 v[16:19], v[112:115], a[64:67], v[16:19]
  ds_read_b128 v[136:139], v251 offset:32768
  v_xor_b32 v12, v12, v11
  v_mfma_f32_16x16x32_bf16 v[16:19], v[116:119], a[68:71], v[16:19]
  ds_read_b128 v[140:143], v251 offset:33792
  v_lshlrev_b32 v12, 4, v12
  v_mfma_f32_16x16x32_bf16 v[32:35], v[112:115], a[72:75], v[32:35]
  buffer_load_dwordx4 a[128:131], v252, s[4:7], s42 offen sc1
  v_mfma_f32_16x16x32_bf16 v[32:35], v[116:119], a[76:79], v[32:35]
  v_lshl_add_u32 v222, v11, 11, v12
  s_waitcnt lgkmcnt(4)
  v_mfma_f32_16x16x32_bf16 v[20:23], v[120:123], a[64:67], v[20:23]
  ds_read_b128 v[112:115], v248 offset:34816
  v_and_b32 v10, 15, v0
  v_mfma_f32_16x16x32_bf16 v[20:23], v[124:127], a[68:71], v[20:23]
  ds_read_b128 v[116:119], v248 offset:35840
  v_bfe_u32 v11, v0, 1, 1
  v_mfma_f32_16x16x32_bf16 v[36:39], v[120:123], a[72:75], v[36:39]
  buffer_load_dwordx4 a[132:135], v252, s[4:7], s42 offen offset:1024 sc1
  v_mfma_f32_16x16x32_bf16 v[36:39], v[124:127], a[76:79], v[36:39]
  v_bfe_u32 v12, v0, 3, 1
  s_waitcnt lgkmcnt(4)
  v_mfma_f32_16x16x32_bf16 v[24:27], v[128:131], a[64:67], v[24:27]
  ds_read_b128 v[120:123], v249 offset:34816
  v_lshl_add_u32 v11, v12, 1, v11
  v_mfma_f32_16x16x32_bf16 v[24:27], v[132:135], a[68:71], v[24:27]
  ds_read_b128 v[124:127], v249 offset:35840
  v_lshlrev_b32 v11, 1, v11
  v_mfma_f32_16x16x32_bf16 v[40:43], v[128:131], a[72:75], v[40:43]
  buffer_load_dwordx4 a[136:139], v253, s[4:7], s42 offen sc1
  v_mfma_f32_16x16x32_bf16 v[40:43], v[132:135], a[76:79], v[40:43]
  v_bfe_u32 v12, v0, 2, 1
  s_waitcnt lgkmcnt(4)
  v_mfma_f32_16x16x32_bf16 v[28:31], v[136:139], a[64:67], v[28:31]
  ds_read_b128 v[128:131], v250 offset:34816
  v_xor_b32 v11, v11, v12
  v_mfma_f32_16x16x32_bf16 v[28:31], v[140:143], a[68:71], v[28:31]
  ds_read_b128 v[132:135], v250 offset:35840
  v_lshrrev_b32 v12, 4, v0
  v_mfma_f32_16x16x32_bf16 v[44:47], v[136:139], a[72:75], v[44:47]
  buffer_load_dwordx4 a[140:143], v253, s[4:7], s42 offen offset:1024 sc1
  v_mfma_f32_16x16x32_bf16 v[44:47], v[140:143], a[76:79], v[44:47]
  v_lshlrev_b32 v12, 1, v12
  s_waitcnt vmcnt(12)
  s_waitcnt lgkmcnt(4)
  v_mfma_f32_16x16x32_bf16 v[16:19], v[112:115], a[80:83], v[16:19]
  ds_read_b128 v[136:139], v251 offset:34816
  v_xor_b32 v11, v11, v12
  v_mfma_f32_16x16x32_bf16 v[16:19], v[116:119], a[84:87], v[16:19]
  ds_read_b128 v[140:143], v251 offset:35840
  v_lshlrev_b32 v11, 4, v11
  v_mfma_f32_16x16x32_bf16 v[32:35], v[112:115], a[88:91], v[32:35]
  buffer_load_dwordx4 a[144:147], v252, s[4:7], s43 offen sc1
  v_mfma_f32_16x16x32_bf16 v[32:35], v[116:119], a[92:95], v[32:35]
  v_lshl_add_u32 v10, v10, 7, v11
  s_waitcnt lgkmcnt(4)
  v_mfma_f32_16x16x32_bf16 v[20:23], v[120:123], a[80:83], v[20:23]
  ds_read_b128 v[112:115], v248 offset:49152
  s_add_u32 s79, s94, 16384
  v_mfma_f32_16x16x32_bf16 v[20:23], v[124:127], a[84:87], v[20:23]
  ds_read_b128 v[116:119], v248 offset:50176
  v_add_u32 v200, s79, v10
  v_mfma_f32_16x16x32_bf16 v[36:39], v[120:123], a[88:91], v[36:39]
  buffer_load_dwordx4 a[148:151], v252, s[4:7], s43 offen offset:1024 sc1
  v_mfma_f32_16x16x32_bf16 v[36:39], v[124:127], a[92:95], v[36:39]
  v_xor_b32 v201, 16, v200
  s_waitcnt lgkmcnt(4)
  v_mfma_f32_16x16x32_bf16 v[24:27], v[128:131], a[80:83], v[24:27]
  ds_read_b128 v[120:123], v249 offset:49152
  v_lshrrev_b32 v10, 4, v0
  v_mfma_f32_16x16x32_bf16 v[24:27], v[132:135], a[84:87], v[24:27]
  ds_read_b128 v[124:127], v249 offset:50176
  v_bfe_u32 v11, v0, 2, 2
  v_mfma_f32_16x16x32_bf16 v[40:43], v[128:131], a[88:91], v[40:43]
  buffer_load_dwordx4 a[152:155], v253, s[4:7], s43 offen sc1
  v_mfma_f32_16x16x32_bf16 v[40:43], v[132:135], a[92:95], v[40:43]
  v_lshl_add_u32 v12, v10, 3, v11
  s_waitcnt lgkmcnt(4)
  v_mfma_f32_16x16x32_bf16 v[28:31], v[136:139], a[80:83], v[28:31]
  ds_read_b128 v[128:131], v250 offset:49152
  v_lshlrev_b32 v12, 7, v12
  v_mfma_f32_16x16x32_bf16 v[28:31], v[140:143], a[84:87], v[28:31]
  ds_read_b128 v[132:135], v250 offset:50176
  v_lshrrev_b32 v11, 1, v11
  v_mfma_f32_16x16x32_bf16 v[44:47], v[136:139], a[88:91], v[44:47]
  buffer_load_dwordx4 a[156:159], v253, s[4:7], s43 offen offset:1024 sc1
  v_mfma_f32_16x16x32_bf16 v[44:47], v[140:143], a[92:95], v[44:47]
  v_and_b32 v10, 1, v10
  s_waitcnt vmcnt(12)
  s_waitcnt lgkmcnt(4)
  v_mfma_f32_16x16x32_bf16 v[16:19], v[112:115], a[96:99], v[16:19]
  ds_read_b128 v[136:139], v251 offset:49152
  v_lshl_add_u32 v11, v10, 1, v11
  v_mfma_f32_16x16x32_bf16 v[16:19], v[116:119], a[100:103], v[16:19]
  ds_read_b128 v[140:143], v251 offset:50176
  v_lshlrev_b32 v11, 1, v11
  v_mfma_f32_16x16x32_bf16 v[32:35], v[112:115], a[104:107], v[32:35]
  buffer_load_dwordx4 a[160:163], v252, s[4:7], s44 offen sc1
  v_mfma_f32_16x16x32_bf16 v[32:35], v[116:119], a[108:111], v[32:35]
  v_bfe_u32 v10, v0, 1, 1
  s_waitcnt lgkmcnt(4)
  v_mfma_f32_16x16x32_bf16 v[20:23], v[120:123], a[96:99], v[20:23]
  ds_read_b128 v[112:115], v248 offset:51200
  v_xor_b32 v11, v11, v10
  v_mfma_f32_16x16x32_bf16 v[20:23], v[124:127], a[100:103], v[20:23]
  ds_read_b128 v[116:119], v248 offset:52224
  v_lshl_add_u32 v12, v11, 4, v12
  v_mfma_f32_16x16x32_bf16 v[36:39], v[120:123], a[104:107], v[36:39]
  buffer_load_dwordx4 a[164:167], v252, s[4:7], s44 offen offset:1024 sc1
  v_mfma_f32_16x16x32_bf16 v[36:39], v[124:127], a[108:111], v[36:39]
  v_and_b32 v10, 1, v0
  s_waitcnt lgkmcnt(4)
  v_mfma_f32_16x16x32_bf16 v[24:27], v[128:131], a[96:99], v[24:27]
  ds_read_b128 v[120:123], v249 offset:51200
  v_lshl_add_u32 v12, v10, 3, v12
  v_mfma_f32_16x16x32_bf16 v[24:27], v[132:135], a[100:103], v[24:27]
  ds_read_b128 v[124:127], v249 offset:52224
  v_add_u32 v12, 16384, v12
  v_mfma_f32_16x16x32_bf16 v[40:43], v[128:131], a[104:107], v[40:43]
  buffer_load_dwordx4 a[168:171], v253, s[4:7], s44 offen sc1
  v_mfma_f32_16x16x32_bf16 v[40:43], v[132:135], a[108:111], v[40:43]
  v_xor_b32 v224, 0, v12
  s_waitcnt lgkmcnt(4)
  v_mfma_f32_16x16x32_bf16 v[28:31], v[136:139], a[96:99], v[28:31]
  ds_read_b128 v[128:131], v250 offset:51200
  v_xor_b32 v225, 16, v12
  v_mfma_f32_16x16x32_bf16 v[28:31], v[140:143], a[100:103], v[28:31]
  ds_read_b128 v[132:135], v250 offset:52224
  v_add_u32 v225, 512, v225
  v_mfma_f32_16x16x32_bf16 v[44:47], v[136:139], a[104:107], v[44:47]
  buffer_load_dwordx4 a[172:175], v253, s[4:7], s44 offen offset:1024 sc1
  v_mfma_f32_16x16x32_bf16 v[44:47], v[140:143], a[108:111], v[44:47]
  v_xor_b32 v226, 32, v12
  s_waitcnt vmcnt(12)
  s_waitcnt lgkmcnt(4)
  v_mfma_f32_16x16x32_bf16 v[16:19], v[112:115], a[112:115], v[16:19]
  ds_read_b128 v[136:139], v251 offset:51200
  v_xor_b32 v227, 48, v12
  v_mfma_f32_16x16x32_bf16 v[16:19], v[116:119], a[116:119], v[16:19]
  ds_read_b128 v[140:143], v251 offset:52224
  v_add_u32 v227, 512, v227
  v_mfma_f32_16x16x32_bf16 v[32:35], v[112:115], a[120:123], v[32:35]
  buffer_load_dwordx4 a[176:179], v252, s[4:7], s45 offen sc1
  v_mfma_f32_16x16x32_bf16 v[32:35], v[116:119], a[124:127], v[32:35]
  v_xor_b32 v228, 64, v12
  s_waitcnt lgkmcnt(4)
  v_mfma_f32_16x16x32_bf16 v[20:23], v[120:123], a[112:115], v[20:23]
  ds_read_b128 v[112:115], v144 offset:16384
  v_xor_b32 v229, 80, v12
  v_mfma_f32_16x16x32_bf16 v[20:23], v[124:127], a[116:119], v[20:23]
  ds_read_b128 v[116:119], v144 offset:17408
  v_add_u32 v229, 512, v229
  v_mfma_f32_16x16x32_bf16 v[36:39], v[120:123], a[120:123], v[36:39]
  buffer_load_dwordx4 a[180:183], v252, s[4:7], s45 offen offset:1024 sc1
  v_mfma_f32_16x16x32_bf16 v[36:39], v[124:127], a[124:127], v[36:39]
  v_xor_b32 v230, 96, v12
  s_waitcnt lgkmcnt(4)
  v_mfma_f32_16x16x32_bf16 v[24:27], v[128:131], a[112:115], v[24:27]
  ds_read_b128 v[120:123], v145 offset:16384
  v_xor_b32 v231, 112, v12
  v_mfma_f32_16x16x32_bf16 v[24:27], v[132:135], a[116:119], v[24:27]
  ds_read_b128 v[124:127], v145 offset:17408
  v_add_u32 v231, 512, v231
  v_mfma_f32_16x16x32_bf16 v[40:43], v[128:131], a[120:123], v[40:43]
  buffer_load_dwordx4 a[184:187], v253, s[4:7], s45 offen sc1
  v_mfma_f32_16x16x32_bf16 v[40:43], v[132:135], a[124:127], v[40:43]
  s_lshl_b32 s90, s28, 15
  s_waitcnt lgkmcnt(4)
  v_mfma_f32_16x16x32_bf16 v[28:31], v[136:139], a[112:115], v[28:31]
  ds_read_b128 v[128:131], v146 offset:16384
  s_lshl_b32 s91, s32, 19
  v_mfma_f32_16x16x32_bf16 v[28:31], v[140:143], a[116:119], v[28:31]
  ds_read_b128 v[132:135], v146 offset:17408
  s_add_u32 s90, s90, s91
  v_mfma_f32_16x16x32_bf16 v[44:47], v[136:139], a[120:123], v[44:47]
  buffer_load_dwordx4 a[188:191], v253, s[4:7], s45 offen offset:1024 sc1
  v_mfma_f32_16x16x32_bf16 v[44:47], v[140:143], a[124:127], v[44:47]
  s_add_u32 s90, s90, 1048576
  s_waitcnt vmcnt(12)
  s_waitcnt lgkmcnt(4)
  v_mfma_f32_16x16x32_bf16 v[16:19], v[112:115], a[128:131], v[16:19]
  ds_read_b128 v[136:139], v147 offset:16384
  s_lshl_b32 s91, s29, 11
  v_mfma_f32_16x16x32_bf16 v[16:19], v[116:119], a[132:135], v[16:19]
  ds_read_b128 v[140:143], v147 offset:17408
  s_add_u32 s91, s91, s90
  v_mfma_f32_16x16x32_bf16 v[32:35], v[112:115], a[136:139], v[32:35]
  buffer_load_dwordx4 a[192:195], v252, s[4:7], s46 offen sc1
  v_mfma_f32_16x16x32_bf16 v[32:35], v[116:119], a[140:143], v[32:35]
  s_lshl_b32 s92, s28, 2
  s_waitcnt lgkmcnt(4)
  v_mfma_f32_16x16x32_bf16 v[20:23], v[120:123], a[128:131], v[20:23]
  ds_read_b128 v[112:115], v144 offset:18432
  s_add_u32 s92, s92, s30
  v_mfma_f32_16x16x32_bf16 v[20:23], v[124:127], a[132:135], v[20:23]
  ds_read_b128 v[116:119], v144 offset:19456
  s_lshl_b32 s92, s92, 16
  v_mfma_f32_16x16x32_bf16 v[36:39], v[120:123], a[136:139], v[36:39]
  buffer_load_dwordx4 a[196:199], v252, s[4:7], s46 offen offset:1024 sc1
  v_mfma_f32_16x16x32_bf16 v[36:39], v[124:127], a[140:143], v[36:39]
  s_lshl_b32 s79, s29, 7
  s_waitcnt lgkmcnt(4)
  v_mfma_f32_16x16x32_bf16 v[24:27], v[128:131], a[128:131], v[24:27]
  ds_read_b128 v[120:123], v145 offset:18432
  s_add_u32 s92, s92, s79
  v_mfma_f32_16x16x32_bf16 v[24:27], v[132:135], a[132:135], v[24:27]
  ds_read_b128 v[124:127], v145 offset:19456
  s_lshl_b32 s79, s32, 23
  v_mfma_f32_16x16x32_bf16 v[40:43], v[128:131], a[136:139], v[40:43]
  buffer_load_dwordx4 a[200:203], v253, s[4:7], s46 offen sc1
  v_mfma_f32_16x16x32_bf16 v[40:43], v[132:135], a[140:143], v[40:43]
  s_add_u32 s92, s92, s79
  s_waitcnt lgkmcnt(4)
  v_mfma_f32_16x16x32_bf16 v[28:31], v[136:139], a[128:131], v[28:31]
  ds_read_b128 v[128:131], v146 offset:18432
  s_add_u32 s92, s92, 20971520
  v_mfma_f32_16x16x32_bf16 v[28:31], v[140:143], a[132:135], v[28:31]
  ds_read_b128 v[132:135], v146 offset:19456
  v_mfma_f32_16x16x32_bf16 v[44:47], v[136:139], a[136:139], v[44:47]
  buffer_load_dwordx4 a[204:207], v253, s[4:7], s46 offen offset:1024 sc1
  v_mfma_f32_16x16x32_bf16 v[44:47], v[140:143], a[140:143], v[44:47]
  s_waitcnt vmcnt(12)
  s_waitcnt lgkmcnt(4)
  v_mfma_f32_16x16x32_bf16 v[16:19], v[112:115], a[144:147], v[16:19]
  ds_read_b128 v[136:139], v147 offset:18432
  v_mfma_f32_16x16x32_bf16 v[16:19], v[116:119], a[148:151], v[16:19]
  ds_read_b128 v[140:143], v147 offset:19456
  v_mfma_f32_16x16x32_bf16 v[32:35], v[112:115], a[152:155], v[32:35]
  buffer_load_dwordx4 a[208:211], v252, s[4:7], s47 offen sc1
  v_mfma_f32_16x16x32_bf16 v[32:35], v[116:119], a[156:159], v[32:35]
  s_waitcnt lgkmcnt(4)
  v_mfma_f32_16x16x32_bf16 v[20:23], v[120:123], a[144:147], v[20:23]
  ds_read_b128 v[112:115], v144 offset:32768
  v_mfma_f32_16x16x32_bf16 v[20:23], v[124:127], a[148:151], v[20:23]
  ds_read_b128 v[116:119], v144 offset:33792
  v_mfma_f32_16x16x32_bf16 v[36:39], v[120:123], a[152:155], v[36:39]
  buffer_load_dwordx4 a[212:215], v252, s[4:7], s47 offen offset:1024 sc1
  v_mfma_f32_16x16x32_bf16 v[36:39], v[124:127], a[156:159], v[36:39]
  s_waitcnt lgkmcnt(4)
  v_mfma_f32_16x16x32_bf16 v[24:27], v[128:131], a[144:147], v[24:27]
  ds_read_b128 v[120:123], v145 offset:32768
  v_mfma_f32_16x16x32_bf16 v[24:27], v[132:135], a[148:151], v[24:27]
  ds_read_b128 v[124:127], v145 offset:33792
  v_mfma_f32_16x16x32_bf16 v[40:43], v[128:131], a[152:155], v[40:43]
  buffer_load_dwordx4 a[216:219], v253, s[4:7], s47 offen sc1
  v_mfma_f32_16x16x32_bf16 v[40:43], v[132:135], a[156:159], v[40:43]
  s_waitcnt lgkmcnt(4)
  v_mfma_f32_16x16x32_bf16 v[28:31], v[136:139], a[144:147], v[28:31]
  ds_read_b128 v[128:131], v146 offset:32768
  v_mfma_f32_16x16x32_bf16 v[28:31], v[140:143], a[148:151], v[28:31]
  ds_read_b128 v[132:135], v146 offset:33792
  v_mfma_f32_16x16x32_bf16 v[44:47], v[136:139], a[152:155], v[44:47]
  buffer_load_dwordx4 a[220:223], v253, s[4:7], s47 offen offset:1024 sc1
  v_mfma_f32_16x16x32_bf16 v[44:47], v[140:143], a[156:159], v[44:47]
  s_waitcnt vmcnt(12)
  s_waitcnt lgkmcnt(4)
  v_mfma_f32_16x16x32_bf16 v[16:19], v[112:115], a[160:163], v[16:19]
  ds_read_b128 v[136:139], v147 offset:32768
  v_mfma_f32_16x16x32_bf16 v[16:19], v[116:119], a[164:167], v[16:19]
  ds_read_b128 v[140:143], v147 offset:33792
  v_mfma_f32_16x16x32_bf16 v[32:35], v[112:115], a[168:171], v[32:35]
  buffer_load_dwordx4 a[224:227], v252, s[4:7], s48 offen sc1
  v_mfma_f32_16x16x32_bf16 v[32:35], v[116:119], a[172:175], v[32:35]
  s_waitcnt lgkmcnt(4)
  v_mfma_f32_16x16x32_bf16 v[20:23], v[120:123], a[160:163], v[20:23]
  ds_read_b128 v[112:115], v144 offset:34816
  v_mfma_f32_16x16x32_bf16 v[20:23], v[124:127], a[164:167], v[20:23]
  ds_read_b128 v[116:119], v144 offset:35840
  v_mfma_f32_16x16x32_bf16 v[36:39], v[120:123], a[168:171], v[36:39]
  buffer_load_dwordx4 a[228:231], v252, s[4:7], s48 offen offset:1024 sc1
  v_mfma_f32_16x16x32_bf16 v[36:39], v[124:127], a[172:175], v[36:39]
  s_waitcnt lgkmcnt(4)
  v_mfma_f32_16x16x32_bf16 v[24:27], v[128:131], a[160:163], v[24:27]
  ds_read_b128 v[120:123], v145 offset:34816
  v_mfma_f32_16x16x32_bf16 v[24:27], v[132:135], a[164:167], v[24:27]
  ds_read_b128 v[124:127], v145 offset:35840
  v_mfma_f32_16x16x32_bf16 v[40:43], v[128:131], a[168:171], v[40:43]
  buffer_load_dwordx4 a[232:235], v253, s[4:7], s48 offen sc1
  v_mfma_f32_16x16x32_bf16 v[40:43], v[132:135], a[172:175], v[40:43]
  s_waitcnt lgkmcnt(4)
  v_mfma_f32_16x16x32_bf16 v[28:31], v[136:139], a[160:163], v[28:31]
  ds_read_b128 v[128:131], v146 offset:34816
  v_mfma_f32_16x16x32_bf16 v[28:31], v[140:143], a[164:167], v[28:31]
  ds_read_b128 v[132:135], v146 offset:35840
  v_mfma_f32_16x16x32_bf16 v[44:47], v[136:139], a[168:171], v[44:47]
  buffer_load_dwordx4 a[236:239], v253, s[4:7], s48 offen offset:1024 sc1
  v_mfma_f32_16x16x32_bf16 v[44:47], v[140:143], a[172:175], v[44:47]
  s_waitcnt vmcnt(12)
  s_waitcnt lgkmcnt(4)
  v_mfma_f32_16x16x32_bf16 v[16:19], v[112:115], a[176:179], v[16:19]
  ds_read_b128 v[136:139], v147 offset:34816
  v_mfma_f32_16x16x32_bf16 v[16:19], v[116:119], a[180:183], v[16:19]
  ds_read_b128 v[140:143], v147 offset:35840
  v_mfma_f32_16x16x32_bf16 v[32:35], v[112:115], a[184:187], v[32:35]
  buffer_load_dwordx4 a[240:243], v252, s[4:7], s49 offen sc1
  v_mfma_f32_16x16x32_bf16 v[32:35], v[116:119], a[188:191], v[32:35]
  s_waitcnt lgkmcnt(4)
  v_mfma_f32_16x16x32_bf16 v[20:23], v[120:123], a[176:179], v[20:23]
  ds_read_b128 v[112:115], v144 offset:0
  v_mfma_f32_16x16x32_bf16 v[20:23], v[124:127], a[180:183], v[20:23]
  ds_read_b128 v[116:119], v144 offset:1024
  v_mfma_f32_16x16x32_bf16 v[36:39], v[120:123], a[184:187], v[36:39]
  buffer_load_dwordx4 a[244:247], v252, s[4:7], s49 offen offset:1024 sc1
  v_mfma_f32_16x16x32_bf16 v[36:39], v[124:127], a[188:191], v[36:39]
  s_waitcnt lgkmcnt(4)
  v_mfma_f32_16x16x32_bf16 v[24:27], v[128:131], a[176:179], v[24:27]
  ds_read_b128 v[120:123], v145 offset:0
  v_mfma_f32_16x16x32_bf16 v[24:27], v[132:135], a[180:183], v[24:27]
  ds_read_b128 v[124:127], v145 offset:1024
  v_mfma_f32_16x16x32_bf16 v[40:43], v[128:131], a[184:187], v[40:43]
  buffer_load_dwordx4 a[248:251], v253, s[4:7], s49 offen sc1
  v_mfma_f32_16x16x32_bf16 v[40:43], v[132:135], a[188:191], v[40:43]
  s_waitcnt lgkmcnt(4)
  v_mfma_f32_16x16x32_bf16 v[28:31], v[136:139], a[176:179], v[28:31]
  ds_read_b128 v[128:131], v146 offset:0
  v_mfma_f32_16x16x32_bf16 v[28:31], v[140:143], a[180:183], v[28:31]
  ds_read_b128 v[132:135], v146 offset:1024
  v_mfma_f32_16x16x32_bf16 v[44:47], v[136:139], a[184:187], v[44:47]
  buffer_load_dwordx4 a[252:255], v253, s[4:7], s49 offen offset:1024 sc1
  v_mfma_f32_16x16x32_bf16 v[44:47], v[140:143], a[188:191], v[44:47]
  s_waitcnt vmcnt(12)
  s_waitcnt lgkmcnt(4)
  v_mfma_f32_16x16x32_bf16 v[16:19], v[112:115], a[192:195], v[16:19]
  ds_read_b128 v[136:139], v147 offset:0
  v_mfma_f32_16x16x32_bf16 v[16:19], v[116:119], a[196:199], v[16:19]
  ds_read_b128 v[140:143], v147 offset:1024
  v_mfma_f32_16x16x32_bf16 v[32:35], v[112:115], a[200:203], v[32:35]
  s_add_u32 m0, s85, 0
  s_add_u32 s93, s84, 0
  buffer_load_dwordx4 v14, s[4:7], s93 offen sc1 lds
  v_mfma_f32_16x16x32_bf16 v[32:35], v[116:119], a[204:207], v[32:35]
  s_waitcnt lgkmcnt(4)
  v_mfma_f32_16x16x32_bf16 v[20:23], v[120:123], a[192:195], v[20:23]
  ds_read_b128 v[112:115], v144 offset:2048
  v_mfma_f32_16x16x32_bf16 v[20:23], v[124:127], a[196:199], v[20:23]
  ds_read_b128 v[116:119], v144 offset:3072
  v_mfma_f32_16x16x32_bf16 v[36:39], v[120:123], a[200:203], v[36:39]
  s_add_u32 m0, s85, 1024
  s_add_u32 s93, s84, 16384
  buffer_load_dwordx4 v14, s[4:7], s93 offen sc1 lds
  v_mfma_f32_16x16x32_bf16 v[36:39], v[124:127], a[204:207], v[36:39]
  s_waitcnt lgkmcnt(4)
  v_mfma_f32_16x16x32_bf16 v[24:27], v[128:131], a[192:195], v[24:27]
  ds_read_b128 v[120:123], v145 offset:2048
  v_mfma_f32_16x16x32_bf16 v[24:27], v[132:135], a[196:199], v[24:27]
  ds_read_b128 v[124:127], v145 offset:3072
  v_mfma_f32_16x16x32_bf16 v[40:43], v[128:131], a[200:203], v[40:43]
  s_add_u32 m0, s85, 2048
  s_add_u32 s93, s84, 32768
  buffer_load_dwordx4 v14, s[4:7], s93 offen sc1 lds
  v_mfma_f32_16x16x32_bf16 v[40:43], v[132:135], a[204:207], v[40:43]
  s_waitcnt lgkmcnt(4)
  v_mfma_f32_16x16x32_bf16 v[28:31], v[136:139], a[192:195], v[28:31]
  ds_read_b128 v[128:131], v146 offset:2048
  v_mfma_f32_16x16x32_bf16 v[28:31], v[140:143], a[196:199], v[28:31]
  ds_read_b128 v[132:135], v146 offset:3072
  v_mfma_f32_16x16x32_bf16 v[44:47], v[136:139], a[200:203], v[44:47]
  s_add_u32 m0, s85, 3072
  s_add_u32 s93, s84, 49152
  buffer_load_dwordx4 v14, s[4:7], s93 offen sc1 lds
  v_mfma_f32_16x16x32_bf16 v[44:47], v[140:143], a[204:207], v[44:47]
  s_waitcnt vmcnt(12)
  s_waitcnt lgkmcnt(4)
  v_mfma_f32_16x16x32_bf16 v[16:19], v[112:115], a[208:211], v[16:19]
  ds_read_b128 v[136:139], v147 offset:2048
  v_mfma_f32_16x16x32_bf16 v[16:19], v[116:119], a[212:215], v[16:19]
  ds_read_b128 v[140:143], v147 offset:3072
  v_mfma_f32_16x16x32_bf16 v[32:35], v[112:115], a[216:219], v[32:35]
  v_mfma_f32_16x16x32_bf16 v[32:35], v[116:119], a[220:223], v[32:35]
  s_waitcnt lgkmcnt(4)
  v_mfma_f32_16x16x32_bf16 v[20:23], v[120:123], a[208:211], v[20:23]
  ds_read_b128 v[112:115], v144 offset:49152
  v_mfma_f32_16x16x32_bf16 v[20:23], v[124:127], a[212:215], v[20:23]
  ds_read_b128 v[116:119], v144 offset:50176
  v_mfma_f32_16x16x32_bf16 v[36:39], v[120:123], a[216:219], v[36:39]
  v_mfma_f32_16x16x32_bf16 v[36:39], v[124:127], a[220:223], v[36:39]
  s_waitcnt lgkmcnt(4)
  v_mfma_f32_16x16x32_bf16 v[24:27], v[128:131], a[208:211], v[24:27]
  ds_read_b128 v[120:123], v145 offset:49152
  v_mfma_f32_16x16x32_bf16 v[24:27], v[132:135], a[212:215], v[24:27]
  ds_read_b128 v[124:127], v145 offset:50176
  v_mfma_f32_16x16x32_bf16 v[40:43], v[128:131], a[216:219], v[40:43]
  v_mfma_f32_16x16x32_bf16 v[40:43], v[132:135], a[220:223], v[40:43]
  s_waitcnt lgkmcnt(4)
  v_mfma_f32_16x16x32_bf16 v[28:31], v[136:139], a[208:211], v[28:31]
  ds_read_b128 v[128:131], v146 offset:49152
  v_mfma_f32_16x16x32_bf16 v[28:31], v[140:143], a[212:215], v[28:31]
  ds_read_b128 v[132:135], v146 offset:50176
  v_mfma_f32_16x16x32_bf16 v[44:47], v[136:139], a[216:219], v[44:47]
  v_mfma_f32_16x16x32_bf16 v[44:47], v[140:143], a[220:223], v[44:47]
  s_waitcnt vmcnt(8)
  s_waitcnt lgkmcnt(4)
  v_mfma_f32_16x16x32_bf16 v[16:19], v[112:115], a[224:227], v[16:19]
  ds_read_b128 v[136:139], v147 offset:49152
  v_mfma_f32_16x16x32_bf16 v[16:19], v[116:119], a[228:231], v[16:19]
  ds_read_b128 v[140:143], v147 offset:50176
  v_mfma_f32_16x16x32_bf16 v[32:35], v[112:115], a[232:235], v[32:35]
  v_mfma_f32_16x16x32_bf16 v[32:35], v[116:119], a[236:239], v[32:35]
  s_waitcnt lgkmcnt(4)
  v_mfma_f32_16x16x32_bf16 v[20:23], v[120:123], a[224:227], v[20:23]
  ds_read_b128 v[112:115], v144 offset:51200
  v_mfma_f32_16x16x32_bf16 v[20:23], v[124:127], a[228:231], v[20:23]
  ds_read_b128 v[116:119], v144 offset:52224
  v_mfma_f32_16x16x32_bf16 v[36:39], v[120:123], a[232:235], v[36:39]
  v_mfma_f32_16x16x32_bf16 v[36:39], v[124:127], a[236:239], v[36:39]
  s_waitcnt lgkmcnt(4)
  v_mfma_f32_16x16x32_bf16 v[24:27], v[128:131], a[224:227], v[24:27]
  ds_read_b128 v[120:123], v145 offset:51200
  v_mfma_f32_16x16x32_bf16 v[24:27], v[132:135], a[228:231], v[24:27]
  ds_read_b128 v[124:127], v145 offset:52224
  v_mfma_f32_16x16x32_bf16 v[40:43], v[128:131], a[232:235], v[40:43]
  v_mfma_f32_16x16x32_bf16 v[40:43], v[132:135], a[236:239], v[40:43]
  s_waitcnt lgkmcnt(4)
  v_mfma_f32_16x16x32_bf16 v[28:31], v[136:139], a[224:227], v[28:31]
  ds_read_b128 v[128:131], v146 offset:51200
  v_mfma_f32_16x16x32_bf16 v[28:31], v[140:143], a[228:231], v[28:31]
  ds_read_b128 v[132:135], v146 offset:52224
  v_mfma_f32_16x16x32_bf16 v[44:47], v[136:139], a[232:235], v[44:47]
  v_mfma_f32_16x16x32_bf16 v[44:47], v[140:143], a[236:239], v[44:47]
  s_waitcnt vmcnt(4)
  s_waitcnt lgkmcnt(4)
  v_mfma_f32_16x16x32_bf16 v[16:19], v[112:115], a[240:243], v[16:19]
  ds_read_b128 v[136:139], v147 offset:51200
  v_mfma_f32_16x16x32_bf16 v[16:19], v[116:119], a[244:247], v[16:19]
  ds_read_b128 v[140:143], v147 offset:52224
  v_mfma_f32_16x16x32_bf16 v[32:35], v[112:115], a[248:251], v[32:35]
  v_mfma_f32_16x16x32_bf16 v[32:35], v[116:119], a[252:255], v[32:35]
  s_waitcnt lgkmcnt(4)
  v_mfma_f32_16x16x32_bf16 v[20:23], v[120:123], a[240:243], v[20:23]
  v_mfma_f32_16x16x32_bf16 v[20:23], v[124:127], a[244:247], v[20:23]
  v_mfma_f32_16x16x32_bf16 v[36:39], v[120:123], a[248:251], v[36:39]
  v_mfma_f32_16x16x32_bf16 v[36:39], v[124:127], a[252:255], v[36:39]
  s_waitcnt lgkmcnt(2)
  v_mfma_f32_16x16x32_bf16 v[24:27], v[128:131], a[240:243], v[24:27]
  v_mfma_f32_16x16x32_bf16 v[24:27], v[132:135], a[244:247], v[24:27]
  v_mfma_f32_16x16x32_bf16 v[40:43], v[128:131], a[248:251], v[40:43]
  v_mfma_f32_16x16x32_bf16 v[40:43], v[132:135], a[252:255], v[40:43]
  s_waitcnt lgkmcnt(0)
  v_mfma_f32_16x16x32_bf16 v[28:31], v[136:139], a[240:243], v[28:31]
  v_mfma_f32_16x16x32_bf16 v[28:31], v[140:143], a[244:247], v[28:31]
  v_mfma_f32_16x16x32_bf16 v[44:47], v[136:139], a[248:251], v[44:47]
  v_mfma_f32_16x16x32_bf16 v[44:47], v[140:143], a[252:255], v[44:47]
  s_waitcnt vmcnt(0)
  ds_read_b128 v[232:235], v216 offset:0
  ds_read_b128 v[236:239], v217 offset:0
  ds_read_b128 v[240:243], v216 offset:2048
  ds_read_b128 v[244:247], v217 offset:2048
  v_mov_b32 v10, 0x00003f80
  v_mov_b32 v11, 0x3f800000
  s_waitcnt lgkmcnt(0)
  v_dot2_f32_bf16 v16, v232, v10, v16
  v_dot2_f32_bf16 v17, v232, v11, v17
  v_dot2_f32_bf16 v18, v233, v10, v18
  v_dot2_f32_bf16 v19, v233, v11, v19
  v_dot2_f32_bf16 v20, v234, v10, v20
  v_dot2_f32_bf16 v21, v234, v11, v21
  v_dot2_f32_bf16 v22, v235, v10, v22
  v_dot2_f32_bf16 v23, v235, v11, v23
  v_dot2_f32_bf16 v24, v236, v10, v24
  v_dot2_f32_bf16 v25, v236, v11, v25
  v_dot2_f32_bf16 v26, v237, v10, v26
  v_dot2_f32_bf16 v27, v237, v11, v27
  v_dot2_f32_bf16 v28, v238, v10, v28
  v_dot2_f32_bf16 v29, v238, v11, v29
  v_dot2_f32_bf16 v30, v239, v10, v30
  v_dot2_f32_bf16 v31, v239, v11, v31
  v_dot2_f32_bf16 v32, v240, v10, v32
  v_dot2_f32_bf16 v33, v240, v11, v33
  v_dot2_f32_bf16 v34, v241, v10, v34
  v_dot2_f32_bf16 v35, v241, v11, v35
  v_dot2_f32_bf16 v36, v242, v10, v36
  v_dot2_f32_bf16 v37, v242, v11, v37
  v_dot2_f32_bf16 v38, v243, v10, v38
  v_dot2_f32_bf16 v39, v243, v11, v39
  v_dot2_f32_bf16 v40, v244, v10, v40
  v_dot2_f32_bf16 v41, v244, v11, v41
  v_dot2_f32_bf16 v42, v245, v10, v42
  v_dot2_f32_bf16 v43, v245, v11, v43
  v_dot2_f32_bf16 v44, v246, v10, v44
  v_dot2_f32_bf16 v45, v246, v11, v45
  v_dot2_f32_bf16 v46, v247, v10, v46
  v_dot2_f32_bf16 v47, v247, v11, v47
  v_add_f32 v80, v16, v17
  v_add_f32 v81, v18, v19
  v_add_f32 v82, v20, v21
  v_add_f32 v83, v22, v23
  v_add_f32 v84, v24, v25
  v_add_f32 v85, v26, v27
  v_add_f32 v86, v28, v29
  v_add_f32 v87, v30, v31
  v_add_f32 v80, v80, v81
  v_add_f32 v81, v82, v83
  v_add_f32 v82, v84, v85
  v_add_f32 v83, v86, v87
  v_add_f32 v80, v80, v81
  v_add_f32 v81, v82, v83
  v_add_f32 v64, v80, v81
  v_add_f32 v88, v32, v33
  v_add_f32 v89, v34, v35
  v_add_f32 v90, v36, v37
  v_add_f32 v91, v38, v39
  v_add_f32 v92, v40, v41
  v_add_f32 v93, v42, v43
  v_add_f32 v94, v44, v45
  v_add_f32 v95, v46, v47
  v_add_f32 v88, v88, v89
  v_add_f32 v89, v90, v91
  v_add_f32 v90, v92, v93
  v_add_f32 v91, v94, v95
  v_add_f32 v88, v88, v89
  v_add_f32 v89, v90, v91
  v_add_f32 v65, v88, v89
  v_mov_b32 v72, v64
  v_mov_b32 v73, v65
  s_nop 0
  v_permlane16_swap_b32 v64, v72
  v_permlane16_swap_b32 v65, v73
  v_add_f32 v64, v64, v72
  v_add_f32 v65, v65, v73
  v_mov_b32 v72, v64
  v_mov_b32 v73, v65
  s_nop 0
  v_permlane32_swap_b32 v64, v72
  v_permlane32_swap_b32 v65, v73
  v_add_f32 v64, v64, v72
  v_add_f32 v65, v65, v73
  v_mul_f32 v66, 0x3c800000, v64
  v_mul_f32 v67, 0x3c800000, v65
  v_sub_f32 v80, v16, v66
  v_sub_f32 v81, v17, v66
  v_sub_f32 v82, v18, v66
  v_sub_f32 v83, v19, v66
  v_sub_f32 v84, v20, v66
  v_sub_f32 v85, v21, v66
  v_sub_f32 v86, v22, v66
  v_sub_f32 v87, v23, v66
  v_sub_f32 v88, v24, v66
  v_sub_f32 v89, v25, v66
  v_sub_f32 v90, v26, v66
  v_sub_f32 v91, v27, v66
  v_sub_f32 v92, v28, v66
  v_sub_f32 v93, v29, v66
  v_sub_f32 v94, v30, v66
  v_sub_f32 v95, v31, v66
  v_sub_f32 v96, v32, v67
  v_sub_f32 v97, v33, v67
  v_sub_f32 v98, v34, v67
  v_sub_f32 v99, v35, v67
  v_sub_f32 v100, v36, v67
  v_sub_f32 v101, v37, v67
  v_sub_f32 v102, v38, v67
  v_sub_f32 v103, v39, v67
  v_sub_f32 v104, v40, v67
  v_sub_f32 v105, v41, v67
  v_sub_f32 v106, v42, v67
  v_sub_f32 v107, v43, v67
  v_sub_f32 v108, v44, v67
  v_sub_f32 v109, v45, v67
  v_sub_f32 v110, v46, v67
  v_sub_f32 v111, v47, v67
  v_mul_f32 v112, v80, v80
  v_mul_f32 v113, v81, v81
  v_mul_f32 v114, v82, v82
  v_mul_f32 v115, v83, v83
  v_fmac_f32 v112, v84, v84
  v_fmac_f32 v113, v85, v85
  v_fmac_f32 v114, v86, v86
  v_fmac_f32 v115, v87, v87
  v_fmac_f32 v112, v88, v88
  v_fmac_f32 v113, v89, v89
  v_fmac_f32 v114, v90, v90
  v_fmac_f32 v115, v91, v91
  v_fmac_f32 v112, v92, v92
  v_fmac_f32 v113, v93, v93
  v_fmac_f32 v114, v94, v94
  v_fmac_f32 v115, v95, v95
  v_add_f32 v120, v112, v113
  v_add_f32 v121, v114, v115
  v_add_f32 v68, v120, v121
  v_mul_f32 v116, v96, v96
  v_mul_f32 v117, v97, v97
  v_mul_f32 v118, v98, v98
  v_mul_f32 v119, v99, v99
  v_fmac_f32 v116, v100, v100
  v_fmac_f32 v117, v101, v101
  v_fmac_f32 v118, v102, v102
  v_fmac_f32 v119, v103, v103
  v_fmac_f32 v116, v104, v104
  v_fmac_f32 v117, v105, v105
  v_fmac_f32 v118, v106, v106
  v_fmac_f32 v119, v107, v107
  v_fmac_f32 v116, v108, v108
  v_fmac_f32 v117, v109, v109
  v_fmac_f32 v118, v110, v110
  v_fmac_f32 v119, v111, v111
  v_add_f32 v122, v116, v117
  v_add_f32 v123, v118, v119
  v_add_f32 v69, v122, v123
  v_mov_b32 v72, v68
  v_mov_b32 v73, v69
  s_nop 0
  v_permlane16_swap_b32 v68, v72
  v_permlane16_swap_b32 v69, v73
  v_add_f32 v68, v68, v72
  v_add_f32 v69, v69, v73
  v_mov_b32 v72, v68
  v_mov_b32 v73, v69
  s_nop 0
  v_permlane32_swap_b32 v68, v72
  v_permlane32_swap_b32 v69, v73
  v_add_f32 v68, v68, v72
  v_add_f32 v69, v69, v73
  v_cmp_lt_u32 vcc, 15, v0
  v_mov_b32 v78, s31
  v_mov_b32 v79, s31
  v_cndmask_b32 v76, v66, v67, vcc
  v_cndmask_b32 v77, v68, v69, vcc
  s_mov_b32 exec_hi, 0
  buffer_store_dwordx4 v[76:79], v220, s[4:7], s91 offen sc1
  s_mov_b64 exec, -1
  s_lshl_b32 s79, s30, 13
  s_lshl_b32 s80, s29, 15
  s_add_u32 s80, s80, s79
  s_add_u32 s80, s80, 524288
  s_add_u32 m0, s79, 131072
  s_nop 0
  buffer_load_dwordx4 v1, s[4:7], s80 offen sc1 lds
  buffer_load_dwordx4 v1, s[4:7], s80 offen offset:1024 sc1 lds
  buffer_load_dwordx4 v1, s[4:7], s80 offen offset:2048 sc1 lds
  buffer_load_dwordx4 v1, s[4:7], s80 offen offset:3072 sc1 lds
  s_add_u32 s80, s80, 4096
  s_add_u32 m0, s79, 135168
  s_nop 0
  buffer_load_dwordx4 v1, s[4:7], s80 offen sc1 lds
  buffer_load_dwordx4 v1, s[4:7], s80 offen offset:1024 sc1 lds
  buffer_load_dwordx4 v1, s[4:7], s80 offen offset:2048 sc1 lds
  buffer_load_dwordx4 v1, s[4:7], s80 offen offset:3072 sc1 lds
  v_cvt_pk_bf16_f32 v48, v16, v17
  v_cvt_pk_bf16_f32 v49, v18, v19
  v_cvt_pk_bf16_f32 v50, v20, v21
  v_cvt_pk_bf16_f32 v51, v22, v23
  v_cvt_pk_bf16_f32 v52, v24, v25
  v_cvt_pk_bf16_f32 v53, v26, v27
  v_cvt_pk_bf16_f32 v54, v28, v29
  v_cvt_pk_bf16_f32 v55, v30, v31
  v_cvt_pk_bf16_f32 v56, v32, v33
  v_cvt_pk_bf16_f32 v57, v34, v35
  v_cvt_pk_bf16_f32 v58, v36, v37
  v_cvt_pk_bf16_f32 v59, v38, v39
  v_cvt_pk_bf16_f32 v60, v40, v41
  v_cvt_pk_bf16_f32 v61, v42, v43
  v_cvt_pk_bf16_f32 v62, v44, v45
  v_cvt_pk_bf16_f32 v63, v46, v47
  s_barrier
  ds_write_b128 v218, v[48:51] offset:0
  ds_write_b128 v219, v[52:55] offset:0
  ds_write_b128 v218, v[56:59] offset:2048
  ds_write_b128 v219, v[60:63] offset:2048
  v_add_u32 v11, s94, v1
  ds_read_b128 v[80:83], v11 offset:0
  ds_read_b128 v[84:87], v11 offset:1024
  ds_read_b128 v[88:91], v11 offset:2048
  ds_read_b128 v[92:95], v11 offset:3072
  s_add_u32 s85, s90, 4096
  s_add_u32 s86, s90, 8192
  s_add_u32 s87, s90, 12288
  s_mov_b32 s84, s90
  v_and_b32 v248, 15, v0
  s_lshl_b32 s79, s30, 4
  v_add_u32 v248, s79, v248
  v_lshrrev_b32 v249, 4, v0
  v_lshlrev_b32 v249, 4, v249
  s_mov_b32 s79, 65536
  v_mad_u32_u24 v248, v248, s79, v249
  s_lshl_b32 s93, s28, 12
  s_lshl_b32 s80, s29, 8
  s_add_u32 s93, s93, s80
  s_mul_i32 s80, s32, 0x900000
  s_add_u32 s93, s93, s80
  s_add_u32 s93, s93, 50331648
  s_cmp_eq_u32 s30, 0
  s_cselect_b32 s76, 0x00010001, 0
  s_mov_b32 s77, s76
  v_add_u32 v250, 131072, v1
  s_mov_b32 s95, 131072
L_stat_12:
  buffer_load_dwordx4 v[96:99], v221, s[4:7], s84 offen sc1
  buffer_load_dwordx4 v[100:103], v221, s[4:7], s84 offen offset:2048 sc1
  buffer_load_dwordx4 v[104:107], v221, s[4:7], s85 offen sc1
  buffer_load_dwordx4 v[108:111], v221, s[4:7], s85 offen offset:2048 sc1
  buffer_load_dwordx4 v[112:115], v221, s[4:7], s86 offen sc1
  buffer_load_dwordx4 v[116:119], v221, s[4:7], s86 offen offset:2048 sc1
  buffer_load_dwordx4 v[120:123], v221, s[4:7], s87 offen sc1
  buffer_load_dwordx4 v[124:127], v221, s[4:7], s87 offen offset:2048 sc1
  s_waitcnt vmcnt(0)
  v_xor_b32 v98, s31, v98
  v_xor_b32 v102, s31, v102
  v_xor_b32 v106, s31, v106
  v_xor_b32 v110, s31, v110
  v_xor_b32 v114, s31, v114
  v_xor_b32 v118, s31, v118
  v_xor_b32 v122, s31, v122
  v_xor_b32 v126, s31, v126
  v_or3_b32 v10, v98, v102, v106
  v_or3_b32 v12, v110, v114, v118
  v_or3_b32 v10, v10, v122, v126
  v_or_b32 v10, v10, v12
  v_cmp_ne_u32 vcc, 0, v10
  s_cbranch_vccz L_stat_12_done
  s_sub_u32 s95, s95, 1
  s_cmp_lg_u32 s95, 0
  s_cbranch_scc1 L_stat_12
L_stat_12_done:
  v_add_f32 v68, v96, v100
  v_add_f32 v69, v104, v108
  v_add_f32 v70, v112, v116
  v_add_f32 v71, v120, v124
  v_add_f32 v68, v68, v69
  v_add_f32 v69, v70, v71
  v_add_f32 v64, v68, v69
  v_add_f32 v72, v97, v101
  v_add_f32 v73, v105, v109
  v_add_f32 v74, v113, v117
  v_add_f32 v75, v121, v125
  v_add_f32 v72, v72, v73
  v_add_f32 v73, v74, v75
  v_add_f32 v65, v72, v73
  v_mov_b32 v67, v64
  s_nop 1
  v_permlane16_swap_b32 v64, v67
  v_add_f32 v64, v64, v67
  v_mul_f32 v64, 0x3d800000, v64
  v_sub_f32 v96, v96, v64
  v_sub_f32 v100, v100, v64
  v_sub_f32 v104, v104, v64
  v_sub_f32 v108, v108, v64
  v_sub_f32 v112, v112, v64
  v_sub_f32 v116, v116, v64
  v_sub_f32 v120, v120, v64
  v_sub_f32 v124, v124, v64
  v_mul_f32 v66, v96, v96
  v_mul_f32 v67, v100, v100
  v_fmac_f32 v66, v104, v104
  v_fmac_f32 v67, v108, v108
  v_fmac_f32 v66, v112, v112
  v_fmac_f32 v67, v116, v116
  v_fmac_f32 v66, v120, v120
  v_fmac_f32 v67, v124, v124
  v_add_f32 v66, v66, v67
  v_fmac_f32 v65, 0x42800000, v66
  v_mov_b32 v67, v65
  s_nop 1
  v_permlane16_swap_b32 v65, v67
  v_add_f32 v65, v65, v67
  v_mov_b32 v67, 0x3727c5ac
  v_fmac_f32 v67, 0x3a800000, v65
  v_rsq_f32 v68, v67
  s_nop 0
  v_mul_f32 v69, v64, v68
  v_mov_b32 v70, v68
  v_mov_b32 v71, v69
  s_nop 1
  v_permlane32_swap_b32 v68, v70
  v_permlane32_swap_b32 v69, v71
  v_fma_f32 v16, v16, v68, -v69
  v_fma_f32 v17, v17, v68, -v69
  v_fma_f32 v18, v18, v68, -v69
  v_fma_f32 v19, v19, v68, -v69
  v_fma_f32 v20, v20, v68, -v69
  v_fma_f32 v21, v21, v68, -v69
  v_fma_f32 v22, v22, v68, -v69
  v_fma_f32 v23, v23, v68, -v69
  v_fma_f32 v24, v24, v68, -v69
  v_fma_f32 v25, v25, v68, -v69
  v_fma_f32 v26, v26, v68, -v69
  v_fma_f32 v27, v27, v68, -v69
  v_fma_f32 v28, v28, v68, -v69
  v_fma_f32 v29, v29, v68, -v69
  v_fma_f32 v30, v30, v68, -v69
  v_fma_f32 v31, v31, v68, -v69
  v_fma_f32 v32, v32, v70, -v71
  v_fma_f32 v33, v33, v70, -v71
  v_fma_f32 v34, v34, v70, -v71
  v_fma_f32 v35, v35, v70, -v71
  v_fma_f32 v36, v36, v70, -v71
  v_fma_f32 v37, v37, v70, -v71
  v_fma_f32 v38, v38, v70, -v71
  v_fma_f32 v39, v39, v70, -v71
  v_fma_f32 v40, v40, v70, -v71
  v_fma_f32 v41, v41, v70, -v71
  v_fma_f32 v42, v42, v70, -v71
  v_fma_f32 v43, v43, v70, -v71
  v_fma_f32 v44, v44, v70, -v71
  v_fma_f32 v45, v45, v70, -v71
  v_fma_f32 v46, v46, v70, -v71
  v_fma_f32 v47, v47, v70, -v71
  v_cvt_pk_bf16_f32 v48, v16, v17
  v_cvt_pk_bf16_f32 v49, v18, v19
  v_cvt_pk_bf16_f32 v50, v20, v21
  v_cvt_pk_bf16_f32 v51, v22, v23
  v_cvt_pk_bf16_f32 v52, v24, v25
  v_cvt_pk_bf16_f32 v53, v26, v27
  v_cvt_pk_bf16_f32 v54, v28, v29
  v_cvt_pk_bf16_f32 v55, v30, v31
  v_cvt_pk_bf16_f32 v56, v32, v33
  v_cvt_pk_bf16_f32 v57, v34, v35
  v_cvt_pk_bf16_f32 v58, v36, v37
  v_cvt_pk_bf16_f32 v59, v38, v39
  v_cvt_pk_bf16_f32 v60, v40, v41
  v_cvt_pk_bf16_f32 v61, v42, v43
  v_cvt_pk_bf16_f32 v62, v44, v45
  v_cvt_pk_bf16_f32 v63, v46, v47
  ds_write_b128 v200, v[48:51] offset:0
  ds_write_b128 v201, v[52:55] offset:0
  ds_write_b128 v200, v[56:59] offset:2048
  ds_write_b128 v201, v[60:63] offset:2048
  s_waitcnt lgkmcnt(0)
  s_barrier
  ds_read_b64_tr_b16 v[48:49], v224 offset:0
  ds_read_b64_tr_b16 v[50:51], v225 offset:0
  ds_read_b64_tr_b16 v[52:53], v226 offset:0
  ds_read_b64_tr_b16 v[54:55], v227 offset:0
  ds_read_b64_tr_b16 v[56:57], v228 offset:0
  ds_read_b64_tr_b16 v[58:59], v229 offset:0
  ds_read_b64_tr_b16 v[60:61], v230 offset:0
  ds_read_b64_tr_b16 v[62:63], v231 offset:0
  ds_read_b64_tr_b16 v[64:65], v224 offset:4096
  ds_read_b64_tr_b16 v[66:67], v225 offset:4096
  ds_read_b64_tr_b16 v[68:69], v226 offset:4096
  ds_read_b64_tr_b16 v[70:71], v227 offset:4096
  s_waitcnt lgkmcnt(10)
  v_mfma_f32_16x16x32_bf16 v[184:187], v[48:51], v[152:155], 0
  v_mfma_f32_16x16x32_bf16 v[200:203], v[48:51], v[168:171], 0
  ds_read_b64_tr_b16 v[72:73], v228 offset:4096
  ds_read_b64_tr_b16 v[74:75], v229 offset:4096
  s_waitcnt lgkmcnt(10)
  v_mfma_f32_16x16x32_bf16 v[188:191], v[52:55], v[152:155], 0
  v_mfma_f32_16x16x32_bf16 v[204:207], v[52:55], v[168:171], 0
  ds_read_b64_tr_b16 v[76:77], v230 offset:4096
  ds_read_b64_tr_b16 v[78:79], v231 offset:4096
  s_waitcnt lgkmcnt(10)
  v_mfma_f32_16x16x32_bf16 v[192:195], v[56:59], v[152:155], 0
  v_mfma_f32_16x16x32_bf16 v[208:211], v[56:59], v[168:171], 0
  ds_read_b64_tr_b16 v[48:49], v224 offset:8192
  ds_read_b64_tr_b16 v[50:51], v225 offset:8192
  buffer_store_dwordx4 v[80:83], v222, s[4:7], s92 offen sc1
  s_add_u32 s92, s92, 16384
  s_waitcnt lgkmcnt(10)
  v_mfma_f32_16x16x32_bf16 v[196:199], v[60:63], v[152:155], 0
  v_mfma_f32_16x16x32_bf16 v[212:215], v[60:63], v[168:171], 0
  ds_read_b64_tr_b16 v[52:53], v226 offset:8192
  ds_read_b64_tr_b16 v[54:55], v227 offset:8192
  s_waitcnt lgkmcnt(10)
  v_mfma_f32_16x16x32_bf16 v[184:187], v[64:67], v[156:159], v[184:187]
  v_mfma_f32_16x16x32_bf16 v[200:203], v[64:67], v[172:175], v[200:203]
  ds_read_b64_tr_b16 v[56:57], v228 offset:8192
  ds_read_b64_tr_b16 v[58:59], v229 offset:8192
  s_waitcnt lgkmcnt(10)
  v_mfma_f32_16x16x32_bf16 v[188:191], v[68:71], v[156:159], v[188:191]
  v_mfma_f32_16x16x32_bf16 v[204:207], v[68:71], v[172:175], v[204:207]
  ds_read_b64_tr_b16 v[60:61], v230 offset:8192
  ds_read_b64_tr_b16 v[62:63], v231 offset:8192
  buffer_store_dwordx4 v[84:87], v222, s[4:7], s92 offen sc1
  s_add_u32 s92, s92, 16384
  s_waitcnt lgkmcnt(10)
  v_mfma_f32_16x16x32_bf16 v[192:195], v[72:75], v[156:159], v[192:195]
  v_mfma_f32_16x16x32_bf16 v[208:211], v[72:75], v[172:175], v[208:211]
  ds_read_b64_tr_b16 v[64:65], v224 offset:12288
  ds_read_b64_tr_b16 v[66:67], v225 offset:12288
  s_waitcnt lgkmcnt(10)
  v_mfma_f32_16x16x32_bf16 v[196:199], v[76:79], v[156:159], v[196:199]
  v_mfma_f32_16x16x32_bf16 v[212:215], v[76:79], v[172:175], v[212:215]
  ds_read_b64_tr_b16 v[68:69], v226 offset:12288
  ds_read_b64_tr_b16 v[70:71], v227 offset:12288
  s_waitcnt lgkmcnt(10)
  v_mfma_f32_16x16x32_bf16 v[184:187], v[48:51], v[160:163], v[184:187]
  v_mfma_f32_16x16x32_bf16 v[200:203], v[48:51], v[176:179], v[200:203]
  ds_read_b64_tr_b16 v[72:73], v228 offset:12288
  ds_read_b64_tr_b16 v[74:75], v229 offset:12288
  buffer_store_dwordx4 v[88:91], v222, s[4:7], s92 offen sc1
  s_add_u32 s92, s92, 16384
  s_waitcnt lgkmcnt(10)
  v_mfma_f32_16x16x32_bf16 v[188:191], v[52:55], v[160:163], v[188:191]
  v_mfma_f32_16x16x32_bf16 v[204:207], v[52:55], v[176:179], v[204:207]
  ds_read_b64_tr_b16 v[76:77], v230 offset:12288
  ds_read_b64_tr_b16 v[78:79], v231 offset:12288
  s_waitcnt lgkmcnt(10)
  v_mfma_f32_16x16x32_bf16 v[192:195], v[56:59], v[160:163], v[192:195]
  v_mfma_f32_16x16x32_bf16 v[208:211], v[56:59], v[176:179], v[208:211]
  ds_read_b128 v[112:115], v250 offset:0
  s_waitcnt lgkmcnt(9)
  v_mfma_f32_16x16x32_bf16 v[196:199], v[60:63], v[160:163], v[196:199]
  v_mfma_f32_16x16x32_bf16 v[212:215], v[60:63], v[176:179], v[212:215]
  buffer_store_dwordx4 v[92:95], v222, s[4:7], s92 offen sc1
  ds_read_b128 v[116:119], v250 offset:1024
  s_waitcnt lgkmcnt(8)
  v_mfma_f32_16x16x32_bf16 v[184:187], v[64:67], v[164:167], v[184:187]
  v_mfma_f32_16x16x32_bf16 v[200:203], v[64:67], v[180:183], v[200:203]
  ds_read_b128 v[120:123], v250 offset:2048
  s_waitcnt lgkmcnt(7)
  v_mfma_f32_16x16x32_bf16 v[188:191], v[68:71], v[164:167], v[188:191]
  v_mfma_f32_16x16x32_bf16 v[204:207], v[68:71], v[180:183], v[204:207]
  ds_read_b128 v[124:127], v250 offset:3072
  s_waitcnt lgkmcnt(6)
  v_mfma_f32_16x16x32_bf16 v[192:195], v[72:75], v[164:167], v[192:195]
  v_mfma_f32_16x16x32_bf16 v[208:211], v[72:75], v[180:183], v[208:211]
  ds_read_b128 v[128:131], v250 offset:4096
  s_waitcnt lgkmcnt(5)
  v_mfma_f32_16x16x32_bf16 v[196:199], v[76:79], v[164:167], v[196:199]
  v_mfma_f32_16x16x32_bf16 v[212:215], v[76:79], v[180:183], v[212:215]
  ds_read_b128 v[132:135], v250 offset:5120
  v_cvt_pk_bf16_f32 v216, v184, v185
  v_cvt_pk_bf16_f32 v217, v186, v187
  v_cvt_pk_bf16_f32 v218, v188, v189
  v_cvt_pk_bf16_f32 v219, v190, v191
  v_cvt_pk_bf16_f32 v220, v192, v193
  v_cvt_pk_bf16_f32 v221, v194, v195
  v_cvt_pk_bf16_f32 v222, v196, v197
  v_cvt_pk_bf16_f32 v223, v198, v199
  v_cvt_pk_bf16_f32 v224, v200, v201
  v_cvt_pk_bf16_f32 v225, v202, v203
  v_cvt_pk_bf16_f32 v226, v204, v205
  v_cvt_pk_bf16_f32 v227, v206, v207
  v_cvt_pk_bf16_f32 v228, v208, v209
  v_cvt_pk_bf16_f32 v229, v210, v211
  v_cvt_pk_bf16_f32 v230, v212, v213
  v_cvt_pk_bf16_f32 v231, v214, v215
  v_cndmask_b32 v232, v224, 0, s[76:77]
  v_cndmask_b32 v233, v225, 0, s[76:77]
  v_cndmask_b32 v234, v226, 0, s[76:77]
  v_cndmask_b32 v235, v227, 0, s[76:77]
  v_cndmask_b32 v236, v228, 0, s[76:77]
  v_cndmask_b32 v237, v229, 0, s[76:77]
  v_cndmask_b32 v238, v230, 0, s[76:77]
  v_cndmask_b32 v239, v231, 0, s[76:77]
  s_waitcnt lgkmcnt(5)
  v_mfma_f32_16x16x32_bf16 v[48:51], v[112:115], v[216:219], 0
  v_mfma_f32_16x16x32_bf16 v[80:83], v[112:115], v[224:227], 0
  ds_read_b128 v[136:139], v250 offset:6144
  s_waitcnt lgkmcnt(5)
  v_mfma_f32_16x16x32_bf16 v[48:51], v[116:119], v[220:223], v[48:51]
  v_mfma_f32_16x16x32_bf16 v[80:83], v[116:119], v[228:231], v[80:83]
  ds_read_b128 v[140:143], v250 offset:7168
  s_waitcnt lgkmcnt(5)
  v_mfma_f32_16x16x32_bf16 v[48:51], v[120:123], v[232:235], v[48:51]
  ds_read_b128 v[112:115], v250 offset:8192
  s_waitcnt lgkmcnt(5)
  v_mfma_f32_16x16x32_bf16 v[48:51], v[124:127], v[236:239], v[48:51]
  ds_read_b128 v[116:119], v250 offset:9216
  s_waitcnt lgkmcnt(5)
  v_mfma_f32_16x16x32_bf16 v[52:55], v[128:131], v[216:219], 0
  v_mfma_f32_16x16x32_bf16 v[84:87], v[128:131], v[224:227], 0
  ds_read_b128 v[120:123], v250 offset:10240
  s_waitcnt lgkmcnt(5)
  v_mfma_f32_16x16x32_bf16 v[52:55], v[132:135], v[220:223], v[52:55]
  v_mfma_f32_16x16x32_bf16 v[84:87], v[132:135], v[228:231], v[84:87]
  ds_read_b128 v[124:127], v250 offset:11264
  s_waitcnt lgkmcnt(5)
  v_mfma_f32_16x16x32_bf16 v[52:55], v[136:139], v[232:235], v[52:55]
  ds_read_b128 v[128:131], v250 offset:12288
  s_waitcnt lgkmcnt(5)
  v_mfma_f32_16x16x32_bf16 v[52:55], v[140:143], v[236:239], v[52:55]
  ds_read_b128 v[132:135], v250 offset:13312
  s_waitcnt lgkmcnt(5)
  v_mfma_f32_16x16x32_bf16 v[56:59], v[112:115], v[216:219], 0
  v_mfma_f32_16x16x32_bf16 v[88:91], v[112:115], v[224:227], 0
  ds_read_b128 v[136:139], v250 offset:14336
  s_waitcnt lgkmcnt(5)
  v_mfma_f32_16x16x32_bf16 v[56:59], v[116:119], v[220:223], v[56:59]
  v_mfma_f32_16x16x32_bf16 v[88:91], v[116:119], v[228:231], v[88:91]
  ds_read_b128 v[140:143], v250 offset:15360
  s_waitcnt lgkmcnt(5)
  v_mfma_f32_16x16x32_bf16 v[56:59], v[120:123], v[232:235], v[56:59]
  ds_read_b128 v[112:115], v250 offset:16384
  s_waitcnt lgkmcnt(5)
  v_mfma_f32_16x16x32_bf16 v[56:59], v[124:127], v[236:239], v[56:59]
  ds_read_b128 v[116:119], v250 offset:17408
  s_waitcnt lgkmcnt(5)
  v_mfma_f32_16x16x32_bf16 v[60:63], v[128:131], v[216:219], 0
  v_mfma_f32_16x16x32_bf16 v[92:95], v[128:131], v[224:227], 0
  ds_read_b128 v[120:123], v250 offset:18432
  s_waitcnt lgkmcnt(5)
  v_mfma_f32_16x16x32_bf16 v[60:63], v[132:135], v[220:223], v[60:63]
  v_mfma_f32_16x16x32_bf16 v[92:95], v[132:135], v[228:231], v[92:95]
  ds_read_b128 v[124:127], v250 offset:19456
  v_cvt_pk_bf16_f32 v144, v48, v49
  v_cvt_pk_bf16_f32 v145, v50, v51
  v_cvt_pk_bf16_f32 v146, v52, v53
  v_cvt_pk_bf16_f32 v147, v54, v55
  buffer_store_dwordx4 v[144:147], v248, s[4:7], s93 offen offset:0 sc1
  s_cmp_lg_u32 s30, 0
  s_cbranch_scc1 L_nyq_13
  v_cvt_pk_bf16_f32 v160, v80, v81
  v_cvt_pk_bf16_f32 v161, v82, v83
  v_cvt_pk_bf16_f32 v162, v84, v85
  v_cvt_pk_bf16_f32 v163, v86, v87
  s_add_u32 s80, s93, 4194304
  s_mov_b32 exec_lo, 0x00010001
  s_mov_b32 exec_hi, 0x00010001
  buffer_store_dwordx4 v[160:163], v249, s[4:7], s80 offen offset:0 sc1
  s_mov_b64 exec, -1
L_nyq_13:
  s_waitcnt lgkmcnt(5)
  v_mfma_f32_16x16x32_bf16 v[60:63], v[136:139], v[232:235], v[60:63]
  ds_read_b128 v[128:131], v250 offset:20480
  s_waitcnt lgkmcnt(5)
  v_mfma_f32_16x16x32_bf16 v[60:63], v[140:143], v[236:239], v[60:63]
  ds_read_b128 v[132:135], v250 offset:21504
  s_waitcnt lgkmcnt(5)
  v_mfma_f32_16x16x32_bf16 v[64:67], v[112:115], v[216:219], 0
  v_mfma_f32_16x16x32_bf16 v[96:99], v[112:115], v[224:227], 0
  ds_read_b128 v[136:139], v250 offset:22528
  s_waitcnt lgkmcnt(5)
  v_mfma_f32_16x16x32_bf16 v[64:67], v[116:119], v[220:223], v[64:67]
  v_mfma_f32_16x16x32_bf16 v[96:99], v[116:119], v[228:231], v[96:99]
  ds_read_b128 v[140:143], v250 offset:23552
  s_waitcnt lgkmcnt(5)
  v_mfma_f32_16x16x32_bf16 v[64:67], v[120:123], v[232:235], v[64:67]
  ds_read_b128 v[112:115], v250 offset:24576
  s_waitcnt lgkmcnt(5)
  v_mfma_f32_16x16x32_bf16 v[64:67], v[124:127], v[236:239], v[64:67]
  ds_read_b128 v[116:119], v250 offset:25600
  s_waitcnt lgkmcnt(5)
  v_mfma_f32_16x16x32_bf16 v[68:71], v[128:131], v[216:219], 0
  v_mfma_f32_16x16x32_bf16 v[100:103], v[128:131], v[224:227], 0
  ds_read_b128 v[120:123], v250 offset:26624
  s_waitcnt lgkmcnt(5)
  v_mfma_f32_16x16x32_bf16 v[68:71], v[132:135], v[220:223], v[68:71]
  v_mfma_f32_16x16x32_bf16 v[100:103], v[132:135], v[228:231], v[100:103]
  ds_read_b128 v[124:127], v250 offset:27648
  v_cvt_pk_bf16_f32 v148, v56, v57
  v_cvt_pk_bf16_f32 v149, v58, v59
  v_cvt_pk_bf16_f32 v150, v60, v61
  v_cvt_pk_bf16_f32 v151, v62, v63
  buffer_store_dwordx4 v[148:151], v248, s[4:7], s93 offen offset:64 sc1
  s_cmp_lg_u32 s30, 0
  s_cbranch_scc1 L_nyq_14
  v_cvt_pk_bf16_f32 v164, v88, v89
  v_cvt_pk_bf16_f32 v165, v90, v91
  v_cvt_pk_bf16_f32 v166, v92, v93
  v_cvt_pk_bf16_f32 v167, v94, v95
  s_add_u32 s80, s93, 4194304
  s_mov_b32 exec_lo, 0x00010001
  s_mov_b32 exec_hi, 0x00010001
  buffer_store_dwordx4 v[164:167], v249, s[4:7], s80 offen offset:64 sc1
  s_mov_b64 exec, -1
L_nyq_14:
  s_waitcnt lgkmcnt(5)
  v_mfma_f32_16x16x32_bf16 v[68:71], v[136:139], v[232:235], v[68:71]
  ds_read_b128 v[128:131], v250 offset:28672
  s_waitcnt lgkmcnt(5)
  v_mfma_f32_16x16x32_bf16 v[68:71], v[140:143], v[236:239], v[68:71]
  ds_read_b128 v[132:135], v250 offset:29696
  s_waitcnt lgkmcnt(5)
  v_mfma_f32_16x16x32_bf16 v[72:75], v[112:115], v[216:219], 0
  v_mfma_f32_16x16x32_bf16 v[104:107], v[112:115], v[224:227], 0
  ds_read_b128 v[136:139], v250 offset:30720
  s_waitcnt lgkmcnt(5)
  v_mfma_f32_16x16x32_bf16 v[72:75], v[116:119], v[220:223], v[72:75]
  v_mfma_f32_16x16x32_bf16 v[104:107], v[116:119], v[228:231], v[104:107]
  ds_read_b128 v[140:143], v250 offset:31744
  s_waitcnt lgkmcnt(5)
  v_mfma_f32_16x16x32_bf16 v[72:75], v[120:123], v[232:235], v[72:75]
  s_waitcnt lgkmcnt(4)
  v_mfma_f32_16x16x32_bf16 v[72:75], v[124:127], v[236:239], v[72:75]
  s_waitcnt lgkmcnt(3)
  v_mfma_f32_16x16x32_bf16 v[76:79], v[128:131], v[216:219], 0
  v_mfma_f32_16x16x32_bf16 v[108:111], v[128:131], v[224:227], 0
  s_waitcnt lgkmcnt(2)
  v_mfma_f32_16x16x32_bf16 v[76:79], v[132:135], v[220:223], v[76:79]
  v_mfma_f32_16x16x32_bf16 v[108:111], v[132:135], v[228:231], v[108:111]
  v_cvt_pk_bf16_f32 v152, v64, v65
  v_cvt_pk_bf16_f32 v153, v66, v67
  v_cvt_pk_bf16_f32 v154, v68, v69
  v_cvt_pk_bf16_f32 v155, v70, v71
  buffer_store_dwordx4 v[152:155], v248, s[4:7], s93 offen offset:128 sc1
  s_cmp_lg_u32 s30, 0
  s_cbranch_scc1 L_nyq_15
  v_cvt_pk_bf16_f32 v168, v96, v97
  v_cvt_pk_bf16_f32 v169, v98, v99
  v_cvt_pk_bf16_f32 v170, v100, v101
  v_cvt_pk_bf16_f32 v171, v102, v103
  s_add_u32 s80, s93, 4194304
  s_mov_b32 exec_lo, 0x00010001
  s_mov_b32 exec_hi, 0x00010001
  buffer_store_dwordx4 v[168:171], v249, s[4:7], s80 offen offset:128 sc1
  s_mov_b64 exec, -1
L_nyq_15:
  s_waitcnt lgkmcnt(1)
  v_mfma_f32_16x16x32_bf16 v[76:79], v[136:139], v[232:235], v[76:79]
  s_waitcnt lgkmcnt(0)
  v_mfma_f32_16x16x32_bf16 v[76:79], v[140:143], v[236:239], v[76:79]
  v_cvt_pk_bf16_f32 v156, v72, v73
  v_cvt_pk_bf16_f32 v157, v74, v75
  s_nop 5
  v_cvt_pk_bf16_f32 v158, v76, v77
  v_cvt_pk_bf16_f32 v159, v78, v79
  buffer_store_dwordx4 v[156:159], v248, s[4:7], s93 offen offset:192 sc1
  s_cmp_lg_u32 s30, 0
  s_cbranch_scc1 L_nyq_16
  v_cvt_pk_bf16_f32 v172, v104, v105
  v_cvt_pk_bf16_f32 v173, v106, v107
  v_cvt_pk_bf16_f32 v174, v108, v109
  v_cvt_pk_bf16_f32 v175, v110, v111
  s_add_u32 s80, s93, 4194304
  s_mov_b32 exec_lo, 0x00010001
  s_mov_b32 exec_hi, 0x00010001
  buffer_store_dwordx4 v[172:175], v249, s[4:7], s80 offen offset:192 sc1
  s_mov_b64 exec, -1
L_nyq_16:
  s_waitcnt vmcnt(0)
  s_barrier
  s_cmp_lg_u32 s30, 0
  s_cbranch_scc1 L_gb_17_w
  s_lshl_b32 s83, s32, 11
  s_add_u32 s83, s83, 53248
  s_and_b32 s79, s2, 7
  s_lshl_b32 s79, s79, 7
  v_mov_b32 v10, s79
  v_mov_b32 v11, 1
  s_mov_b64 exec, 1
  buffer_atomic_add v11, v10, s[4:7], s83 offen sc1
  s_mov_b64 exec, -1
L_gb_17_w:
  s_cmp_eq_u32 s32, 1
  s_cbranch_scc1 L_wpre_18
  s_mov_b32 s34, 0
  s_mov_b32 s50, 0
  s_mov_b32 s35, 2048
  s_mov_b32 s51, 6144
  s_mov_b32 s36, 4096
  s_mov_b32 s52, 12288
  s_mov_b32 s37, 6144
  s_mov_b32 s53, 18432
  s_mov_b32 s38, 8192
  s_mov_b32 s54, 24576
  s_mov_b32 s39, 10240
  s_mov_b32 s55, 30720
  s_mov_b32 s40, 12288
  s_mov_b32 s56, 36864
  s_mov_b32 s41, 14336
  s_mov_b32 s57, 43008
  s_mov_b32 s42, 16384
  s_mov_b32 s58, 49152
  s_mov_b32 s43, 18432
  s_mov_b32 s59, 55296
  s_mov_b32 s44, 20480
  s_mov_b32 s60, 61440
  s_mov_b32 s45, 22528
  s_mov_b32 s61, 67584
  s_mov_b32 s46, 24576
  s_mov_b32 s62, 73728
  s_mov_b32 s47, 26624
  s_mov_b32 s63, 79872
  s_mov_b32 s48, 28672
  s_mov_b32 s64, 86016
  s_mov_b32 s49, 30720
  s_mov_b32 s65, 92160
  s_mov_b32 s33, 0
  v_lshrrev_b32 v10, 3, v0
  v_bfe_u32 v11, v0, 4, 1
  v_bfe_u32 v12, v0, 1, 2
  v_xor_b32 v11, v11, v12
  v_and_b32 v12, 1, v0
  v_lshlrev_b32 v12, 4, v12
  s_mov_b32 s79, 393216
  v_mul_lo_u32 v10, s79, v10
  v_add_u32 v10, v10, v12
  s_mul_i32 s79, s30, 98304
  s_lshl_b32 s80, s29, 7
  s_add_u32 s79, s79, s80
  v_add_u32 v10, s79, v10
  v_lshl_add_u32 v4, v11, 5, v10
  v_xor_b32 v11, 2, v11
  v_lshl_add_u32 v5, v11, 5, v10
  v_add_u32 v5, 3145728, v5
  v_add_u32 v2, 2048, v4
  v_add_u32 v3, 2048, v5
  s_add_u32 m0, s94, 0
  s_nop 0
  buffer_load_dwordx4 v2, s[8:11], s50 offen lds
  buffer_load_dwordx4 v2, s[8:11], s50 offen offset:2048 lds
  s_add_u32 m0, s94, 1024
  s_nop 0
  buffer_load_dwordx4 v3, s[8:11], s50 offen lds
  buffer_load_dwordx4 v3, s[8:11], s50 offen offset:2048 lds
  s_add_u32 m0, s94, 16384
  s_nop 0
  buffer_load_dwordx4 v2, s[8:11], s51 offen lds
  buffer_load_dwordx4 v2, s[8:11], s51 offen offset:2048 lds
  s_add_u32 m0, s94, 17408
  s_nop 0
  buffer_load_dwordx4 v3, s[8:11], s51 offen lds
  buffer_load_dwordx4 v3, s[8:11], s51 offen offset:2048 lds
  s_add_u32 m0, s94, 32768
  s_nop 0
  buffer_load_dwordx4 v2, s[8:11], s52 offen lds
  buffer_load_dwordx4 v2, s[8:11], s52 offen offset:2048 lds
  s_add_u32 m0, s94, 33792
  s_nop 0
  buffer_load_dwordx4 v3, s[8:11], s52 offen lds
  buffer_load_dwordx4 v3, s[8:11], s52 offen offset:2048 lds
  s_add_u32 m0, s94, 49152
  s_nop 0
  buffer_load_dwordx4 v2, s[8:11], s53 offen lds
  buffer_load_dwordx4 v2, s[8:11], s53 offen offset:2048 lds
  s_add_u32 m0, s94, 50176
  s_nop 0
  buffer_load_dwordx4 v3, s[8:11], s53 offen lds
  buffer_load_dwordx4 v3, s[8:11], s53 offen offset:2048 lds
L_wpre_18:
  s_lshl_b32 s81, s69, 14
  s_add_u32 s81, s81, 163840
  buffer_load_dwordx4 v[144:147], v1, s[4:7], s81 offen sc1
  buffer_load_dwordx4 v[148:151], v1, s[4:7], s81 offen offset:1024 sc1
  buffer_load_dwordx4 v[152:155], v1, s[4:7], s81 offen offset:2048 sc1
  buffer_load_dwordx4 v[156:159], v1, s[4:7], s81 offen offset:3072 sc1
  s_add_u32 s81, s81, 4096
  buffer_load_dwordx4 v[160:163], v1, s[4:7], s81 offen sc1
  buffer_load_dwordx4 v[164:167], v1, s[4:7], s81 offen offset:1024 sc1
  buffer_load_dwordx4 v[168:171], v1, s[4:7], s81 offen offset:2048 sc1
  buffer_load_dwordx4 v[172:175], v1, s[4:7], s81 offen offset:3072 sc1
  s_add_u32 s81, s81, 4096
  buffer_load_dwordx4 v[176:179], v1, s[4:7], s81 offen sc1
  buffer_load_dwordx4 v[180:183], v1, s[4:7], s81 offen offset:1024 sc1
  buffer_load_dwordx4 v[184:187], v1, s[4:7], s81 offen offset:2048 sc1
  buffer_load_dwordx4 v[188:191], v1, s[4:7], s81 offen offset:3072 sc1
  s_add_u32 s81, s81, 4096
  buffer_load_dwordx4 v[192:195], v1, s[4:7], s81 offen sc1
  buffer_load_dwordx4 v[196:199], v1, s[4:7], s81 offen offset:1024 sc1
  buffer_load_dwordx4 v[200:203], v1, s[4:7], s81 offen offset:2048 sc1
  buffer_load_dwordx4 v[204:207], v1, s[4:7], s81 offen offset:3072 sc1
  s_lshr_b32 s79, s67, 1
  s_lshl_b32 s79, s79, 4
  s_add_u32 s82, s79, s66
  s_and_b32 s79, s67, 1
  s_lshl_b32 s79, s79, 10
  s_add_u32 s79, s79, s82
  v_bfe_u32 v16, v0, 2, 2
  v_bfe_u32 v17, v0, 1, 1
  v_lshl_add_u32 v16, v17, 2, v16
  v_lshlrev_b32 v16, 7, v16
  v_add_u32 v16, s79, v16
  v_sub_u32 v17, 0x800, v16
  s_cmp_lg_u32 s69, 0
  s_cselect_b64 vcc, -1, 0
  v_cndmask_b32 v16, v16, v17, vcc
  v_and_b32 v135, 15, v0
  s_lshl_b32 s79, s30, 4
  v_add_u32 v135, s79, v135
  v_sub_u32 v17, 64, v135
  v_and_b32 v17, 63, v17
  v_cndmask_b32 v135, v135, v17, vcc
  v_lshrrev_b32 v17, 4, v0
  v_lshlrev_b32 v17, 1, v17
  v_and_b32 v18, 1, v0
  v_cmp_eq_u32 s[84:85], 1, v18
  s_mov_b32 s79, 0x3a000000
  v_add_u32 v20, 0, v17
  v_mul_u32_u24 v20, v20, v16
  v_and_b32 v20, 2047, v20
  v_cvt_f32_u32 v20, v20
  v_mul_f32 v20, s79, v20
  v_add_u32 v21, 1, v17
  v_mul_u32_u24 v21, v21, v16
  v_and_b32 v21, 2047, v21
  v_cvt_f32_u32 v21, v21
  v_mul_f32 v21, s79, v21
  v_add_u32 v22, 8, v17
  v_mul_u32_u24 v22, v22, v16
  v_and_b32 v22, 2047, v22
  v_cvt_f32_u32 v22, v22
  v_mul_f32 v22, s79, v22
  v_add_u32 v23, 9, v17
  v_mul_u32_u24 v23, v23, v16
  v_and_b32 v23, 2047, v23
  v_cvt_f32_u32 v23, v23
  v_mul_f32 v23, s79, v23
  v_cos_f32 v24, v20
  v_sin_f32 v28, v20
  v_cos_f32 v25, v21
  v_sin_f32 v29, v21
  v_cos_f32 v26, v22
  v_sin_f32 v30, v22
  v_cos_f32 v27, v23
  v_sin_f32 v31, v23
  v_sub_f32 v32, 0, v28
  v_cndmask_b32 v36, v24, v32, s[84:85]
  v_cndmask_b32 v40, v28, v24, s[84:85]
  v_cvt_pk_bf16_f32 v240, v36, v40
  v_sub_f32 v33, 0, v29
  v_cndmask_b32 v37, v25, v33, s[84:85]
  v_cndmask_b32 v41, v29, v25, s[84:85]
  v_cvt_pk_bf16_f32 v241, v37, v41
  v_sub_f32 v34, 0, v30
  v_cndmask_b32 v38, v26, v34, s[84:85]
  v_cndmask_b32 v42, v30, v26, s[84:85]
  v_cvt_pk_bf16_f32 v242, v38, v42
  v_sub_f32 v35, 0, v31
  v_cndmask_b32 v39, v27, v35, s[84:85]
  v_cndmask_b32 v43, v31, v27, s[84:85]
  v_cvt_pk_bf16_f32 v243, v39, v43
  v_lshrrev_b32 v12, 3, v0
  v_xor_b32 v12, v12, v0
  v_and_b32 v12, 7, v12
  v_and_b32 v13, 56, v0
  v_or_b32 v12, v12, v13
  v_lshlrev_b32 v12, 4, v12
  s_lshl_b32 s79, s30, 5
  v_lshrrev_b32 v13, 4, v0
  v_lshlrev_b32 v13, 1, v13
  v_bfe_u32 v14, v0, 3, 1
  v_add_u32 v13, v13, v14
  v_mul_u32_u24 v13, 4128, v13
  v_bfe_u32 v14, v0, 2, 1
  v_lshl_add_u32 v13, v14, 7, v13
  v_and_b32 v14, 3, v0
  v_lshl_add_u32 v13, v14, 3, v13
  v_add_u32 v13, s79, v13
  s_mul_i32 s84, s68, 65536
  s_mul_i32 s80, s32, 0x900000
  s_add_u32 s84, s84, s80
  s_lshl_b32 s80, s32, 23
  s_add_u32 s84, s84, 50331648
  s_lshl_b32 s79, s30, 14
  s_add_u32 s84, s84, s79
  s_mul_i32 s81, s30, 16512
  s_add_u32 s81, s81, 97792
  v_add_u32 v13, 97792, v13
  v_mov_b32 v14, 0
  s_lshl_b32 s85, s66, 7
  s_lshl_b32 s79, s67, 3
  s_add_u32 s85, s85, s79
  s_lshl_b32 s85, s85, 11
  s_add_u32 s85, s85, s80
  s_add_u32 s85, s85, 20971520
  v_and_b32 v10, 15, v135
  v_lshrrev_b32 v11, 4, v135
  v_lshlrev_b32 v133, 1, v11
  v_and_b32 v132, 7, v10
  v_xor_b32 v132, v133, v132
  v_lshl_add_u32 v132, v10, 3, v132
  v_lshlrev_b32 v132, 4, v132
  v_lshrrev_b32 v131, 4, v0
  v_lshl_add_u32 v128, v131, 11, v132
  v_mov_b32 v136, v128
  v_add_u32 v128, 97792, v128
  v_xor_b32 v129, 16, v128
  v_lshlrev_b32 v10, 11, v10
  v_lshl_add_u32 v10, v131, 4, v10
  v_lshrrev_b32 v133, 1, v11
  v_lshl_add_u32 v10, v133, 10, v10
  v_and_b32 v11, 1, v11
  v_lshl_add_u32 v133, v11, 9, v10
  v_lshlrev_b32 v131, 5, v131
  v_add_u32 v131, 114432, v131
  s_lshl_b32 s79, s30, 3
  v_add_u32 v130, s79, v131
  s_add_u32 s79, s94, 97792
  v_add_u32 v132, s79, v1
  v_lshrrev_b32 v11, 3, v0
  v_xor_b32 v11, v11, v0
  v_and_b32 v11, 7, v11
  v_and_b32 v10, 56, v0
  v_or_b32 v11, v11, v10
  v_lshlrev_b32 v134, 4, v11
  s_lshl_b32 s88, s66, 3
  s_lshr_b32 s80, s67, 1
  s_add_u32 s88, s88, s80
  s_lshl_b32 s88, s88, 15
  s_and_b32 s80, s67, 1
  s_lshl_b32 s80, s80, 7
  s_add_u32 s88, s88, s80
  s_add_u32 s88, s88, 12582912
  s_lshl_b32 s89, s66, 7
  s_lshl_b32 s80, s67, 3
  s_add_u32 s89, s89, s80
  s_lshl_b32 s80, s30, 1
  s_add_u32 s89, s89, s80
  s_lshl_b32 s89, s89, 11
  s_add_u32 s89, s89, 25165824
  v_add_u32 v15, 80896, v136
  s_cmp_lg_u32 s30, 0
  s_cbranch_scc1 L_gw_19_skip
  v_min_u32 v10, 7, v0
  v_lshlrev_b32 v10, 7, v10
  s_mov_b32 s95, 131072
  buffer_load_dword v48, v10, s[4:7], s83 offen sc1
L_gw_20:
  s_waitcnt vmcnt(0)
  v_cmp_ne_u32 vcc, 32, v48
  s_cbranch_vccz L_gw_20_done
  buffer_load_dword v48, v10, s[4:7], s83 offen sc1
  s_sub_u32 s95, s95, 1
  s_cmp_lg_u32 s95, 0
  s_cbranch_scc1 L_gw_20
L_gw_20_done:
L_gw_19_skip:
  s_barrier
  s_or_b32 s79, s2, s30
  s_or_b32 s79, s79, s32
  s_cmp_lg_u32 s79, 0
  s_cbranch_scc1 L_tagwb_21
  v_mov_b32 v10, s31
  v_mov_b32 v11, 0
  s_mov_b64 exec, 1
  buffer_store_dword v10, v11, s[4:7], 0 offen sc1
  s_mov_b64 exec, -1
L_tagwb_21:
  s_add_u32 m0, s81, 0
  s_nop 0
  buffer_load_dwordx4 v1, s[4:7], s84 offen sc1 lds
  buffer_load_dwordx4 v1, s[4:7], s84 offen offset:1024 sc1 lds
  buffer_load_dwordx4 v1, s[4:7], s84 offen offset:2048 sc1 lds
  buffer_load_dwordx4 v1, s[4:7], s84 offen offset:3072 sc1 lds
  s_add_u32 s84, s84, 4096
  s_add_u32 m0, s81, 4128
  s_nop 0
  buffer_load_dwordx4 v1, s[4:7], s84 offen sc1 lds
  buffer_load_dwordx4 v1, s[4:7], s84 offen offset:1024 sc1 lds
  buffer_load_dwordx4 v1, s[4:7], s84 offen offset:2048 sc1 lds
  buffer_load_dwordx4 v1, s[4:7], s84 offen offset:3072 sc1 lds
  s_add_u32 s84, s84, 4096
  s_add_u32 m0, s81, 8256
  s_nop 0
  buffer_load_dwordx4 v1, s[4:7], s84 offen sc1 lds
  buffer_load_dwordx4 v1, s[4:7], s84 offen offset:1024 sc1 lds
  buffer_load_dwordx4 v1, s[4:7], s84 offen offset:2048 sc1 lds
  buffer_load_dwordx4 v1, s[4:7], s84 offen offset:3072 sc1 lds
  s_add_u32 s84, s84, 4096
  s_add_u32 m0, s81, 12384
  s_nop 0
  buffer_load_dwordx4 v1, s[4:7], s84 offen sc1 lds
  buffer_load_dwordx4 v1, s[4:7], s84 offen offset:1024 sc1 lds
  buffer_load_dwordx4 v1, s[4:7], s84 offen offset:2048 sc1 lds
  buffer_load_dwordx4 v1, s[4:7], s84 offen offset:3072 sc1 lds
  s_lshl_b32 s79, s30, 12
  s_add_u32 m0, s79, 80896
  s_add_u32 s85, s85, s79
  buffer_load_dwordx4 v12, s[4:7], s85 offen sc1 lds
  buffer_load_dwordx4 v12, s[4:7], s85 offen offset:1024 sc1 lds
  buffer_load_dwordx4 v12, s[4:7], s85 offen offset:2048 sc1 lds
  buffer_load_dwordx4 v12, s[4:7], s85 offen offset:3072 sc1 lds
  s_waitcnt vmcnt(4)
  s_barrier
  ds_read_b64_tr_b16 v[48:49], v13 offset:0
  ds_read_b64_tr_b16 v[50:51], v13 offset:33024
  ds_read_b64_tr_b16 v[52:53], v13 offset:256
  ds_read_b64_tr_b16 v[54:55], v13 offset:33280
  ds_read_b64_tr_b16 v[56:57], v13 offset:512
  ds_read_b64_tr_b16 v[58:59], v13 offset:33536
  ds_read_b64_tr_b16 v[60:61], v13 offset:768
  ds_read_b64_tr_b16 v[62:63], v13 offset:33792
  ds_read_b64_tr_b16 v[64:65], v13 offset:1024
  ds_read_b64_tr_b16 v[66:67], v13 offset:34048
  ds_read_b64_tr_b16 v[68:69], v13 offset:1280
  ds_read_b64_tr_b16 v[70:71], v13 offset:34304
  s_waitcnt lgkmcnt(10)
  v_mfma_f32_16x16x32_bf16 v[80:83], v[240:243], v[48:51], 0
  ds_read_b64_tr_b16 v[72:73], v13 offset:1536
  ds_read_b64_tr_b16 v[74:75], v13 offset:34560
  s_waitcnt lgkmcnt(10)
  v_mfma_f32_16x16x32_bf16 v[84:87], v[240:243], v[52:55], 0
  ds_read_b64_tr_b16 v[76:77], v13 offset:1792
  ds_read_b64_tr_b16 v[78:79], v13 offset:34816
  s_waitcnt lgkmcnt(10)
  v_mfma_f32_16x16x32_bf16 v[88:91], v[240:243], v[56:59], 0
  ds_read_b64_tr_b16 v[48:49], v13 offset:2048
  ds_read_b64_tr_b16 v[50:51], v13 offset:35072
  s_waitcnt lgkmcnt(10)
  v_mfma_f32_16x16x32_bf16 v[92:95], v[240:243], v[60:63], 0
  ds_read_b64_tr_b16 v[52:53], v13 offset:2304
  ds_read_b64_tr_b16 v[54:55], v13 offset:35328
  v_cvt_pk_bf16_f32 v208, v80, v81
  v_cvt_pk_bf16_f32 v224, v82, v83
  s_waitcnt lgkmcnt(10)
  v_mfma_f32_16x16x32_bf16 v[96:99], v[240:243], v[64:67], 0
  ds_read_b64_tr_b16 v[56:57], v13 offset:2560
  ds_read_b64_tr_b16 v[58:59], v13 offset:35584
  v_cvt_pk_bf16_f32 v209, v84, v85
  v_cvt_pk_bf16_f32 v225, v86, v87
  s_waitcnt lgkmcnt(10)
  v_mfma_f32_16x16x32_bf16 v[100:103], v[240:243], v[68:71], 0
  ds_read_b64_tr_b16 v[60:61], v13 offset:2816
  ds_read_b64_tr_b16 v[62:63], v13 offset:35840
  v_cvt_pk_bf16_f32 v210, v88, v89
  v_cvt_pk_bf16_f32 v226, v90, v91
  s_waitcnt lgkmcnt(10)
  v_mfma_f32_16x16x32_bf16 v[104:107], v[240:243], v[72:75], 0
  ds_read_b64_tr_b16 v[64:65], v13 offset:3072
  ds_read_b64_tr_b16 v[66:67], v13 offset:36096
  v_cvt_pk_bf16_f32 v211, v92, v93
  v_cvt_pk_bf16_f32 v227, v94, v95
  s_waitcnt lgkmcnt(10)
  v_mfma_f32_16x16x32_bf16 v[108:111], v[240:243], v[76:79], 0
  ds_read_b64_tr_b16 v[68:69], v13 offset:3328
  ds_read_b64_tr_b16 v[70:71], v13 offset:36352
  v_mfma_f32_16x16x32_bf16 v[16:19], v[144:147], v[208:211], 0
  v_mfma_f32_16x16x32_bf16 v[20:23], v[160:163], v[208:211], 0
  v_cvt_pk_bf16_f32 v212, v96, v97
  v_cvt_pk_bf16_f32 v228, v98, v99
  s_waitcnt lgkmcnt(10)
  v_mfma_f32_16x16x32_bf16 v[80:83], v[240:243], v[48:51], 0
  ds_read_b64_tr_b16 v[72:73], v13 offset:3584
  ds_read_b64_tr_b16 v[74:75], v13 offset:36608
  v_mfma_f32_16x16x32_bf16 v[24:27], v[176:179], v[208:211], 0
  v_mfma_f32_16x16x32_bf16 v[28:31], v[192:195], v[208:211], 0
  v_cvt_pk_bf16_f32 v213, v100, v101
  v_cvt_pk_bf16_f32 v229, v102, v103
  s_waitcnt lgkmcnt(10)
  v_mfma_f32_16x16x32_bf16 v[84:87], v[240:243], v[52:55], 0
  ds_read_b64_tr_b16 v[76:77], v13 offset:3840
  ds_read_b64_tr_b16 v[78:79], v13 offset:36864
  v_mfma_f32_16x16x32_bf16 v[32:35], v[144:147], v[224:227], 0
  v_mfma_f32_16x16x32_bf16 v[36:39], v[160:163], v[224:227], 0
  v_cvt_pk_bf16_f32 v214, v104, v105
  v_cvt_pk_bf16_f32 v230, v106, v107
  s_waitcnt lgkmcnt(10)
  v_mfma_f32_16x16x32_bf16 v[88:91], v[240:243], v[56:59], 0
  v_mfma_f32_16x16x32_bf16 v[40:43], v[176:179], v[224:227], 0
  v_mfma_f32_16x16x32_bf16 v[44:47], v[192:195], v[224:227], 0
  v_cvt_pk_bf16_f32 v215, v108, v109
  v_cvt_pk_bf16_f32 v231, v110, v111
  s_waitcnt lgkmcnt(8)
  v_mfma_f32_16x16x32_bf16 v[92:95], v[240:243], v[60:63], 0
  v_mfma_f32_16x16x32_bf16 v[16:19], v[148:151], v[212:215], v[16:19]
  v_mfma_f32_16x16x32_bf16 v[20:23], v[164:167], v[212:215], v[20:23]
  v_cvt_pk_bf16_f32 v216, v80, v81
  v_cvt_pk_bf16_f32 v232, v82, v83
  s_waitcnt lgkmcnt(6)
  v_mfma_f32_16x16x32_bf16 v[96:99], v[240:243], v[64:67], 0
  v_mfma_f32_16x16x32_bf16 v[24:27], v[180:183], v[212:215], v[24:27]
  v_mfma_f32_16x16x32_bf16 v[28:31], v[196:199], v[212:215], v[28:31]
  v_cvt_pk_bf16_f32 v217, v84, v85
  v_cvt_pk_bf16_f32 v233, v86, v87
  s_waitcnt lgkmcnt(4)
  v_mfma_f32_16x16x32_bf16 v[100:103], v[240:243], v[68:71], 0
  v_mfma_f32_16x16x32_bf16 v[32:35], v[148:151], v[228:231], v[32:35]
  v_mfma_f32_16x16x32_bf16 v[36:39], v[164:167], v[228:231], v[36:39]
  v_cvt_pk_bf16_f32 v218, v88, v89
  v_cvt_pk_bf16_f32 v234, v90, v91
  s_waitcnt lgkmcnt(2)
  v_mfma_f32_16x16x32_bf16 v[104:107], v[240:243], v[72:75], 0
  v_mfma_f32_16x16x32_bf16 v[40:43], v[180:183], v[228:231], v[40:43]
  v_mfma_f32_16x16x32_bf16 v[44:47], v[196:199], v[228:231], v[44:47]
  v_cvt_pk_bf16_f32 v219, v92, v93
  v_cvt_pk_bf16_f32 v235, v94, v95
  s_waitcnt lgkmcnt(0)
  v_mfma_f32_16x16x32_bf16 v[108:111], v[240:243], v[76:79], 0
  v_mfma_f32_16x16x32_bf16 v[16:19], v[152:155], v[216:219], v[16:19]
  v_mfma_f32_16x16x32_bf16 v[20:23], v[168:171], v[216:219], v[20:23]
  v_cvt_pk_bf16_f32 v220, v96, v97
  v_cvt_pk_bf16_f32 v236, v98, v99
  s_waitcnt vmcnt(0)
  s_barrier
  v_xor_b32 v14, 16, v15
  ds_read_b128 v[112:115], v15 offset:0
  ds_read_b128 v[116:119], v14 offset:0
  ds_read_b128 v[120:123], v15 offset:8192
  ds_read_b128 v[124:127], v14 offset:8192
  v_cvt_pk_bf16_f32 v221, v100, v101
  v_cvt_pk_bf16_f32 v237, v102, v103
  v_cvt_pk_bf16_f32 v222, v104, v105
  v_cvt_pk_bf16_f32 v238, v106, v107
  v_cvt_pk_bf16_f32 v223, v108, v109
  v_cvt_pk_bf16_f32 v239, v110, v111
  v_mfma_f32_16x16x32_bf16 v[24:27], v[184:187], v[216:219], v[24:27]
  v_mfma_f32_16x16x32_bf16 v[28:31], v[200:203], v[216:219], v[28:31]
  v_mfma_f32_16x16x32_bf16 v[32:35], v[152:155], v[232:235], v[32:35]
  v_mfma_f32_16x16x32_bf16 v[36:39], v[168:171], v[232:235], v[36:39]
  v_mfma_f32_16x16x32_bf16 v[40:43], v[184:187], v[232:235], v[40:43]
  v_mfma_f32_16x16x32_bf16 v[44:47], v[200:203], v[232:235], v[44:47]
  v_mfma_f32_16x16x32_bf16 v[16:19], v[156:159], v[220:223], v[16:19]
  v_mfma_f32_16x16x32_bf16 v[20:23], v[172:175], v[220:223], v[20:23]
  v_mfma_f32_16x16x32_bf16 v[24:27], v[188:191], v[220:223], v[24:27]
  v_mfma_f32_16x16x32_bf16 v[28:31], v[204:207], v[220:223], v[28:31]
  v_mfma_f32_16x16x32_bf16 v[32:35], v[156:159], v[236:239], v[32:35]
  v_mfma_f32_16x16x32_bf16 v[36:39], v[172:175], v[236:239], v[36:39]
  v_mfma_f32_16x16x32_bf16 v[40:43], v[188:191], v[236:239], v[40:43]
  v_mfma_f32_16x16x32_bf16 v[44:47], v[204:207], v[236:239], v[44:47]
  s_cmp_eq_u32 s69, 0
  s_cbranch_scc1 L_rot_22
  s_cmp_lg_u32 s30, 0
  s_cbranch_scc1 L_rot_22
  s_mov_b32 s84, 0x00010001
  s_mov_b32 s85, 0x00010001
  v_mov_b32 v48, v31
  v_cndmask_b32 v31, v31, v30, s[84:85]
  v_cndmask_b32 v30, v30, v29, s[84:85]
  v_cndmask_b32 v29, v29, v28, s[84:85]
  v_cndmask_b32 v28, v28, v27, s[84:85]
  v_cndmask_b32 v27, v27, v26, s[84:85]
  v_cndmask_b32 v26, v26, v25, s[84:85]
  v_cndmask_b32 v25, v25, v24, s[84:85]
  v_cndmask_b32 v24, v24, v23, s[84:85]
  v_cndmask_b32 v23, v23, v22, s[84:85]
  v_cndmask_b32 v22, v22, v21, s[84:85]
  v_cndmask_b32 v21, v21, v20, s[84:85]
  v_cndmask_b32 v20, v20, v19, s[84:85]
  v_cndmask_b32 v19, v19, v18, s[84:85]
  v_cndmask_b32 v18, v18, v17, s[84:85]
  v_cndmask_b32 v17, v17, v16, s[84:85]
  v_cndmask_b32 v16, v16, v48, s[84:85]
  v_mov_b32 v48, v47
  v_cndmask_b32 v47, v47, v46, s[84:85]
  v_cndmask_b32 v46, v46, v45, s[84:85]
  v_cndmask_b32 v45, v45, v44, s[84:85]
  v_cndmask_b32 v44, v44, v43, s[84:85]
  v_cndmask_b32 v43, v43, v42, s[84:85]
  v_cndmask_b32 v42, v42, v41, s[84:85]
  v_cndmask_b32 v41, v41, v40, s[84:85]
  v_cndmask_b32 v40, v40, v39, s[84:85]
  v_cndmask_b32 v39, v39, v38, s[84:85]
  v_cndmask_b32 v38, v38, v37, s[84:85]
  v_cndmask_b32 v37, v37, v36, s[84:85]
  v_cndmask_b32 v36, v36, v35, s[84:85]
  v_cndmask_b32 v35, v35, v34, s[84:85]
  v_cndmask_b32 v34, v34, v33, s[84:85]
  v_cndmask_b32 v33, v33, v32, s[84:85]
  v_cndmask_b32 v32, v32, v48, s[84:85]
L_rot_22:
  v_mov_b32 v10, 0x00003f80
  v_mov_b32 v11, 0x3f800000
  s_waitcnt lgkmcnt(0)
  v_dot2_f32_bf16 v16, v112, v10, v16
  v_dot2_f32_bf16 v17, v112, v11, v17
  v_dot2_f32_bf16 v18, v113, v10, v18
  v_dot2_f32_bf16 v19, v113, v11, v19
  v_dot2_f32_bf16 v20, v114, v10, v20
  v_dot2_f32_bf16 v21, v114, v11, v21
  v_dot2_f32_bf16 v22, v115, v10, v22
  v_dot2_f32_bf16 v23, v115, v11, v23
  v_dot2_f32_bf16 v24, v116, v10, v24
  v_dot2_f32_bf16 v25, v116, v11, v25
  v_dot2_f32_bf16 v26, v117, v10, v26
  v_dot2_f32_bf16 v27, v117, v11, v27
  v_dot2_f32_bf16 v28, v118, v10, v28
  v_dot2_f32_bf16 v29, v118, v11, v29
  v_dot2_f32_bf16 v30, v119, v10, v30
  v_dot2_f32_bf16 v31, v119, v11, v31
  v_dot2_f32_bf16 v32, v120, v10, v32
  v_dot2_f32_bf16 v33, v120, v11, v33
  v_dot2_f32_bf16 v34, v121, v10, v34
  v_dot2_f32_bf16 v35, v121, v11, v35
  v_dot2_f32_bf16 v36, v122, v10, v36
  v_dot2_f32_bf16 v37, v122, v11, v37
  v_dot2_f32_bf16 v38, v123, v10, v38
  v_dot2_f32_bf16 v39, v123, v11, v39
  v_dot2_f32_bf16 v40, v124, v10, v40
  v_dot2_f32_bf16 v41, v124, v11, v41
  v_dot2_f32_bf16 v42, v125, v10, v42
  v_dot2_f32_bf16 v43, v125, v11, v43
  v_dot2_f32_bf16 v44, v126, v10, v44
  v_dot2_f32_bf16 v45, v126, v11, v45
  v_dot2_f32_bf16 v46, v127, v10, v46
  v_dot2_f32_bf16 v47, v127, v11, v47
  s_cmp_eq_u32 s32, 1
  s_cbranch_scc1 L_fin_23
  v_add_f32 v80, v16, v17
  v_add_f32 v81, v18, v19
  v_add_f32 v82, v20, v21
  v_add_f32 v83, v22, v23
  v_add_f32 v84, v24, v25
  v_add_f32 v85, v26, v27
  v_add_f32 v86, v28, v29
  v_add_f32 v87, v30, v31
  v_add_f32 v80, v80, v81
  v_add_f32 v81, v82, v83
  v_add_f32 v82, v84, v85
  v_add_f32 v83, v86, v87
  v_add_f32 v80, v80, v81
  v_add_f32 v81, v82, v83
  v_add_f32 v66, v80, v81
  v_add_f32 v88, v32, v33
  v_add_f32 v89, v34, v35
  v_add_f32 v90, v36, v37
  v_add_f32 v91, v38, v39
  v_add_f32 v92, v40, v41
  v_add_f32 v93, v42, v43
  v_add_f32 v94, v44, v45
  v_add_f32 v95, v46, v47
  v_add_f32 v88, v88, v89
  v_add_f32 v89, v90, v91
  v_add_f32 v90, v92, v93
  v_add_f32 v91, v94, v95
  v_add_f32 v88, v88, v89
  v_add_f32 v89, v90, v91
  v_add_f32 v67, v88, v89
  v_add_f32_dpp v70, v66, v66 row_ror:8 row_mask:0xf bank_mask:0xf
  s_nop 0
  v_add_f32_dpp v71, v67, v67 row_ror:8 row_mask:0xf bank_mask:0xf
  v_add_f32_dpp v66, v70, v70 row_ror:4 row_mask:0xf bank_mask:0xf
  s_nop 0
  v_add_f32_dpp v67, v71, v71 row_ror:4 row_mask:0xf bank_mask:0xf
  v_add_f32_dpp v70, v66, v66 row_ror:2 row_mask:0xf bank_mask:0xf
  s_nop 0
  v_add_f32_dpp v71, v67, v67 row_ror:2 row_mask:0xf bank_mask:0xf
  v_add_f32_dpp v66, v70, v70 row_ror:1 row_mask:0xf bank_mask:0xf
  s_nop 0
  v_add_f32_dpp v67, v71, v71 row_ror:1 row_mask:0xf bank_mask:0xf
  v_mul_f32 v74, 0x3b800000, v66
  v_mul_f32 v76, 0x3b800000, v67
  v_sub_f32 v80, v16, v74
  v_sub_f32 v81, v17, v74
  v_sub_f32 v82, v18, v74
  v_sub_f32 v83, v19, v74
  v_sub_f32 v84, v20, v74
  v_sub_f32 v85, v21, v74
  v_sub_f32 v86, v22, v74
  v_sub_f32 v87, v23, v74
  v_sub_f32 v88, v24, v74
  v_sub_f32 v89, v25, v74
  v_sub_f32 v90, v26, v74
  v_sub_f32 v91, v27, v74
  v_sub_f32 v92, v28, v74
  v_sub_f32 v93, v29, v74
  v_sub_f32 v94, v30, v74
  v_sub_f32 v95, v31, v74
  v_sub_f32 v96, v32, v76
  v_sub_f32 v97, v33, v76
  v_sub_f32 v98, v34, v76
  v_sub_f32 v99, v35, v76
  v_sub_f32 v100, v36, v76
  v_sub_f32 v101, v37, v76
  v_sub_f32 v102, v38, v76
  v_sub_f32 v103, v39, v76
  v_sub_f32 v104, v40, v76
  v_sub_f32 v105, v41, v76
  v_sub_f32 v106, v42, v76
  v_sub_f32 v107, v43, v76
  v_sub_f32 v108, v44, v76
  v_sub_f32 v109, v45, v76
  v_sub_f32 v110, v46, v76
  v_sub_f32 v111, v47, v76
  v_mul_f32 v112, v80, v80
  v_mul_f32 v113, v81, v81
  v_mul_f32 v114, v82, v82
  v_mul_f32 v115, v83, v83
  v_fmac_f32 v112, v84, v84
  v_fmac_f32 v113, v85, v85
  v_fmac_f32 v114, v86, v86
  v_fmac_f32 v115, v87, v87
  v_fmac_f32 v112, v88, v88
  v_fmac_f32 v113, v89, v89
  v_fmac_f32 v114, v90, v90
  v_fmac_f32 v115, v91, v91
  v_fmac_f32 v112, v92, v92
  v_fmac_f32 v113, v93, v93
  v_fmac_f32 v114, v94, v94
  v_fmac_f32 v115, v95, v95
  v_add_f32 v120, v112, v113
  v_add_f32 v121, v114, v115
  v_add_f32 v66, v120, v121
  v_mul_f32 v116, v96, v96
  v_mul_f32 v117, v97, v97
  v_mul_f32 v118, v98, v98
  v_mul_f32 v119, v99, v99
  v_fmac_f32 v116, v100, v100
  v_fmac_f32 v117, v101, v101
  v_fmac_f32 v118, v102, v102
  v_fmac_f32 v119, v103, v103
  v_fmac_f32 v116, v104, v104
  v_fmac_f32 v117, v105, v105
  v_fmac_f32 v118, v106, v106
  v_fmac_f32 v119, v107, v107
  v_fmac_f32 v116, v108, v108
  v_fmac_f32 v117, v109, v109
  v_fmac_f32 v118, v110, v110
  v_fmac_f32 v119, v111, v111
  v_add_f32 v122, v116, v117
  v_add_f32 v123, v118, v119
  v_add_f32 v67, v122, v123
  v_add_f32_dpp v70, v66, v66 row_ror:8 row_mask:0xf bank_mask:0xf
  s_nop 0
  v_add_f32_dpp v71, v67, v67 row_ror:8 row_mask:0xf bank_mask:0xf
  v_add_f32_dpp v66, v70, v70 row_ror:4 row_mask:0xf bank_mask:0xf
  s_nop 0
  v_add_f32_dpp v67, v71, v71 row_ror:4 row_mask:0xf bank_mask:0xf
  v_add_f32_dpp v70, v66, v66 row_ror:2 row_mask:0xf bank_mask:0xf
  s_nop 0
  v_add_f32_dpp v71, v67, v67 row_ror:2 row_mask:0xf bank_mask:0xf
  v_add_f32_dpp v66, v70, v70 row_ror:1 row_mask:0xf bank_mask:0xf
  s_nop 0
  v_add_f32_dpp v67, v71, v71 row_ror:1 row_mask:0xf bank_mask:0xf
  v_mov_b32 v75, v66
  v_mov_b32 v77, v67
  s_mov_b32 exec_lo, 0x00010001
  s_mov_b32 exec_hi, 0x00010001
  ds_write_b64 v130, v[74:75]
  ds_write_b64 v130, v[76:77] offset:128
  s_mov_b64 exec, -1
  s_waitcnt lgkmcnt(0)
  s_barrier
  ds_read_b128 v[80:83], v131 offset:0
  ds_read_b128 v[84:87], v131 offset:16
  ds_read_b128 v[88:91], v131 offset:128
  ds_read_b128 v[92:95], v131 offset:144
  v_cvt_pk_bf16_f32 v96, v16, v17
  v_cvt_pk_bf16_f32 v97, v18, v19
  v_cvt_pk_bf16_f32 v98, v20, v21
  v_cvt_pk_bf16_f32 v99, v22, v23
  v_cvt_pk_bf16_f32 v100, v24, v25
  v_cvt_pk_bf16_f32 v101, v26, v27
  v_cvt_pk_bf16_f32 v102, v28, v29
  v_cvt_pk_bf16_f32 v103, v30, v31
  v_cvt_pk_bf16_f32 v104, v32, v33
  v_cvt_pk_bf16_f32 v105, v34, v35
  v_cvt_pk_bf16_f32 v106, v36, v37
  v_cvt_pk_bf16_f32 v107, v38, v39
  v_cvt_pk_bf16_f32 v108, v40, v41
  v_cvt_pk_bf16_f32 v109, v42, v43
  v_cvt_pk_bf16_f32 v110, v44, v45
  v_cvt_pk_bf16_f32 v111, v46, v47
  s_waitcnt lgkmcnt(0)
  v_add_f32 v70, v80, v82
  v_add_f32 v71, v84, v86
  v_add_f32 v72, v81, v83
  v_add_f32 v73, v85, v87
  v_add_f32 v70, v70, v71
  v_add_f32 v72, v72, v73
  v_mul_f32 v112, 0.25, v70
  v_sub_f32 v80, v80, v112
  v_sub_f32 v82, v82, v112
  v_sub_f32 v84, v84, v112
  v_sub_f32 v86, v86, v112
  v_mul_f32 v70, v80, v80
  v_mul_f32 v71, v82, v82
  v_fmac_f32 v70, v84, v84
  v_fmac_f32 v71, v86, v86
  v_add_f32 v70, v70, v71
  v_fmac_f32 v72, 0x43800000, v70
  v_mov_b32 v71, 0x3727c5ac
  v_fmac_f32 v71, 0x3a800000, v72
  v_rsq_f32 v114, v71
  v_add_f32 v70, v88, v90
  v_add_f32 v71, v92, v94
  v_add_f32 v72, v89, v91
  v_add_f32 v73, v93, v95
  v_add_f32 v70, v70, v71
  v_add_f32 v72, v72, v73
  v_mul_f32 v113, 0.25, v70
  v_sub_f32 v88, v88, v113
  v_sub_f32 v90, v90, v113
  v_sub_f32 v92, v92, v113
  v_sub_f32 v94, v94, v113
  v_mul_f32 v70, v88, v88
  v_mul_f32 v71, v90, v90
  v_fmac_f32 v70, v92, v92
  v_fmac_f32 v71, v94, v94
  v_add_f32 v70, v70, v71
  v_fmac_f32 v72, 0x43800000, v70
  v_mov_b32 v71, 0x3727c5ac
  v_fmac_f32 v71, 0x3a800000, v72
  v_rsq_f32 v115, v71
  v_mul_f32 v112, v112, v114
  v_mul_f32 v113, v113, v115
  v_fma_f32 v16, v16, v114, -v112
  v_fma_f32 v17, v17, v114, -v112
  v_fma_f32 v18, v18, v114, -v112
  v_fma_f32 v19, v19, v114, -v112
  v_fma_f32 v20, v20, v114, -v112
  v_fma_f32 v21, v21, v114, -v112
  v_fma_f32 v22, v22, v114, -v112
  v_fma_f32 v23, v23, v114, -v112
  v_fma_f32 v24, v24, v114, -v112
  v_fma_f32 v25, v25, v114, -v112
  v_fma_f32 v26, v26, v114, -v112
  v_fma_f32 v27, v27, v114, -v112
  v_fma_f32 v28, v28, v114, -v112
  v_fma_f32 v29, v29, v114, -v112
  v_fma_f32 v30, v30, v114, -v112
  v_fma_f32 v31, v31, v114, -v112
  v_fma_f32 v32, v32, v115, -v113
  v_fma_f32 v33, v33, v115, -v113
  v_fma_f32 v34, v34, v115, -v113
  v_fma_f32 v35, v35, v115, -v113
  v_fma_f32 v36, v36, v115, -v113
  v_fma_f32 v37, v37, v115, -v113
  v_fma_f32 v38, v38, v115, -v113
  v_fma_f32 v39, v39, v115, -v113
  v_fma_f32 v40, v40, v115, -v113
  v_fma_f32 v41, v41, v115, -v113
  v_fma_f32 v42, v42, v115, -v113
  v_fma_f32 v43, v43, v115, -v113
  v_fma_f32 v44, v44, v115, -v113
  v_fma_f32 v45, v45, v115, -v113
  v_fma_f32 v46, v46, v115, -v113
  v_fma_f32 v47, v47, v115, -v113
  v_cvt_pk_bf16_f32 v48, v16, v17
  v_cvt_pk_bf16_f32 v49, v18, v19
  v_cvt_pk_bf16_f32 v50, v20, v21
  v_cvt_pk_bf16_f32 v51, v22, v23
  v_cvt_pk_bf16_f32 v52, v24, v25
  v_cvt_pk_bf16_f32 v53, v26, v27
  v_cvt_pk_bf16_f32 v54, v28, v29
  v_cvt_pk_bf16_f32 v55, v30, v31
  v_cvt_pk_bf16_f32 v56, v32, v33
  v_cvt_pk_bf16_f32 v57, v34, v35
  v_cvt_pk_bf16_f32 v58, v36, v37
  v_cvt_pk_bf16_f32 v59, v38, v39
  v_cvt_pk_bf16_f32 v60, v40, v41
  v_cvt_pk_bf16_f32 v61, v42, v43
  v_cvt_pk_bf16_f32 v62, v44, v45
  v_cvt_pk_bf16_f32 v63, v46, v47
  buffer_store_dwordx4 v[48:51], v133, s[4:7], s88 offen offset:0 sc1
  buffer_store_dwordx4 v[52:55], v133, s[4:7], s88 offen offset:256 sc1
  buffer_store_dwordx4 v[56:59], v133, s[4:7], s88 offen offset:64 sc1
  buffer_store_dwordx4 v[60:63], v133, s[4:7], s88 offen offset:320 sc1
  ds_write_b128 v128, v[96:99] offset:0
  ds_write_b128 v129, v[100:103] offset:0
  ds_write_b128 v128, v[104:107] offset:8192
  ds_write_b128 v129, v[108:111] offset:8192
  s_lshl_b32 s80, s66, 2
  s_lshr_b32 s78, s67, 2
  s_add_u32 s80, s80, s78
  s_lshl_b32 s80, s80, 7
  s_and_b32 s78, s67, 3
  s_lshl_b32 s78, s78, 2
  s_add_u32 s78, s78, s30
  s_lshl_b32 s78, s78, 2
  s_add_u32 s80, s80, s78
  s_add_u32 s80, s80, 12288
  s_waitcnt vmcnt(0)
  v_mov_b32 v10, s31
  v_mov_b32 v11, 0
  s_mov_b64 exec, 1
  buffer_store_dword v10, v11, s[4:7], s80 offen sc1
  s_mov_b64 exec, -1
  s_waitcnt lgkmcnt(0)
  s_barrier
  ds_read_b128 v[96:99], v132 offset:0
  ds_read_b128 v[100:103], v132 offset:1024
  ds_read_b128 v[104:107], v132 offset:2048
  ds_read_b128 v[108:111], v132 offset:3072
  s_waitcnt lgkmcnt(0)
  s_barrier
  s_branch L_p3end_24
L_fin_23:
  v_cvt_pk_bf16_f32 v48, v16, v17
  v_cvt_pk_bf16_f32 v49, v18, v19
  v_cvt_pk_bf16_f32 v50, v20, v21
  v_cvt_pk_bf16_f32 v51, v22, v23
  v_cvt_pk_bf16_f32 v52, v24, v25
  v_cvt_pk_bf16_f32 v53, v26, v27
  v_cvt_pk_bf16_f32 v54, v28, v29
  v_cvt_pk_bf16_f32 v55, v30, v31
  v_cvt_pk_bf16_f32 v56, v32, v33
  v_cvt_pk_bf16_f32 v57, v34, v35
  v_cvt_pk_bf16_f32 v58, v36, v37
  v_cvt_pk_bf16_f32 v59, v38, v39
  v_cvt_pk_bf16_f32 v60, v40, v41
  v_cvt_pk_bf16_f32 v61, v42, v43
  v_cvt_pk_bf16_f32 v62, v44, v45
  v_cvt_pk_bf16_f32 v63, v46, v47
  v_lshrrev_b32 v64, 4, v0
  v_mul_u32_u24 v64, 2080, v64
  v_lshl_add_u32 v64, v135, 1, v64
  v_add_u32 v64, 97792, v64
  ds_write_b16 v64, v48 offset:0
  ds_write_b16_d16_hi v64, v48 offset:128
  ds_write_b16 v64, v49 offset:256
  ds_write_b16_d16_hi v64, v49 offset:384
  ds_write_b16 v64, v50 offset:512
  ds_write_b16_d16_hi v64, v50 offset:640
  ds_write_b16 v64, v51 offset:768
  ds_write_b16_d16_hi v64, v51 offset:896
  ds_write_b16 v64, v52 offset:1024
  ds_write_b16_d16_hi v64, v52 offset:1152
  ds_write_b16 v64, v53 offset:1280
  ds_write_b16_d16_hi v64, v53 offset:1408
  ds_write_b16 v64, v54 offset:1536
  ds_write_b16_d16_hi v64, v54 offset:1664
  ds_write_b16 v64, v55 offset:1792
  s_waitcnt lgkmcnt(12)
  ds_write_b16_d16_hi v64, v55 offset:1920
  ds_write_b16 v64, v56 offset:8320
  ds_write_b16_d16_hi v64, v56 offset:8448
  s_waitcnt lgkmcnt(12)
  ds_write_b16 v64, v57 offset:8576
  ds_write_b16_d16_hi v64, v57 offset:8704
  ds_write_b16 v64, v58 offset:8832
  s_waitcnt lgkmcnt(12)
  ds_write_b16_d16_hi v64, v58 offset:8960
  ds_write_b16 v64, v59 offset:9088
  ds_write_b16_d16_hi v64, v59 offset:9216
  s_waitcnt lgkmcnt(12)
  ds_write_b16 v64, v60 offset:9344
  ds_write_b16_d16_hi v64, v60 offset:9472
  ds_write_b16 v64, v61 offset:9600
  s_waitcnt lgkmcnt(12)
  ds_write_b16_d16_hi v64, v61 offset:9728
  ds_write_b16 v64, v62 offset:9856
  ds_write_b16_d16_hi v64, v62 offset:9984
  s_waitcnt lgkmcnt(12)
  ds_write_b16 v64, v63 offset:10112
  ds_write_b16_d16_hi v64, v63 offset:10240
  s_lshr_b32 s79, s67, 1
  s_lshl_b32 s79, s79, 4
  s_add_u32 s79, s79, s66
  s_and_b32 s78, s67, 1
  s_lshl_b32 s78, s78, 10
  s_add_u32 s79, s79, s78
  s_lshl_b32 s80, s30, 8
  s_add_u32 s79, s79, s80
  s_lshl_b32 s79, s79, 11
  s_add_u32 s80, s79, 262144
  s_mul_i32 s81, s30, 4160
  s_add_u32 s81, s81, 97792
  v_add_u32 v64, s81, v1
  s_waitcnt lgkmcnt(0)
  s_barrier
  ds_read_b128 v[48:51], v64 offset:0
  ds_read_b128 v[52:55], v64 offset:1024
  ds_read_b128 v[56:59], v64 offset:2080
  ds_read_b128 v[60:63], v64 offset:3104
  s_waitcnt lgkmcnt(0)
  buffer_store_dwordx4 v[48:51], v1, s[20:23], s79 offen sc1
  buffer_store_dwordx4 v[52:55], v1, s[20:23], s79 offen offset:1024 sc1
  buffer_store_dwordx4 v[56:59], v1, s[20:23], s80 offen sc1
  buffer_store_dwordx4 v[60:63], v1, s[20:23], s80 offen offset:1024 sc1
L_p3end_24:
  s_add_u32 s32, s32, 1
  s_cmp_eq_u32 s32, 1
  s_cbranch_scc1 L_LAYER
  s_waitcnt vmcnt(0) lgkmcnt(0)
L_END:
  s_endpgm
L_CODE_END:

.section .rodata,"a"
.p2align 6
.amdhsa_kernel interleave_layers__linear_attn_block__spectral_fnet__prompt_kernel
  .amdhsa_next_free_vgpr 512
  .amdhsa_next_free_sgpr 102
  .amdhsa_accum_offset 256
  .amdhsa_group_segment_fixed_size 0
  .amdhsa_kernarg_size 88
  .amdhsa_user_sgpr_count 2
  .amdhsa_user_sgpr_kernarg_segment_ptr 1
  .amdhsa_system_sgpr_workgroup_id_x 1
  .amdhsa_float_denorm_mode_32 3
.end_amdhsa_kernel
```
